```python
import torch

def _softmax(x, axis=-1):
    return torch.softmax(x, dim=axis)
def _gelu(x):
    return torch.nn.functional.gelu(x, approximate="tanh")
def _silu(x):
    return torch.nn.functional.silu(x)
def _sigmoid(x):
    return torch.sigmoid(x)
def _layernorm(x, axis=-1, eps=1e-5):
    m = x.mean(dim=axis, keepdim=True)
    v = x.var(dim=axis, keepdim=True, unbiased=False)
    return (x - m) / torch.sqrt(v + eps)
def _scatter_add(tgt, idx, src, axis=0):
    return tgt.clone().index_add_(axis, idx, src)
def _segment_sum(src, seg, n):
    out = torch.zeros((n,) + src.shape[1:], dtype=src.dtype)
    return out.index_add_(0, seg, src)
def _pad(x, pw):
    flat = tuple(v for pair in reversed(pw) for v in pair)
    return torch.nn.functional.pad(x, flat)

kernel_name = 'sequential_preLN__mha_block__mixer_token_mlp__prompt'

def setup_inputs():

    _w = (lambda a: (lambda t: t.to(torch.bfloat16) if t.is_floating_point() else t)(torch.as_tensor(a)))
    def _A_setup():
        B, S, D, H = 1, 2048, 448, 16
        return {
            "x": _w((lambda *s: torch.randn(*s, dtype=torch.bfloat16) * 0.05)(B, S, D)),
            "wqkv": _w((lambda *s: torch.randn(*s, dtype=torch.bfloat16) * 0.05)(D, 3 * D)),
            "wo": _w((lambda *s: torch.randn(*s, dtype=torch.bfloat16) * 0.05)(D, D)),
        }
    _A_in = _A_setup()

    def _B_setup():
        B, S, D, F = 1, 2048, 448, 1792
        return {
            "x": _w((lambda *s: torch.randn(*s, dtype=torch.bfloat16) * 0.05)(B, S, D)),
            "w1": _w((lambda *s: torch.randn(*s, dtype=torch.bfloat16) * 0.8)(S, F) * (S ** -0.5)),
            "b1": _w((lambda *s: torch.randn(*s, dtype=torch.bfloat16) * 12.8)(F) * 0.02),
            "w2": _w((lambda *s: torch.randn(*s, dtype=torch.bfloat16) * 0.2)(F, S) * (F ** -0.5)),
            "b2": _w((lambda *s: torch.randn(*s, dtype=torch.bfloat16) * 1.6)(S) * 0.02),
        }
    _B_in = _B_setup()

    return {
        "A_x": _A_in["x"],
        "A_wqkv": _A_in["wqkv"],
        "A_wo": _A_in["wo"],
        "B_x": _B_in["x"],
        "B_w1": _B_in["w1"],
        "B_b1": _B_in["b1"],
        "B_w2": _B_in["w2"],
        "B_b2": _B_in["b2"],
    }

def reference(A_x, A_wqkv, A_wo, B_x, B_w1, B_b1, B_w2, B_b2):
    def _A_ref(x, wqkv, wo):
        B, S, D = x.shape
        H = 16
        Dh = D // H
        qkv = (lambda x, *d: x.permute(*d))((x @ wqkv).reshape(B, S, 3, H, Dh), 2, 0, 3, 1, 4)
        q, k, v = qkv[0], qkv[1], qkv[2]
        scores = torch.einsum("bhqd,bhkd->bhqk", q, k) * (Dh ** -0.5)
        p = _softmax(scores, axis=-1)
        o = torch.einsum("bhqk,bhkd->bhqd", p, v)
        return (lambda x, *d: x.permute(*d))(o, 0, 2, 1, 3).reshape(B, S, D) @ wo

    def _B_ref(x, w1, b1, w2, b2):
        B, S, D = x.shape
        h = _layernorm(x, axis=-1)
        u = torch.einsum("bsd,sf->bdf", h, w1) + b1
        u = _gelu(u)
        y = torch.einsum("bdf,fs->bds", u, w2) + b2
        return (lambda x, *d: x.permute(*d))(y, 0, 2, 1)

    x = A_x
    h = x + _A_ref(_layernorm(x, axis=-1), A_wqkv, A_wo)
    h2 = h + _B_ref(_layernorm(h, axis=-1), B_w1, B_b1, B_w2, B_b2)
    return h2
```

```asm
; @launch grid=(256,1,1) block=(256,1,1) lds=163840
.amdgcn_target "amdgcn-amd-amdhsa--gfx950"
.text
.globl sequential_preLN__mha_block__mixer_token_mlp__prompt_kernel
.p2align 8
.type sequential_preLN__mha_block__mixer_token_mlp__prompt_kernel,@function
sequential_preLN__mha_block__mixer_token_mlp__prompt_kernel:
    s_load_dwordx16 s[44:59], s[0:1], 0
    s_getpc_b64 s[10:11]
    v_lshlrev_b32 v24, 5, v0
    v_mov_b32 v25, s11
    v_add_co_u32 v24, vcc, s10, v24
    s_cmp_ge_u32 s2, 256
    s_cbranch_scc1 Lm_end
    v_addc_co_u32 v25, vcc, 0, v25, vcc
    global_load_dword v26, v[24:25], off
    s_load_dwordx4 s[96:99], s[0:1], 64
    s_load_dwordx2 s[8:9], s[0:1], 80
    v_lshrrev_b32 v20, 6, v0
    v_and_b32 v1, 63, v0
    s_and_b32 s24, s2, 7
    v_readfirstlane_b32 s3, v20
    s_mov_b32 s18, 0x1c0000
    s_mov_b32 s19, 0x20000
    s_mov_b32 s14, 0x126000
    s_mov_b32 s15, 0x20000
    s_lshr_b32 s25, s2, 3
    s_lshr_b32 s26, s24, 2
    s_lshl_b32 s26, s26, 3
    s_and_b32 s27, s25, 7
    s_add_u32 s26, s26, s27
    s_and_b32 s27, s24, 3
    s_lshl_b32 s27, s27, 2
    s_lshr_b32 s28, s25, 3
    s_add_u32 s27, s27, s28
    s_lshl_b32 s28, s26, 2
    s_add_u32 s28, s28, s3
    v_lshrrev_b32 v20, 3, v1
    v_mul_u32_u24 v23, 2688, v20
    v_mul_u32_u24 v20, 896, v20
    v_lshrrev_b32 v21, 4, v1
    v_and_b32 v22, 7, v1
    v_xor_b32 v21, v21, v22
    v_lshl_add_u32 v2, v21, 4, v20
    v_xor_b32 v21, 4, v21
    v_lshl_add_u32 v3, v21, 4, v20
    v_add_u32 v3, 6144, v3
    v_add_u32 v4, 12288, v2
    v_add_u32 v5, 12288, v3
    v_bfe_u32 v21, v1, 4, 1
    v_lshlrev_b32 v21, 2, v21
    v_xor_b32 v21, v21, v22
    v_lshl_add_u32 v6, v21, 4, v23
    v_add_u32 v8, 20480, v6
    s_mov_b32 s34, 0xf7f77f7f
    s_mov_b32 s35, 0xf7f77f7f
    s_mul_i32 s29, s28, 28672
    s_mul_i32 s30, s27, 112
    s_mul_i32 s31, s3, 43008
    s_add_u32 s30, s30, s31
    s_add_u32 s30, s30, 896
    s_mul_i32 s31, s3, 16384
    s_lshl_b32 s32, s3, 11
    s_add_u32 s32, s32, 65536
    s_add_u32 s40, s26, s27
    s_and_b32 s40, s40, 1
    s_mul_i32 s40, s40, 3
    s_and_b32 s41, s24, 3
    s_mul_i32 s41, s41, 1
    s_add_u32 s40, s40, s41
    s_lshr_b32 s41, s24, 2
    s_mul_i32 s41, s41, 2
    s_add_u32 s40, s40, s41
    s_mul_i32 s41, s40, 37
    s_lshr_b32 s41, s41, 8
    s_mul_i32 s41, s41, 7
    s_sub_u32 s40, s40, s41
    s_add_u32 s41, s29, 896
    s_lshl_b32 s33, s40, 7
    s_add_u32 s29, s29, s33
    s_mul_i32 s40, s40, 172032
    s_add_u32 s30, s30, s40
    s_waitcnt lgkmcnt(0)
    s_mov_b64 s[16:17], s[44:45]
    s_mov_b64 s[12:13], s[46:47]
    s_add_u32 m0, s31, 0
    s_nop 0
    buffer_load_dwordx4 v2, s[16:19], s29 offen offset:0 lds
    buffer_load_dwordx4 v3, s[16:19], s29 offen offset:1024 lds
    buffer_load_dwordx4 v4, s[16:19], s29 offen offset:2048 lds
    buffer_load_dwordx4 v5, s[16:19], s29 offen offset:3072 lds
    s_add_u32 s29, s29, 128
    s_add_u32 m0, s32, 0
    s_mov_b64 exec, s[34:35]
    buffer_load_dwordx4 v6, s[12:15], s30 offen offset:0 lds
    s_mov_b64 exec, -1
    s_mov_b64 exec, s[34:35]
    buffer_load_dwordx4 v8, s[12:15], s30 offen offset:1024 lds
    s_mov_b64 exec, -1
    s_add_u32 s30, s30, 172032
    s_cmp_ge_u32 s29, s41
    s_cselect_b32 s33, 896, 0
    s_sub_u32 s29, s29, s33
    s_mul_i32 s33, s33, 1344
    s_sub_u32 s30, s30, s33
    v_bfe_u32 v20, v0, 1, 1
    v_lshlrev_b32 v20, 6, v20
    v_xor_b32 v20, 112, v20
    v_lshl_add_u32 v20, v0, 7, v20
    v_add_u32 v20, 65536, v20
    v_mov_b32 v24, 0x3f80
    v_mov_b32 v25, 0
    ds_write_b64 v20, v[24:25]
    v_and_b32 v22, 31, v1
    v_lshrrev_b32 v23, 5, v1
    v_bfe_u32 v20, v1, 1, 3
    v_xor_b32 v20, v20, v23
    v_lshlrev_b32 v21, 3, v20
    v_lshl_add_u32 v21, v22, 6, v21
    v_add_u32 v109, s31, v21
    v_xor_b32 v110, 16, v109
    v_xor_b32 v111, 32, v109
    v_xor_b32 v112, 48, v109
    v_lshlrev_b32 v20, 4, v20
    v_lshl_add_u32 v20, v22, 7, v20
    s_lshl_b32 s33, s3, 5
    v_xor_b32 v20, s33, v20
    v_add_u32 v9, s31, v20
    v_xor_b32 v10, 32, v9
    v_xor_b32 v11, 64, v9
    v_xor_b32 v12, 0x60, v9
    v_bfe_u32 v17, v1, 2, 2
    v_bfe_u32 v21, v1, 4, 1
    v_and_b32 v24, 3, v1
    v_lshl_add_u32 v21, v21, 2, v24
    v_lshl_add_u32 v18, v23, 2, v17
    v_lshrrev_b32 v19, 1, v18
    v_xor_b32 v19, v19, v21
    v_lshlrev_b32 v19, 3, v19
    v_lshl_add_u32 v19, v18, 6, v19
    v_add_u32 v113, s31, v19
    v_xor_b32 v114, 32, v113
    v_lshl_add_u32 v20, v23, 3, v17
    v_lshlrev_b32 v21, 3, v21
    v_lshl_add_u32 v108, v20, 6, v21
    s_lshl_b32 s33, s3, 10
    s_add_u32 s33, s33, 98304
    v_add_u32 v108, s33, v108
    v_bfe_u32 v19, v1, 3, 1
    v_lshlrev_b32 v19, 6, v19
    v_lshl_add_u32 v20, v20, 7, s32
    v_xor_b32 v18, v19, v21
    v_add_u32 v13, v20, v18
    v_add_u32 v21, 56, v21
    v_xor_b32 v18, v19, v21
    v_add_u32 v104, v20, v18
    v_mov_b32 v27, 0x3f803f80
    v_lshlrev_b32 v115, 4, v1
    v_add_u32 v115, 127232, v115
    s_lshl_b32 s33, s3, 10
    v_add_u32 v116, s33, v115
    v_xor_b32 v14, 2048, v13
    v_xor_b32 v105, 2048, v104
    v_xor_b32 v15, 4096, v13
    v_xor_b32 v106, 4096, v104
    v_xor_b32 v16, 6144, v13
    v_xor_b32 v107, 6144, v104
    v_mov_b32 v28, 0
    v_mov_b32 v29, 0
    v_mov_b32 v30, 0
    v_mov_b32 v31, 0
    s_add_u32 m0, s31, 4096
    s_nop 0
    buffer_load_dwordx4 v2, s[16:19], s29 offen offset:0 lds
    buffer_load_dwordx4 v3, s[16:19], s29 offen offset:1024 lds
    buffer_load_dwordx4 v4, s[16:19], s29 offen offset:2048 lds
    buffer_load_dwordx4 v5, s[16:19], s29 offen offset:3072 lds
    s_add_u32 s29, s29, 128
    s_add_u32 m0, s32, 8192
    s_mov_b64 exec, s[34:35]
    buffer_load_dwordx4 v6, s[12:15], s30 offen offset:0 lds
    s_mov_b64 exec, -1
    s_mov_b64 exec, s[34:35]
    buffer_load_dwordx4 v8, s[12:15], s30 offen offset:1024 lds
    s_mov_b64 exec, -1
    s_add_u32 s30, s30, 172032
    s_cmp_ge_u32 s29, s41
    s_cselect_b32 s33, 896, 0
    s_sub_u32 s29, s29, s33
    s_mul_i32 s33, s33, 1344
    s_sub_u32 s30, s30, s33
    s_mov_b32 s20, s8
    s_mov_b32 s21, s9
    s_mov_b32 s22, 0xf00000
    s_mov_b32 s23, 0x20000
    s_mov_b32 s4, s98
    s_mov_b32 s5, s99
    s_mov_b32 s6, 0x100
    s_mov_b32 s7, 0x20000
    s_mov_b32 s100, s96
    s_mov_b32 s101, s97
    s_getpc_b64 s[10:11]
Lm_pc:
    s_lshl_b32 s33, s25, 2
    s_add_u32 s33, s33, s3
    s_lshl_b32 s33, s33, 9
    v_and_b32 v24, 3, v1
    v_lshl_add_u32 v24, v24, 7, s33
    v_min_u32 v24, L_text_end-Lm_pc-4, v24
    v_mov_b32 v25, s11
    v_add_co_u32 v24, vcc, s10, v24
    s_nop 1
    v_addc_co_u32 v25, vcc, 0, v25, vcc
    s_mov_b64 exec, 15
    global_load_dword v26, v[24:25], off
    s_memrealtime s[10:11]
    s_lshl_b32 s33, s2, 8
    v_lshlrev_b32 v20, 8, v0
    s_waitcnt lgkmcnt(0)
    s_or_b32 s10, s10, 1
    v_mov_b32 v22, s10
    v_mov_b32 v23, s11
    s_mov_b64 exec, 1
    buffer_store_dwordx2 v[22:23], v20, s[4:7], s33 offen sc1
    s_mov_b64 exec, -1
    v_lshrrev_b32 v7, 2, v1
    v_mul_u32_u24 v7, 2688, v7
    v_and_b32 v17, 3, v1
    v_lshl_add_u32 v7, v17, 4, v7
    s_mul_i32 s36, s27, 56
    s_mul_i32 s37, s3, 301056
    s_add_u32 s36, s36, s37
    s_add_u32 s36, s36, s40
    s_mul_i32 s37, s3, 7168
    s_add_u32 s37, s37, 98304
    s_and_b32 s38, s27, 7
    s_lshl_b32 s38, s38, 7
    s_add_u32 s38, s38, s28
    s_lshl_b32 s38, s38, 12
    s_and_b32 s39, s27, 8
    s_lshl_b32 s39, s39, 8
    s_add_u32 s38, s38, s39
    s_add_u32 s38, s38, 0x200000
    s_add_u32 s39, s38, 262144
    s_mov_b32 s42, 0
    s_mov_b32 s43, -1
    v_mov_b32 v18, 0
    v_mov_b32 v19, 0
    s_waitcnt vmcnt(8) lgkmcnt(0)
    s_barrier
    ds_read_b128 v[200:203], v9 offset:0
    ds_read_b64_tr_b16 v[120:121], v13 offset:0
    ds_read_b64_tr_b16 v[122:123], v13 offset:512
    ds_read_b64_tr_b16 v[124:125], v104 offset:0
    ds_read_b64_tr_b16 v[126:127], v104 offset:512
    ds_read_b128 v[204:207], v10 offset:0
    ds_read_b64_tr_b16 v[128:129], v14 offset:0
    ds_read_b64_tr_b16 v[130:131], v14 offset:512
    ds_read_b64_tr_b16 v[132:133], v105 offset:0
    ds_read_b64_tr_b16 v[134:135], v105 offset:512
    s_waitcnt lgkmcnt(5)
    v_mfma_f32_32x32x16_bf16 v[40:55], v[120:123], v[200:203], 0
    s_add_u32 m0, s31, 8192
    s_nop 0
    buffer_load_dwordx4 v2, s[16:19], s29 offen offset:0 lds
    ds_read_b128 v[208:211], v11 offset:0
    ds_read_b64_tr_b16 v[136:137], v15 offset:0
    v_accvgpr_write_b32 a144, v200
    v_accvgpr_write_b32 a145, v201
    v_mfma_f32_32x32x16_bf16 v[56:71], v[124:127], v[200:203], 0
    buffer_load_dwordx4 v3, s[16:19], s29 offen offset:1024 lds
    buffer_load_dwordx4 v4, s[16:19], s29 offen offset:2048 lds
    ds_read_b64_tr_b16 v[138:139], v15 offset:512
    ds_read_b64_tr_b16 v[140:141], v106 offset:0
    ds_read_b64_tr_b16 v[142:143], v106 offset:512
    v_accvgpr_write_b32 a146, v202
    v_accvgpr_write_b32 a147, v203
    s_waitcnt lgkmcnt(5)
    v_mfma_f32_32x32x16_bf16 v[40:55], v[128:131], v[204:207], v[40:55]
    buffer_load_dwordx4 v5, s[16:19], s29 offen offset:3072 lds
    s_add_u32 s29, s29, 128
    s_add_u32 m0, s32, 16384
    ds_read_b128 v[212:215], v12 offset:0
    ds_read_b64_tr_b16 v[120:121], v16 offset:0
    v_accvgpr_write_b32 a148, v204
    v_accvgpr_write_b32 a149, v205
    v_mfma_f32_32x32x16_bf16 v[56:71], v[132:135], v[204:207], v[56:71]
    s_mov_b64 exec, s[34:35]
    buffer_load_dwordx4 v6, s[12:15], s30 offen offset:0 lds
    s_mov_b64 exec, -1
    s_mov_b64 exec, s[34:35]
    buffer_load_dwordx4 v8, s[12:15], s30 offen offset:1024 lds
    s_mov_b64 exec, -1
    s_add_u32 s30, s30, 172032
    s_cmp_ge_u32 s29, s41
    s_cselect_b32 s33, 896, 0
    s_sub_u32 s29, s29, s33
    s_mul_i32 s33, s33, 1344
    s_sub_u32 s30, s30, s33
    ds_read_b64_tr_b16 v[122:123], v16 offset:512
    ds_read_b64_tr_b16 v[124:125], v107 offset:0
    ds_read_b64_tr_b16 v[126:127], v107 offset:512
    v_accvgpr_write_b32 a150, v206
    v_accvgpr_write_b32 a151, v207
    s_waitcnt vmcnt(8) lgkmcnt(5)
    s_barrier
    v_dot2_f32_bf16 v18, v200, v200, v18
    v_dot2_f32_bf16 v19, v201, v201, v19
    v_dot2_f32_bf16 v18, v202, v202, v18
    v_dot2_f32_bf16 v19, v203, v203, v19
    v_dot2_f32_bf16 v18, v204, v204, v18
    v_dot2_f32_bf16 v19, v205, v205, v19
    v_dot2_f32_bf16 v18, v206, v206, v18
    v_dot2_f32_bf16 v19, v207, v207, v19
    v_dot2_f32_bf16 v28, v128, v27, v28
    v_dot2_f32_bf16 v29, v132, v27, v29
    v_dot2_f32_bf16 v28, v129, v27, v28
    v_dot2_f32_bf16 v29, v133, v27, v29
    v_dot2_f32_bf16 v28, v130, v27, v28
    v_dot2_f32_bf16 v29, v134, v27, v29
    v_dot2_f32_bf16 v28, v131, v27, v28
    v_dot2_f32_bf16 v29, v135, v27, v29
    v_mfma_f32_32x32x16_bf16 v[40:55], v[136:139], v[208:211], v[40:55]
    ds_read_b128 v[216:219], v9 offset:4096
    ds_read_b64_tr_b16 v[128:129], v13 offset:8192
    v_accvgpr_write_b32 a152, v208
    v_accvgpr_write_b32 a153, v209
    v_mfma_f32_32x32x16_bf16 v[56:71], v[140:143], v[208:211], v[56:71]
    s_add_u32 m0, s31, 12288
    s_nop 0
    buffer_load_dwordx4 v2, s[16:19], s29 offen offset:0 lds
    ds_read_b64_tr_b16 v[130:131], v13 offset:8704
    ds_read_b64_tr_b16 v[132:133], v104 offset:8192
    ds_read_b64_tr_b16 v[134:135], v104 offset:8704
    v_accvgpr_write_b32 a154, v210
    v_accvgpr_write_b32 a155, v211
    s_waitcnt lgkmcnt(5)
    v_mfma_f32_32x32x16_bf16 v[40:55], v[120:123], v[212:215], v[40:55]
    buffer_load_dwordx4 v3, s[16:19], s29 offen offset:1024 lds
    ds_read_b128 v[220:223], v10 offset:4096
    ds_read_b64_tr_b16 v[136:137], v14 offset:8192
    v_accvgpr_write_b32 a156, v212
    v_accvgpr_write_b32 a157, v213
    v_mfma_f32_32x32x16_bf16 v[56:71], v[124:127], v[212:215], v[56:71]
    buffer_load_dwordx4 v4, s[16:19], s29 offen offset:2048 lds
    ds_read_b64_tr_b16 v[138:139], v14 offset:8704
    ds_read_b64_tr_b16 v[140:141], v105 offset:8192
    ds_read_b64_tr_b16 v[142:143], v105 offset:8704
    v_accvgpr_write_b32 a158, v214
    v_accvgpr_write_b32 a159, v215
    s_waitcnt lgkmcnt(5)
    v_mfma_f32_32x32x16_bf16 v[40:55], v[128:131], v[216:219], v[40:55]
    buffer_load_dwordx4 v5, s[16:19], s29 offen offset:3072 lds
    s_add_u32 s29, s29, 128
    s_add_u32 m0, s32, 24576
    ds_read_b128 v[224:227], v11 offset:4096
    ds_read_b64_tr_b16 v[120:121], v15 offset:8192
    v_accvgpr_write_b32 a160, v216
    v_accvgpr_write_b32 a161, v217
    v_mfma_f32_32x32x16_bf16 v[56:71], v[132:135], v[216:219], v[56:71]
    s_mov_b64 exec, s[34:35]
    buffer_load_dwordx4 v6, s[12:15], s30 offen offset:0 lds
    s_mov_b64 exec, -1
    ds_read_b64_tr_b16 v[122:123], v15 offset:8704
    ds_read_b64_tr_b16 v[124:125], v106 offset:8192
    ds_read_b64_tr_b16 v[126:127], v106 offset:8704
    v_accvgpr_write_b32 a162, v218
    v_accvgpr_write_b32 a163, v219
    s_waitcnt lgkmcnt(5)
    v_mfma_f32_32x32x16_bf16 v[40:55], v[136:139], v[220:223], v[40:55]
    ds_read_b128 v[228:231], v12 offset:4096
    ds_read_b64_tr_b16 v[128:129], v16 offset:8192
    v_accvgpr_write_b32 a164, v220
    v_accvgpr_write_b32 a165, v221
    v_mfma_f32_32x32x16_bf16 v[56:71], v[140:143], v[220:223], v[56:71]
    s_mov_b64 exec, s[34:35]
    buffer_load_dwordx4 v8, s[12:15], s30 offen offset:1024 lds
    s_mov_b64 exec, -1
    s_add_u32 s30, s30, 172032
    s_cmp_ge_u32 s29, s41
    s_cselect_b32 s33, 896, 0
    s_sub_u32 s29, s29, s33
    s_mul_i32 s33, s33, 1344
    s_sub_u32 s30, s30, s33
    ds_read_b64_tr_b16 v[130:131], v16 offset:8704
    ds_read_b64_tr_b16 v[132:133], v107 offset:8192
    ds_read_b64_tr_b16 v[134:135], v107 offset:8704
    v_accvgpr_write_b32 a166, v222
    v_accvgpr_write_b32 a167, v223
    s_waitcnt vmcnt(6) lgkmcnt(5)
    s_barrier
    v_dot2_f32_bf16 v18, v208, v208, v18
    v_dot2_f32_bf16 v19, v209, v209, v19
    v_dot2_f32_bf16 v18, v210, v210, v18
    v_dot2_f32_bf16 v19, v211, v211, v19
    v_dot2_f32_bf16 v18, v212, v212, v18
    v_dot2_f32_bf16 v19, v213, v213, v19
    v_dot2_f32_bf16 v18, v214, v214, v18
    v_dot2_f32_bf16 v19, v215, v215, v19
    v_dot2_f32_bf16 v18, v216, v216, v18
    v_dot2_f32_bf16 v19, v217, v217, v19
    v_dot2_f32_bf16 v18, v218, v218, v18
    v_dot2_f32_bf16 v19, v219, v219, v19
    v_dot2_f32_bf16 v18, v220, v220, v18
    v_dot2_f32_bf16 v19, v221, v221, v19
    v_dot2_f32_bf16 v18, v222, v222, v18
    v_dot2_f32_bf16 v19, v223, v223, v19
    v_dot2_f32_bf16 v28, v136, v27, v28
    v_dot2_f32_bf16 v29, v140, v27, v29
    v_dot2_f32_bf16 v28, v137, v27, v28
    v_dot2_f32_bf16 v29, v141, v27, v29
    v_dot2_f32_bf16 v28, v138, v27, v28
    v_dot2_f32_bf16 v29, v142, v27, v29
    v_dot2_f32_bf16 v28, v139, v27, v28
    v_dot2_f32_bf16 v29, v143, v27, v29
    v_mfma_f32_32x32x16_bf16 v[40:55], v[120:123], v[224:227], v[40:55]
    ds_read_b128 v[200:203], v9 offset:8192
    ds_read_b64_tr_b16 v[136:137], v13 offset:16384
    v_accvgpr_write_b32 a168, v224
    v_accvgpr_write_b32 a169, v225
    v_mfma_f32_32x32x16_bf16 v[56:71], v[124:127], v[224:227], v[56:71]
    s_add_u32 m0, s31, 0
    s_nop 0
    buffer_load_dwordx4 v2, s[16:19], s29 offen offset:0 lds
    ds_read_b64_tr_b16 v[138:139], v13 offset:16896
    ds_read_b64_tr_b16 v[140:141], v104 offset:16384
    ds_read_b64_tr_b16 v[142:143], v104 offset:16896
    v_accvgpr_write_b32 a170, v226
    v_accvgpr_write_b32 a171, v227
    s_waitcnt lgkmcnt(5)
    v_mfma_f32_32x32x16_bf16 v[40:55], v[128:131], v[228:231], v[40:55]
    buffer_load_dwordx4 v3, s[16:19], s29 offen offset:1024 lds
    ds_read_b128 v[204:207], v10 offset:8192
    ds_read_b64_tr_b16 v[120:121], v14 offset:16384
    v_accvgpr_write_b32 a172, v228
    v_accvgpr_write_b32 a173, v229
    v_mfma_f32_32x32x16_bf16 v[56:71], v[132:135], v[228:231], v[56:71]
    buffer_load_dwordx4 v4, s[16:19], s29 offen offset:2048 lds
    ds_read_b64_tr_b16 v[122:123], v14 offset:16896
    ds_read_b64_tr_b16 v[124:125], v105 offset:16384
    ds_read_b64_tr_b16 v[126:127], v105 offset:16896
    v_accvgpr_write_b32 a174, v230
    v_accvgpr_write_b32 a175, v231
    s_waitcnt lgkmcnt(5)
    v_mfma_f32_32x32x16_bf16 v[40:55], v[136:139], v[200:203], v[40:55]
    buffer_load_dwordx4 v5, s[16:19], s29 offen offset:3072 lds
    s_add_u32 s29, s29, 128
    s_add_u32 m0, s32, 0
    ds_read_b128 v[208:211], v11 offset:8192
    ds_read_b64_tr_b16 v[128:129], v15 offset:16384
    v_accvgpr_write_b32 a176, v200
    v_accvgpr_write_b32 a177, v201
    v_mfma_f32_32x32x16_bf16 v[56:71], v[140:143], v[200:203], v[56:71]
    s_mov_b64 exec, s[34:35]
    buffer_load_dwordx4 v6, s[12:15], s30 offen offset:0 lds
    s_mov_b64 exec, -1
    ds_read_b64_tr_b16 v[130:131], v15 offset:16896
    ds_read_b64_tr_b16 v[132:133], v106 offset:16384
    ds_read_b64_tr_b16 v[134:135], v106 offset:16896
    v_accvgpr_write_b32 a178, v202
    v_accvgpr_write_b32 a179, v203
    s_waitcnt lgkmcnt(5)
    v_mfma_f32_32x32x16_bf16 v[40:55], v[120:123], v[204:207], v[40:55]
    ds_read_b128 v[212:215], v12 offset:8192
    ds_read_b64_tr_b16 v[136:137], v16 offset:16384
    v_accvgpr_write_b32 a180, v204
    v_accvgpr_write_b32 a181, v205
    v_mfma_f32_32x32x16_bf16 v[56:71], v[124:127], v[204:207], v[56:71]
    s_mov_b64 exec, s[34:35]
    buffer_load_dwordx4 v8, s[12:15], s30 offen offset:1024 lds
    s_mov_b64 exec, -1
    s_add_u32 s30, s30, 172032
    s_cmp_ge_u32 s29, s41
    s_cselect_b32 s33, 896, 0
    s_sub_u32 s29, s29, s33
    s_mul_i32 s33, s33, 1344
    s_sub_u32 s30, s30, s33
    ds_read_b64_tr_b16 v[138:139], v16 offset:16896
    ds_read_b64_tr_b16 v[140:141], v107 offset:16384
    ds_read_b64_tr_b16 v[142:143], v107 offset:16896
    v_accvgpr_write_b32 a182, v206
    v_accvgpr_write_b32 a183, v207
    s_waitcnt vmcnt(6) lgkmcnt(5)
    s_barrier
    v_dot2_f32_bf16 v18, v224, v224, v18
    v_dot2_f32_bf16 v19, v225, v225, v19
    v_dot2_f32_bf16 v18, v226, v226, v18
    v_dot2_f32_bf16 v19, v227, v227, v19
    v_dot2_f32_bf16 v18, v228, v228, v18
    v_dot2_f32_bf16 v19, v229, v229, v19
    v_dot2_f32_bf16 v18, v230, v230, v18
    v_dot2_f32_bf16 v19, v231, v231, v19
    v_dot2_f32_bf16 v18, v200, v200, v18
    v_dot2_f32_bf16 v19, v201, v201, v19
    v_dot2_f32_bf16 v18, v202, v202, v18
    v_dot2_f32_bf16 v19, v203, v203, v19
    v_dot2_f32_bf16 v18, v204, v204, v18
    v_dot2_f32_bf16 v19, v205, v205, v19
    v_dot2_f32_bf16 v18, v206, v206, v18
    v_dot2_f32_bf16 v19, v207, v207, v19
    v_dot2_f32_bf16 v28, v120, v27, v28
    v_dot2_f32_bf16 v29, v124, v27, v29
    v_dot2_f32_bf16 v28, v121, v27, v28
    v_dot2_f32_bf16 v29, v125, v27, v29
    v_dot2_f32_bf16 v28, v122, v27, v28
    v_dot2_f32_bf16 v29, v126, v27, v29
    v_dot2_f32_bf16 v28, v123, v27, v28
    v_dot2_f32_bf16 v29, v127, v27, v29
    v_mfma_f32_32x32x16_bf16 v[40:55], v[128:131], v[208:211], v[40:55]
    ds_read_b128 v[216:219], v9 offset:12288
    ds_read_b64_tr_b16 v[120:121], v13 offset:24576
    v_accvgpr_write_b32 a184, v208
    v_accvgpr_write_b32 a185, v209
    v_mfma_f32_32x32x16_bf16 v[56:71], v[132:135], v[208:211], v[56:71]
    s_add_u32 m0, s31, 4096
    s_nop 0
    buffer_load_dwordx4 v2, s[16:19], s29 offen offset:0 lds
    ds_read_b64_tr_b16 v[122:123], v13 offset:25088
    ds_read_b64_tr_b16 v[124:125], v104 offset:24576
    ds_read_b64_tr_b16 v[126:127], v104 offset:25088
    v_accvgpr_write_b32 a186, v210
    v_accvgpr_write_b32 a187, v211
    s_waitcnt lgkmcnt(5)
    v_mfma_f32_32x32x16_bf16 v[40:55], v[136:139], v[212:215], v[40:55]
    buffer_load_dwordx4 v3, s[16:19], s29 offen offset:1024 lds
    ds_read_b128 v[220:223], v10 offset:12288
    ds_read_b64_tr_b16 v[128:129], v14 offset:24576
    v_accvgpr_write_b32 a188, v212
    v_accvgpr_write_b32 a189, v213
    v_mfma_f32_32x32x16_bf16 v[56:71], v[140:143], v[212:215], v[56:71]
    buffer_load_dwordx4 v4, s[16:19], s29 offen offset:2048 lds
    ds_read_b64_tr_b16 v[130:131], v14 offset:25088
    ds_read_b64_tr_b16 v[132:133], v105 offset:24576
    ds_read_b64_tr_b16 v[134:135], v105 offset:25088
    v_accvgpr_write_b32 a190, v214
    v_accvgpr_write_b32 a191, v215
    s_waitcnt lgkmcnt(5)
    v_mfma_f32_32x32x16_bf16 v[40:55], v[120:123], v[216:219], v[40:55]
    buffer_load_dwordx4 v5, s[16:19], s29 offen offset:3072 lds
    s_add_u32 s29, s29, 128
    s_add_u32 m0, s32, 8192
    ds_read_b128 v[224:227], v11 offset:12288
    ds_read_b64_tr_b16 v[136:137], v15 offset:24576
    v_accvgpr_write_b32 a192, v216
    v_accvgpr_write_b32 a193, v217
    v_mfma_f32_32x32x16_bf16 v[56:71], v[124:127], v[216:219], v[56:71]
    s_mov_b64 exec, s[34:35]
    buffer_load_dwordx4 v6, s[12:15], s30 offen offset:0 lds
    s_mov_b64 exec, -1
    ds_read_b64_tr_b16 v[138:139], v15 offset:25088
    ds_read_b64_tr_b16 v[140:141], v106 offset:24576
    ds_read_b64_tr_b16 v[142:143], v106 offset:25088
    v_accvgpr_write_b32 a194, v218
    v_accvgpr_write_b32 a195, v219
    s_waitcnt lgkmcnt(5)
    v_mfma_f32_32x32x16_bf16 v[40:55], v[128:131], v[220:223], v[40:55]
    ds_read_b128 v[228:231], v12 offset:12288
    ds_read_b64_tr_b16 v[120:121], v16 offset:24576
    v_accvgpr_write_b32 a196, v220
    v_accvgpr_write_b32 a197, v221
    v_mfma_f32_32x32x16_bf16 v[56:71], v[132:135], v[220:223], v[56:71]
    s_mov_b64 exec, s[34:35]
    buffer_load_dwordx4 v8, s[12:15], s30 offen offset:1024 lds
    s_mov_b64 exec, -1
    s_add_u32 s30, s30, 172032
    s_cmp_ge_u32 s29, s41
    s_cselect_b32 s33, 896, 0
    s_sub_u32 s29, s29, s33
    s_mul_i32 s33, s33, 1344
    s_sub_u32 s30, s30, s33
    ds_read_b64_tr_b16 v[122:123], v16 offset:25088
    ds_read_b64_tr_b16 v[124:125], v107 offset:24576
    ds_read_b64_tr_b16 v[126:127], v107 offset:25088
    v_accvgpr_write_b32 a198, v222
    v_accvgpr_write_b32 a199, v223
    s_waitcnt vmcnt(6) lgkmcnt(5)
    s_barrier
    v_dot2_f32_bf16 v18, v208, v208, v18
    v_dot2_f32_bf16 v19, v209, v209, v19
    v_dot2_f32_bf16 v18, v210, v210, v18
    v_dot2_f32_bf16 v19, v211, v211, v19
    v_dot2_f32_bf16 v18, v212, v212, v18
    v_dot2_f32_bf16 v19, v213, v213, v19
    v_dot2_f32_bf16 v18, v214, v214, v18
    v_dot2_f32_bf16 v19, v215, v215, v19
    v_dot2_f32_bf16 v18, v216, v216, v18
    v_dot2_f32_bf16 v19, v217, v217, v19
    v_dot2_f32_bf16 v18, v218, v218, v18
    v_dot2_f32_bf16 v19, v219, v219, v19
    v_dot2_f32_bf16 v18, v220, v220, v18
    v_dot2_f32_bf16 v19, v221, v221, v19
    v_dot2_f32_bf16 v18, v222, v222, v18
    v_dot2_f32_bf16 v19, v223, v223, v19
    v_dot2_f32_bf16 v28, v128, v27, v28
    v_dot2_f32_bf16 v29, v132, v27, v29
    v_dot2_f32_bf16 v28, v129, v27, v28
    v_dot2_f32_bf16 v29, v133, v27, v29
    v_dot2_f32_bf16 v28, v130, v27, v28
    v_dot2_f32_bf16 v29, v134, v27, v29
    v_dot2_f32_bf16 v28, v131, v27, v28
    v_dot2_f32_bf16 v29, v135, v27, v29
    v_mfma_f32_32x32x16_bf16 v[40:55], v[136:139], v[224:227], v[40:55]
    ds_read_b128 v[200:203], v9 offset:0
    ds_read_b64_tr_b16 v[128:129], v13 offset:0
    v_accvgpr_write_b32 a200, v224
    v_accvgpr_write_b32 a201, v225
    v_mfma_f32_32x32x16_bf16 v[56:71], v[140:143], v[224:227], v[56:71]
    s_add_u32 m0, s31, 8192
    s_nop 0
    buffer_load_dwordx4 v2, s[16:19], s29 offen offset:0 lds
    ds_read_b64_tr_b16 v[130:131], v13 offset:512
    ds_read_b64_tr_b16 v[132:133], v104 offset:0
    ds_read_b64_tr_b16 v[134:135], v104 offset:512
    v_accvgpr_write_b32 a202, v226
    v_accvgpr_write_b32 a203, v227
    s_waitcnt lgkmcnt(5)
    v_mfma_f32_32x32x16_bf16 v[40:55], v[120:123], v[228:231], v[40:55]
    buffer_load_dwordx4 v3, s[16:19], s29 offen offset:1024 lds
    ds_read_b128 v[204:207], v10 offset:0
    ds_read_b64_tr_b16 v[136:137], v14 offset:0
    v_accvgpr_write_b32 a204, v228
    v_accvgpr_write_b32 a205, v229
    v_mfma_f32_32x32x16_bf16 v[56:71], v[124:127], v[228:231], v[56:71]
    buffer_load_dwordx4 v4, s[16:19], s29 offen offset:2048 lds
    ds_read_b64_tr_b16 v[138:139], v14 offset:512
    ds_read_b64_tr_b16 v[140:141], v105 offset:0
    ds_read_b64_tr_b16 v[142:143], v105 offset:512
    v_accvgpr_write_b32 a206, v230
    v_accvgpr_write_b32 a207, v231
    s_waitcnt lgkmcnt(5)
    v_mfma_f32_32x32x16_bf16 v[40:55], v[128:131], v[200:203], v[40:55]
    buffer_load_dwordx4 v5, s[16:19], s29 offen offset:3072 lds
    s_add_u32 s29, s29, 128
    s_add_u32 m0, s32, 16384
    ds_read_b128 v[208:211], v11 offset:0
    ds_read_b64_tr_b16 v[120:121], v15 offset:0
    v_accvgpr_write_b32 a208, v200
    v_accvgpr_write_b32 a209, v201
    v_mfma_f32_32x32x16_bf16 v[56:71], v[132:135], v[200:203], v[56:71]
    s_mov_b64 exec, s[34:35]
    buffer_load_dwordx4 v6, s[12:15], s30 offen offset:0 lds
    s_mov_b64 exec, -1
    ds_read_b64_tr_b16 v[122:123], v15 offset:512
    ds_read_b64_tr_b16 v[124:125], v106 offset:0
    ds_read_b64_tr_b16 v[126:127], v106 offset:512
    v_accvgpr_write_b32 a210, v202
    v_accvgpr_write_b32 a211, v203
    s_waitcnt lgkmcnt(5)
    v_mfma_f32_32x32x16_bf16 v[40:55], v[136:139], v[204:207], v[40:55]
    ds_read_b128 v[212:215], v12 offset:0
    ds_read_b64_tr_b16 v[128:129], v16 offset:0
    v_accvgpr_write_b32 a212, v204
    v_accvgpr_write_b32 a213, v205
    v_mfma_f32_32x32x16_bf16 v[56:71], v[140:143], v[204:207], v[56:71]
    s_mov_b64 exec, s[34:35]
    buffer_load_dwordx4 v8, s[12:15], s30 offen offset:1024 lds
    s_mov_b64 exec, -1
    s_add_u32 s30, s30, 172032
    ds_read_b64_tr_b16 v[130:131], v16 offset:512
    ds_read_b64_tr_b16 v[132:133], v107 offset:0
    ds_read_b64_tr_b16 v[134:135], v107 offset:512
    v_accvgpr_write_b32 a214, v206
    v_accvgpr_write_b32 a215, v207
    s_waitcnt vmcnt(6) lgkmcnt(5)
    s_barrier
    v_dot2_f32_bf16 v18, v224, v224, v18
    v_dot2_f32_bf16 v19, v225, v225, v19
    v_dot2_f32_bf16 v18, v226, v226, v18
    v_dot2_f32_bf16 v19, v227, v227, v19
    v_dot2_f32_bf16 v18, v228, v228, v18
    v_dot2_f32_bf16 v19, v229, v229, v19
    v_dot2_f32_bf16 v18, v230, v230, v18
    v_dot2_f32_bf16 v19, v231, v231, v19
    v_dot2_f32_bf16 v18, v200, v200, v18
    v_dot2_f32_bf16 v19, v201, v201, v19
    v_dot2_f32_bf16 v18, v202, v202, v18
    v_dot2_f32_bf16 v19, v203, v203, v19
    v_dot2_f32_bf16 v18, v204, v204, v18
    v_dot2_f32_bf16 v19, v205, v205, v19
    v_dot2_f32_bf16 v18, v206, v206, v18
    v_dot2_f32_bf16 v19, v207, v207, v19
    v_dot2_f32_bf16 v28, v136, v27, v28
    v_dot2_f32_bf16 v29, v140, v27, v29
    v_dot2_f32_bf16 v28, v137, v27, v28
    v_dot2_f32_bf16 v29, v141, v27, v29
    v_dot2_f32_bf16 v28, v138, v27, v28
    v_dot2_f32_bf16 v29, v142, v27, v29
    v_dot2_f32_bf16 v28, v139, v27, v28
    v_dot2_f32_bf16 v29, v143, v27, v29
    v_mfma_f32_32x32x16_bf16 v[40:55], v[120:123], v[208:211], v[40:55]
    s_add_u32 m0, s37, 0
    s_cmp_ge_u32 s36, 1204224
    s_cselect_b32 s33, 1204224, 0
    s_sub_u32 s36, s36, s33
    buffer_load_dwordx4 v7, s[12:15], s36 offen lds
    s_add_u32 s36, s36, 43008
    ds_read_b128 v[216:219], v9 offset:4096
    ds_read_b64_tr_b16 v[136:137], v13 offset:8192
    v_accvgpr_write_b32 a216, v208
    v_accvgpr_write_b32 a217, v209
    v_mfma_f32_32x32x16_bf16 v[56:71], v[124:127], v[208:211], v[56:71]
    s_add_u32 m0, s37, 1024
    s_cmp_ge_u32 s36, 1204224
    s_cselect_b32 s33, 1204224, 0
    s_sub_u32 s36, s36, s33
    buffer_load_dwordx4 v7, s[12:15], s36 offen lds
    s_add_u32 s36, s36, 43008
    ds_read_b64_tr_b16 v[138:139], v13 offset:8704
    ds_read_b64_tr_b16 v[140:141], v104 offset:8192
    ds_read_b64_tr_b16 v[142:143], v104 offset:8704
    v_accvgpr_write_b32 a218, v210
    v_accvgpr_write_b32 a219, v211
    s_waitcnt lgkmcnt(5)
    v_mfma_f32_32x32x16_bf16 v[40:55], v[128:131], v[212:215], v[40:55]
    s_add_u32 m0, s37, 2048
    s_cmp_ge_u32 s36, 1204224
    s_cselect_b32 s33, 1204224, 0
    s_sub_u32 s36, s36, s33
    buffer_load_dwordx4 v7, s[12:15], s36 offen lds
    s_add_u32 s36, s36, 43008
    ds_read_b128 v[220:223], v10 offset:4096
    ds_read_b64_tr_b16 v[120:121], v14 offset:8192
    v_accvgpr_write_b32 a220, v212
    v_accvgpr_write_b32 a221, v213
    v_mfma_f32_32x32x16_bf16 v[56:71], v[132:135], v[212:215], v[56:71]
    s_add_u32 m0, s37, 3072
    s_cmp_ge_u32 s36, 1204224
    s_cselect_b32 s33, 1204224, 0
    s_sub_u32 s36, s36, s33
    buffer_load_dwordx4 v7, s[12:15], s36 offen lds
    s_add_u32 s36, s36, 43008
    ds_read_b64_tr_b16 v[122:123], v14 offset:8704
    ds_read_b64_tr_b16 v[124:125], v105 offset:8192
    ds_read_b64_tr_b16 v[126:127], v105 offset:8704
    v_accvgpr_write_b32 a222, v214
    v_accvgpr_write_b32 a223, v215
    s_waitcnt lgkmcnt(5)
    v_mfma_f32_32x32x16_bf16 v[40:55], v[136:139], v[216:219], v[40:55]
    s_add_u32 m0, s37, 4096
    s_cmp_ge_u32 s36, 1204224
    s_cselect_b32 s33, 1204224, 0
    s_sub_u32 s36, s36, s33
    buffer_load_dwordx4 v7, s[12:15], s36 offen lds
    s_add_u32 s36, s36, 43008
    ds_read_b128 v[224:227], v11 offset:4096
    ds_read_b64_tr_b16 v[128:129], v15 offset:8192
    v_accvgpr_write_b32 a224, v216
    v_accvgpr_write_b32 a225, v217
    v_mfma_f32_32x32x16_bf16 v[56:71], v[140:143], v[216:219], v[56:71]
    s_add_u32 m0, s37, 5120
    s_cmp_ge_u32 s36, 1204224
    s_cselect_b32 s33, 1204224, 0
    s_sub_u32 s36, s36, s33
    buffer_load_dwordx4 v7, s[12:15], s36 offen lds
    s_add_u32 s36, s36, 43008
    ds_read_b64_tr_b16 v[130:131], v15 offset:8704
    ds_read_b64_tr_b16 v[132:133], v106 offset:8192
    ds_read_b64_tr_b16 v[134:135], v106 offset:8704
    v_accvgpr_write_b32 a226, v218
    v_accvgpr_write_b32 a227, v219
    s_waitcnt lgkmcnt(5)
    v_mfma_f32_32x32x16_bf16 v[40:55], v[120:123], v[220:223], v[40:55]
    s_add_u32 m0, s37, 6144
    s_cmp_ge_u32 s36, 1204224
    s_cselect_b32 s33, 1204224, 0
    s_sub_u32 s36, s36, s33
    buffer_load_dwordx4 v7, s[12:15], s36 offen lds
    s_add_u32 s36, s36, 43008
    ds_read_b128 v[228:231], v12 offset:4096
    ds_read_b64_tr_b16 v[136:137], v16 offset:8192
    v_accvgpr_write_b32 a228, v220
    v_accvgpr_write_b32 a229, v221
    v_mfma_f32_32x32x16_bf16 v[56:71], v[124:127], v[220:223], v[56:71]
    v_lshlrev_b32 v2, 4, v1
    v_mov_b32 v3, 0
    v_mov_b32 v26, 0x3f80
    ds_read_b64_tr_b16 v[138:139], v16 offset:8704
    ds_read_b64_tr_b16 v[140:141], v107 offset:8192
    ds_read_b64_tr_b16 v[142:143], v107 offset:8704
    v_accvgpr_write_b32 a230, v222
    v_accvgpr_write_b32 a231, v223
    s_waitcnt vmcnt(7) lgkmcnt(5)
    s_barrier
    v_dot2_f32_bf16 v18, v208, v208, v18
    v_dot2_f32_bf16 v19, v209, v209, v19
    v_dot2_f32_bf16 v18, v210, v210, v18
    v_dot2_f32_bf16 v19, v211, v211, v19
    v_dot2_f32_bf16 v18, v212, v212, v18
    v_dot2_f32_bf16 v19, v213, v213, v19
    v_dot2_f32_bf16 v18, v214, v214, v18
    v_dot2_f32_bf16 v19, v215, v215, v19
    v_dot2_f32_bf16 v18, v216, v216, v18
    v_dot2_f32_bf16 v19, v217, v217, v19
    v_dot2_f32_bf16 v18, v218, v218, v18
    v_dot2_f32_bf16 v19, v219, v219, v19
    v_dot2_f32_bf16 v18, v220, v220, v18
    v_dot2_f32_bf16 v19, v221, v221, v19
    v_dot2_f32_bf16 v18, v222, v222, v18
    v_dot2_f32_bf16 v19, v223, v223, v19
    v_dot2_f32_bf16 v28, v120, v27, v28
    v_dot2_f32_bf16 v29, v124, v27, v29
    v_dot2_f32_bf16 v28, v121, v27, v28
    v_dot2_f32_bf16 v29, v125, v27, v29
    v_dot2_f32_bf16 v28, v122, v27, v28
    v_dot2_f32_bf16 v29, v126, v27, v29
    v_dot2_f32_bf16 v28, v123, v27, v28
    v_dot2_f32_bf16 v29, v127, v27, v29
    v_mfma_f32_32x32x16_bf16 v[40:55], v[128:131], v[224:227], v[40:55]
    v_mov_b32 v34, 0
    v_mov_b32 v35, 0
    v_mov_b32 v38, 0
    v_mov_b32 v39, 0
    v_mov_b32 v22, 0
    v_mov_b32 v23, 0
    ds_read_b128 v[200:203], v9 offset:8192
    ds_read_b64_tr_b16 v[120:121], v13 offset:16384
    v_accvgpr_write_b32 a232, v224
    v_accvgpr_write_b32 a233, v225
    v_mfma_f32_32x32x16_bf16 v[56:71], v[132:135], v[224:227], v[56:71]
    s_lshl_b32 s33, s3, 11
    v_add_u32 v117, s33, v2
    v_add_u32 v117, 135424, v117
    ds_read_b64_tr_b16 v[122:123], v13 offset:16896
    ds_read_b64_tr_b16 v[124:125], v104 offset:16384
    ds_read_b64_tr_b16 v[126:127], v104 offset:16896
    v_accvgpr_write_b32 a234, v226
    v_accvgpr_write_b32 a235, v227
    s_waitcnt lgkmcnt(5)
    v_mfma_f32_32x32x16_bf16 v[40:55], v[136:139], v[228:231], v[40:55]
    buffer_load_dwordx2 v[24:25], v3, s[4:7], 0 offen sc1
    s_mov_b64 s[12:13], s[52:53]
    s_mov_b32 s14, 0x700000
    s_mov_b64 s[96:97], s[48:49]
    s_mov_b32 s98, 0x62000
    s_mov_b32 s99, 0x20000
    ds_read_b128 v[204:207], v10 offset:8192
    ds_read_b64_tr_b16 v[128:129], v14 offset:16384
    v_accvgpr_write_b32 a236, v228
    v_accvgpr_write_b32 a237, v229
    v_mfma_f32_32x32x16_bf16 v[56:71], v[140:143], v[228:231], v[56:71]
    s_lshl_b32 s11, s25, 2
    s_add_u32 s11, s11, s3
    s_mul_i32 s11, s11, 3200
    v_min_u32 v5, 24, v1
    v_lshlrev_b32 v5, 7, v5
    ds_read_b64_tr_b16 v[130:131], v14 offset:16896
    ds_read_b64_tr_b16 v[132:133], v105 offset:16384
    ds_read_b64_tr_b16 v[134:135], v105 offset:16896
    v_accvgpr_write_b32 a238, v230
    v_accvgpr_write_b32 a239, v231
    s_waitcnt lgkmcnt(5)
    v_mfma_f32_32x32x16_bf16 v[40:55], v[120:123], v[200:203], v[40:55]
    ds_read_b128 v[208:211], v11 offset:8192
    ds_read_b64_tr_b16 v[136:137], v15 offset:16384
    v_accvgpr_write_b32 a240, v200
    v_accvgpr_write_b32 a241, v201
    v_mfma_f32_32x32x16_bf16 v[56:71], v[124:127], v[200:203], v[56:71]
    buffer_load_dword v6, v5, s[96:99], s11 offen
    ds_read_b64_tr_b16 v[138:139], v15 offset:16896
    ds_read_b64_tr_b16 v[140:141], v106 offset:16384
    ds_read_b64_tr_b16 v[142:143], v106 offset:16896
    v_accvgpr_write_b32 a242, v202
    v_accvgpr_write_b32 a243, v203
    s_waitcnt lgkmcnt(5)
    v_dot2_f32_bf16 v28, v128, v27, v28
    v_dot2_f32_bf16 v29, v132, v27, v29
    v_dot2_f32_bf16 v28, v129, v27, v28
    v_dot2_f32_bf16 v29, v133, v27, v29
    v_dot2_f32_bf16 v28, v130, v27, v28
    v_dot2_f32_bf16 v29, v134, v27, v29
    v_dot2_f32_bf16 v28, v131, v27, v28
    v_dot2_f32_bf16 v29, v135, v27, v29
    v_mfma_f32_32x32x16_bf16 v[40:55], v[128:131], v[204:207], v[40:55]
    ds_read_b128 v[212:215], v12 offset:8192
    ds_read_b64_tr_b16 v[120:121], v16 offset:16384
    ds_read_b64_tr_b16 v[122:123], v16 offset:16896
    v_accvgpr_write_b32 a244, v204
    v_accvgpr_write_b32 a245, v205
    v_mfma_f32_32x32x16_bf16 v[56:71], v[132:135], v[204:207], v[56:71]
    ds_read_b64_tr_b16 v[124:125], v107 offset:16384
    ds_read_b64_tr_b16 v[126:127], v107 offset:16896
    ds_write_b128 v116, v[28:31]
    v_accvgpr_write_b32 a246, v206
    v_accvgpr_write_b32 a247, v207
    s_waitcnt lgkmcnt(0)
    s_barrier
    ds_read_b128 v[88:91], v115 offset:0
    ds_read_b128 v[92:95], v115 offset:1024
    ds_read_b128 v[96:99], v115 offset:2048
    ds_read_b128 v[100:103], v115 offset:3072
    v_dot2_f32_bf16 v18, v224, v224, v18
    v_dot2_f32_bf16 v19, v225, v225, v19
    v_dot2_f32_bf16 v18, v226, v226, v18
    v_dot2_f32_bf16 v19, v227, v227, v19
    v_dot2_f32_bf16 v18, v228, v228, v18
    v_dot2_f32_bf16 v19, v229, v229, v19
    v_dot2_f32_bf16 v18, v230, v230, v18
    v_dot2_f32_bf16 v19, v231, v231, v19
    v_dot2_f32_bf16 v18, v200, v200, v18
    v_dot2_f32_bf16 v19, v201, v201, v19
    v_dot2_f32_bf16 v18, v202, v202, v18
    v_dot2_f32_bf16 v19, v203, v203, v19
    v_dot2_f32_bf16 v18, v204, v204, v18
    v_dot2_f32_bf16 v19, v205, v205, v19
    v_dot2_f32_bf16 v18, v206, v206, v18
    v_dot2_f32_bf16 v19, v207, v207, v19
    v_dot2_f32_bf16 v18, v208, v208, v18
    v_dot2_f32_bf16 v19, v209, v209, v19
    v_dot2_f32_bf16 v18, v210, v210, v18
    v_dot2_f32_bf16 v19, v211, v211, v19
    v_dot2_f32_bf16 v18, v212, v212, v18
    v_dot2_f32_bf16 v19, v213, v213, v19
    v_dot2_f32_bf16 v18, v214, v214, v18
    v_dot2_f32_bf16 v19, v215, v215, v19
    v_mfma_f32_32x32x16_bf16 v[56:71], v[140:143], v[208:211], v[56:71]
    s_waitcnt lgkmcnt(0)
    s_nop 0
    v_add_f32 v18, v18, v19
    v_mov_b32 v19, v18
    v_mfma_f32_32x32x16_bf16 v[56:71], v[124:127], v[212:215], v[56:71]
    v_add_f32 v89, v89, v93
    v_add_f32 v97, v97, v101
    v_add_f32 v89, v89, v97
    v_cvt_pk_bf16_f32 v21, v89, 0
    v_lshlrev_b32 v93, 16, v21
    v_sub_f32 v93, v89, v93
    v_cvt_pk_bf16_f32 v20, v89, v93
    v_mfma_f32_32x32x16_bf16 v[40:55], v[136:139], v[208:211], v[40:55]
    v_permlane32_swap_b32 v18, v19
    v_add_f32 v18, v18, v19
    v_mul_f32 v18, 0x3b124925, v18
    v_xor_b32 v14, 1024, v108
    v_mfma_f32_32x32x16_bf16 v[40:55], v[120:123], v[212:215], v[40:55]
    v_mov_b32 v16, v68
    v_mov_b32 v17, v68
    v_xor_b32 v15, 2048, v108
    v_xor_b32 v13, 3072, v108
    v_permlane32_swap_b32 v17, v16
    v_mul_f32 v16, 0xbb124925, v16
    v_cvt_pk_bf16_f32 v32, v16, v16
    v_and_b32 v17, 0xffff0000, v32
    v_sub_f32 v17, v16, v17
    v_cvt_pk_bf16_f32 v33, v17, 0
    v_fma_f32 v18, -v16, v16, v18
    v_max_f32 v18, 0, v18
    v_mfma_f32_32x32x16_bf16 v[56:71], v[20:23], v[32:35], v[56:71]
    v_add_f32 v88, v88, v92
    v_add_f32 v96, v96, v100
    v_add_f32 v88, v88, v96
    v_cvt_pk_bf16_f32 v37, v88, 0
    v_lshlrev_b32 v92, 16, v37
    v_sub_f32 v92, v88, v92
    v_cvt_pk_bf16_f32 v36, v88, v92
    v_add_f32 v18, 0x3727c5ac, v18
    v_rsq_f32 v18, v18
    v_mfma_f32_32x32x16_bf16 v[40:55], v[36:39], v[32:35], v[40:55]
    s_cmp_lt_u32 s27, 8
    s_cselect_b32 s33, 0, 0x3f80
    v_mov_b32 v26, s33
    v_mul_f32 v56, v56, v18
    v_mul_f32 v57, v57, v18
    v_mul_f32 v58, v58, v18
    v_mul_f32 v59, v59, v18
    v_mul_f32 v60, v60, v18
    v_mul_f32 v61, v61, v18
    v_mul_f32 v62, v62, v18
    v_mul_f32 v63, v63, v18
    v_mul_f32 v64, v64, v18
    v_mul_f32 v65, v65, v18
    v_mul_f32 v66, v66, v18
    v_mul_f32 v67, v67, v18
    v_mul_f32 v68, v68, v18
    v_mul_f32 v69, v69, v18
    v_mul_f32 v70, v70, v18
    v_mul_f32 v71, v71, v18
    v_cvt_pk_bf16_f32 v96, v56, v57
    v_cvt_pk_bf16_f32 v97, v58, v59
    v_cvt_pk_bf16_f32 v98, v60, v61
    v_cvt_pk_bf16_f32 v99, v62, v63
    v_cvt_pk_bf16_f32 v100, v64, v65
    v_cvt_pk_bf16_f32 v101, v66, v67
    v_cvt_pk_bf16_f32 v102, v68, v69
    v_cvt_pk_bf16_f32 v103, v70, v71
    v_cndmask_b32 v102, v102, v26, s[42:43]
    v_cndmask_b32 v103, v103, 0, s[42:43]
    s_cmp_lt_u32 s27, 8
    s_cbranch_scc0 L1_v
    buffer_store_dwordx4 v[96:99], v2, s[20:23], s39 offen sc1
    buffer_store_dwordx4 v[100:103], v2, s[20:23], s39 offen offset:1024 sc1
    v_pk_mul_f32 v[40:41], v[40:41], v[18:19] op_sel:[0,0] op_sel_hi:[1,0]
    v_pk_mul_f32 v[42:43], v[42:43], v[18:19] op_sel:[0,0] op_sel_hi:[1,0]
    v_pk_mul_f32 v[44:45], v[44:45], v[18:19] op_sel:[0,0] op_sel_hi:[1,0]
    v_pk_mul_f32 v[46:47], v[46:47], v[18:19] op_sel:[0,0] op_sel_hi:[1,0]
    v_pk_mul_f32 v[48:49], v[48:49], v[18:19] op_sel:[0,0] op_sel_hi:[1,0]
    v_pk_mul_f32 v[50:51], v[50:51], v[18:19] op_sel:[0,0] op_sel_hi:[1,0]
    v_pk_mul_f32 v[52:53], v[52:53], v[18:19] op_sel:[0,0] op_sel_hi:[1,0]
    v_pk_mul_f32 v[54:55], v[54:55], v[18:19] op_sel:[0,0] op_sel_hi:[1,0]
    v_cvt_pk_bf16_f32 v88, v40, v41
    v_cvt_pk_bf16_f32 v89, v42, v43
    v_cvt_pk_bf16_f32 v90, v44, v45
    v_cvt_pk_bf16_f32 v91, v46, v47
    v_cvt_pk_bf16_f32 v92, v48, v49
    v_cvt_pk_bf16_f32 v93, v50, v51
    v_cvt_pk_bf16_f32 v94, v52, v53
    v_cvt_pk_bf16_f32 v95, v54, v55
    v_cndmask_b32 v94, v94, v26, s[42:43]
    v_cndmask_b32 v95, v95, 0, s[42:43]
    buffer_store_dwordx4 v[88:91], v2, s[20:23], s38 offen sc1
    buffer_store_dwordx4 v[92:95], v2, s[20:23], s38 offen offset:1024 sc1
    s_branch L1_n
L1_v:
    ds_write_b64 v109, v[96:97] offset:0
    ds_write_b64 v110, v[98:99] offset:0
    ds_write_b64 v111, v[100:101] offset:0
    ds_write_b64 v112, v[102:103] offset:0
    ds_read_b64_tr_b16 v[120:121], v113 offset:0
    ds_read_b64_tr_b16 v[122:123], v114 offset:512
    ds_read_b64_tr_b16 v[124:125], v113 offset:1024
    ds_read_b64_tr_b16 v[126:127], v114 offset:1536
    v_pk_mul_f32 v[40:41], v[40:41], v[18:19] op_sel:[0,0] op_sel_hi:[1,0]
    v_pk_mul_f32 v[42:43], v[42:43], v[18:19] op_sel:[0,0] op_sel_hi:[1,0]
    v_pk_mul_f32 v[44:45], v[44:45], v[18:19] op_sel:[0,0] op_sel_hi:[1,0]
    v_pk_mul_f32 v[46:47], v[46:47], v[18:19] op_sel:[0,0] op_sel_hi:[1,0]
    v_pk_mul_f32 v[48:49], v[48:49], v[18:19] op_sel:[0,0] op_sel_hi:[1,0]
    v_pk_mul_f32 v[50:51], v[50:51], v[18:19] op_sel:[0,0] op_sel_hi:[1,0]
    v_pk_mul_f32 v[52:53], v[52:53], v[18:19] op_sel:[0,0] op_sel_hi:[1,0]
    v_pk_mul_f32 v[54:55], v[54:55], v[18:19] op_sel:[0,0] op_sel_hi:[1,0]
    v_cvt_pk_bf16_f32 v88, v40, v41
    v_cvt_pk_bf16_f32 v89, v42, v43
    v_cvt_pk_bf16_f32 v90, v44, v45
    v_cvt_pk_bf16_f32 v91, v46, v47
    v_cvt_pk_bf16_f32 v92, v48, v49
    v_cvt_pk_bf16_f32 v93, v50, v51
    v_cvt_pk_bf16_f32 v94, v52, v53
    v_cvt_pk_bf16_f32 v95, v54, v55
    v_cndmask_b32 v94, v94, v26, s[42:43]
    v_cndmask_b32 v95, v95, 0, s[42:43]
    ds_write_b64 v109, v[88:89] offset:2048
    ds_write_b64 v110, v[90:91] offset:2048
    ds_write_b64 v111, v[92:93] offset:2048
    ds_write_b64 v112, v[94:95] offset:2048
    ds_read_b64_tr_b16 v[128:129], v113 offset:2048
    ds_read_b64_tr_b16 v[130:131], v114 offset:2560
    ds_read_b64_tr_b16 v[132:133], v113 offset:3072
    ds_read_b64_tr_b16 v[134:135], v114 offset:3584
    s_waitcnt lgkmcnt(8)
    buffer_store_dwordx4 v[120:123], v2, s[20:23], s39 offen sc1
    buffer_store_dwordx4 v[124:127], v2, s[20:23], s39 offen offset:1024 sc1
    s_waitcnt lgkmcnt(0)
    buffer_store_dwordx4 v[128:131], v2, s[20:23], s38 offen sc1
    buffer_store_dwordx4 v[132:135], v2, s[20:23], s38 offen offset:1024 sc1
L1_n:
    v_accvgpr_write_b32 a248, v208
    v_accvgpr_write_b32 a249, v209
    v_accvgpr_write_b32 a250, v210
    v_accvgpr_write_b32 a251, v211
    v_accvgpr_write_b32 a252, v212
    v_accvgpr_write_b32 a253, v213
    v_accvgpr_write_b32 a254, v214
    v_accvgpr_write_b32 a255, v215
    s_waitcnt vmcnt(6)
    s_barrier
    ds_read_b64_tr_b16 v[40:41], v108 offset:0
    ds_read_b64_tr_b16 v[42:43], v108 offset:256
    ds_read_b64_tr_b16 v[44:45], v108 offset:4096
    ds_read_b64_tr_b16 v[46:47], v108 offset:4352
    ds_read_b64_tr_b16 v[48:49], v108 offset:8192
    ds_read_b64_tr_b16 v[50:51], v108 offset:8448
    ds_read_b64_tr_b16 v[52:53], v108 offset:12288
    ds_read_b64_tr_b16 v[54:55], v108 offset:12544
    ds_read_b64_tr_b16 v[56:57], v108 offset:16384
    ds_read_b64_tr_b16 v[58:59], v108 offset:16640
    ds_read_b64_tr_b16 v[60:61], v108 offset:20480
    ds_read_b64_tr_b16 v[62:63], v108 offset:20736
    ds_read_b64_tr_b16 v[64:65], v108 offset:24576
    ds_read_b64_tr_b16 v[66:67], v108 offset:24832
    s_mov_b32 s10, 1048576
    s_waitcnt vmcnt(5)
Lm_tag:
    v_cmp_ne_u32 vcc, 0, v24
    s_nop 4
    s_cbranch_vccnz Lm_tage
    buffer_load_dwordx2 v[24:25], v3, s[4:7], 0 offen sc1
    s_sub_u32 s10, s10, 1
    s_waitcnt vmcnt(0)
    s_cbranch_scc0 Lm_tag
Lm_tage:
    s_lshl_b32 s34, s27, 4
    s_add_u32 s34, s34, s26
    s_lshl_b32 s34, s34, 7
    s_add_u32 s34, s34, 0xe80000
    v_lshlrev_b32 v9, 24, v0
    v_mov_b32 v190, v24
    v_mov_b32 v191, v25
    s_mov_b32 s31, s28
    s_lshl_b32 s35, s27, 18
    s_add_u32 s35, s35, 0x200000
    s_lshl_b32 s38, s3, 16
    s_add_u32 s38, s38, s35
    v_bfe_u32 v188, v1, 2, 1
    v_lshlrev_b32 v188, 7, v188
    v_and_b32 v189, 3, v1
    v_add_lshl_u32 v188, v188, v189, 7
    s_lshr_b32 s47, s27, 1
    s_lshl_b32 s47, s47, 2
    s_add_u32 s47, s47, s3
    s_lshl_b32 s47, s47, 9
    s_add_u32 s47, s47, 0xe80000
    v_lshlrev_b32 v189, 7, v0
    s_waitcnt lgkmcnt(0)
    ds_read_b64_tr_b16 v[120:121], v14 offset:0
    ds_read_b64_tr_b16 v[122:123], v14 offset:256
    ds_read_b64_tr_b16 v[124:125], v15 offset:0
    ds_read_b64_tr_b16 v[126:127], v15 offset:256
    ds_read_b64_tr_b16 v[128:129], v13 offset:0
    ds_read_b64_tr_b16 v[130:131], v13 offset:256
    ds_read_b64_tr_b16 v[132:133], v14 offset:4096
    ds_read_b64_tr_b16 v[134:135], v14 offset:4352
    ds_read_b64_tr_b16 v[136:137], v15 offset:4096
    ds_read_b64_tr_b16 v[138:139], v15 offset:4352
    v_dot2_f32_bf16 v30, v40, v27, v30
    v_dot2_f32_bf16 v31, v41, v27, v31
    v_dot2_f32_bf16 v30, v42, v27, v30
    v_dot2_f32_bf16 v31, v43, v27, v31
    v_dot2_f32_bf16 v30, v44, v27, v30
    v_dot2_f32_bf16 v31, v45, v27, v31
    v_dot2_f32_bf16 v30, v46, v27, v30
    v_dot2_f32_bf16 v31, v47, v27, v31
    v_dot2_f32_bf16 v30, v48, v27, v30
    v_dot2_f32_bf16 v31, v49, v27, v31
    v_dot2_f32_bf16 v30, v50, v27, v30
    v_dot2_f32_bf16 v31, v51, v27, v31
    v_dot2_f32_bf16 v30, v52, v27, v30
    v_dot2_f32_bf16 v31, v53, v27, v31
    v_dot2_f32_bf16 v30, v54, v27, v30
    v_dot2_f32_bf16 v31, v55, v27, v31
    v_dot2_f32_bf16 v30, v56, v27, v30
    v_dot2_f32_bf16 v31, v57, v27, v31
    v_dot2_f32_bf16 v30, v58, v27, v30
    v_dot2_f32_bf16 v31, v59, v27, v31
    v_dot2_f32_bf16 v30, v60, v27, v30
    v_dot2_f32_bf16 v31, v61, v27, v31
    v_dot2_f32_bf16 v30, v62, v27, v30
    v_dot2_f32_bf16 v31, v63, v27, v31
    v_dot2_f32_bf16 v30, v64, v27, v30
    v_dot2_f32_bf16 v31, v65, v27, v31
    v_dot2_f32_bf16 v30, v66, v27, v30
    v_dot2_f32_bf16 v31, v67, v27, v31
    s_nop 2
    v_add_f32 v30, v30, v31
    ds_write_b128 v116, v[28:31] offset:4096
    v_mfma_f32_32x32x16_bf16 v[72:87], v[40:43], a[144:147], 0
    s_mov_b32 s4, s48
    s_mov_b32 s5, s49
    s_mov_b32 s6, 0x62000
    s_mov_b32 s7, 0x20000
    s_mov_b32 s96, s54
    v_mfma_f32_32x32x16_bf16 v[72:87], v[44:47], a[160:163], v[72:87]
    s_mov_b32 s97, s55
    s_mov_b32 s98, 0xe00
    s_mov_b32 s99, 0x20000
    v_lshrrev_b32 v7, 5, v1
    v_lshlrev_b32 v166, 3, v7
    v_mfma_f32_32x32x16_bf16 v[72:87], v[48:51], a[176:179], v[72:87]
    v_and_b32 v167, 31, v1
    v_mul_u32_u24 v165, 896, v167
    v_lshl_add_u32 v165, v7, 4, v165
    v_lshlrev_b32 v167, 1, v167
    s_lshl_b32 s39, s31, 4
    v_mfma_f32_32x32x16_bf16 v[72:87], v[52:55], a[192:195], v[72:87]
    s_add_u32 s39, s39, s27
    s_lshl_b32 s39, s39, 11
    s_add_u32 s39, s39, 0x600000
    s_lshl_b32 s40, s2, 2
    s_add_u32 s40, s40, s3
    v_mfma_f32_32x32x16_bf16 v[72:87], v[56:59], a[208:211], v[72:87]
    s_waitcnt vmcnt(0) lgkmcnt(0)
    s_barrier
    buffer_store_dwordx2 v[24:25], v9, s[20:23], s34 offen sc1
    ds_read_b128 v[88:91], v115 offset:4096
    ds_read_b128 v[92:95], v115 offset:5120
    ds_read_b128 v[96:99], v115 offset:6144
    ds_read_b128 v[100:103], v115 offset:7168
    s_mul_i32 s40, s40, 6144
    s_add_u32 s40, s40, 0x600000
    s_lshl_b32 s44, s2, 5
    s_add_u32 s44, s44, s3
    s_lshl_b32 s44, s44, 2
    v_mfma_f32_32x32x16_bf16 v[72:87], v[60:63], a[224:227], v[72:87]
    s_add_u32 s44, s44, 0xe88000
    s_mov_b32 s45, 0xe88000
    s_and_b32 s10, s3, 1
    s_lshr_b32 s11, s3, 1
    s_lshl_b32 s28, s24, 2
    v_mfma_f32_32x32x16_bf16 v[72:87], v[64:67], a[240:243], v[72:87]
    s_and_b32 s29, s25, 3
    s_add_u32 s28, s28, s29
    s_mul_i32 s27, s3, 1835008
    s_lshl_b32 s42, s28, 7
    s_add_u32 s27, s27, s42
    s_waitcnt lgkmcnt(0)
    v_mfma_f32_32x32x16_bf16 v[72:87], v[120:123], a[148:151], v[72:87]
    ds_read_b64_tr_b16 v[140:141], v13 offset:4096
    ds_read_b64_tr_b16 v[142:143], v13 offset:4352
    s_lshl_b32 s28, s28, 1
    s_add_u32 s28, s28, s10
    s_lshr_b32 s29, s25, 2
    s_mul_i32 s48, s3, 100352
    s_lshl_b32 s42, s29, 7
    s_waitcnt lgkmcnt(12)
    v_mfma_f32_32x32x16_bf16 v[72:87], v[124:127], a[152:155], v[72:87]
    ds_read_b64_tr_b16 v[120:121], v14 offset:8192
    ds_read_b64_tr_b16 v[122:123], v14 offset:8448
    s_add_u32 s48, s48, s42
    s_mul_i32 s49, s3, 14336
    s_add_u32 s49, s49, 106496
    s_lshl_b32 s29, s29, 1
    s_waitcnt lgkmcnt(8)
    v_mfma_f32_32x32x16_bf16 v[72:87], v[128:131], a[156:159], v[72:87]
    ds_read_b64_tr_b16 v[124:125], v15 offset:8192
    ds_read_b64_tr_b16 v[126:127], v15 offset:8448
    s_add_u32 s29, s29, s11
    s_mul_i32 s30, s24, 49
    s_add_u32 s30, s30, 1
    s_lshr_b32 s30, s30, 1
    s_waitcnt lgkmcnt(8)
    v_mfma_f32_32x32x16_bf16 v[72:87], v[132:135], a[164:167], v[72:87]
    ds_read_b64_tr_b16 v[128:129], v13 offset:8192
    ds_read_b64_tr_b16 v[130:131], v13 offset:8448
    v_add_f32 v90, v90, v94
    v_add_f32 v98, v98, v102
    v_add_f32 v90, v90, v98
    v_cvt_pk_bf16_f32 v37, v90, 0
    v_lshlrev_b32 v94, 16, v37
    v_sub_f32 v94, v90, v94
    v_cvt_pk_bf16_f32 v36, v90, v94
    s_add_u32 s30, s30, s25
    s_mul_i32 s32, s30, 9363
    s_lshr_b32 s32, s32, 16
    s_mul_i32 s42, s32, 7
    s_waitcnt lgkmcnt(8)
    v_mfma_f32_32x32x16_bf16 v[72:87], v[136:139], a[168:171], v[72:87]
    ds_read_b64_tr_b16 v[132:133], v14 offset:12288
    ds_read_b64_tr_b16 v[134:135], v14 offset:12544
    s_sub_u32 s30, s30, s42
    s_mul_i32 s26, s3, 1835008
    s_lshl_b32 s42, s32, 7
    s_add_u32 s26, s26, s42
    s_waitcnt lgkmcnt(8)
    v_mfma_f32_32x32x16_bf16 v[72:87], v[140:143], a[172:175], v[72:87]
    ds_read_b64_tr_b16 v[136:137], v15 offset:12288
    ds_read_b64_tr_b16 v[138:139], v15 offset:12544
    s_lshl_b32 s30, s30, 1
    s_add_u32 s30, s30, s10
    s_lshl_b32 s32, s32, 1
    s_add_u32 s32, s32, s11
    s_waitcnt lgkmcnt(8)
    v_mfma_f32_32x32x16_bf16 v[72:87], v[120:123], a[180:183], v[72:87]
    ds_read_b64_tr_b16 v[140:141], v13 offset:12288
    ds_read_b64_tr_b16 v[142:143], v13 offset:12544
    s_and_b32 s42, s24, 1
    s_sub_u32 s42, 25, s42
    s_cmp_lt_u32 s25, s42
    s_cselect_b32 s50, s14, 0
    s_waitcnt lgkmcnt(8)
    v_mfma_f32_32x32x16_bf16 v[72:87], v[124:127], a[184:187], v[72:87]
    ds_read_b64_tr_b16 v[120:121], v14 offset:16384
    ds_read_b64_tr_b16 v[122:123], v14 offset:16640
    s_cselect_b32 s51, 0xf00000, 0
    s_mul_i32 s43, s28, 28672
    s_lshl_b32 s42, s29, 6
    s_add_u32 s43, s43, s42
    s_waitcnt lgkmcnt(8)
    v_mfma_f32_32x32x16_bf16 v[72:87], v[128:131], a[188:191], v[72:87]
    ds_read_b64_tr_b16 v[124:125], v15 offset:16384
    ds_read_b64_tr_b16 v[126:127], v15 offset:16640
    s_lshl_b32 s36, s32, 1
    s_add_u32 s36, s36, s10
    s_lshl_b32 s36, s36, 5
    s_lshl_b32 s37, s28, 6
    s_waitcnt lgkmcnt(8)
    v_mfma_f32_32x32x16_bf16 v[72:87], v[132:135], a[196:199], v[72:87]
    ds_read_b64_tr_b16 v[128:129], v13 offset:16384
    ds_read_b64_tr_b16 v[130:131], v13 offset:16640
    s_mul_i32 s31, s3, 14336
    s_add_u32 s31, s31, 49152
    s_add_u32 s54, s26, 1835008
    s_add_u32 s55, s27, 1835008
    s_waitcnt lgkmcnt(8)
    v_mfma_f32_32x32x16_bf16 v[72:87], v[136:139], a[200:203], v[72:87]
    ds_read_b64_tr_b16 v[132:133], v14 offset:20480
    ds_read_b64_tr_b16 v[134:135], v14 offset:20736
    s_and_b32 s53, s24, 3
    s_mul_i32 s42, s53, 458752
    s_add_u32 s26, s26, s42
    s_mul_i32 s42, s53, 458752
    s_waitcnt lgkmcnt(8)
    v_mfma_f32_32x32x16_bf16 v[72:87], v[140:143], a[204:207], v[72:87]
    ds_read_b64_tr_b16 v[136:137], v15 offset:20480
    ds_read_b64_tr_b16 v[138:139], v15 offset:20736
    s_add_u32 s27, s27, s42
    buffer_load_dwordx2 v[232:233], v166, s[96:99], s36 offen offset:0
    buffer_load_dwordx2 v[234:235], v166, s[96:99], s36 offen offset:16
    s_mov_b64 s[96:97], s[58:59]
    s_waitcnt lgkmcnt(8)
    v_mfma_f32_32x32x16_bf16 v[72:87], v[120:123], a[212:215], v[72:87]
    ds_read_b64_tr_b16 v[140:141], v13 offset:20480
    ds_read_b64_tr_b16 v[142:143], v13 offset:20736
    s_movk_i32 s98, 0x1000
    buffer_load_ushort v231, v167, s[96:99], s37 offen
    buffer_load_dwordx4 v[168:171], v165, s[16:19], s43 offen
    buffer_load_dwordx4 v[172:175], v165, s[16:19], s43 offen offset:32
    s_waitcnt lgkmcnt(8)
    v_mfma_f32_32x32x16_bf16 v[72:87], v[124:127], a[216:219], v[72:87]
    ds_read_b64_tr_b16 v[120:121], v14 offset:24576
    ds_read_b64_tr_b16 v[122:123], v14 offset:24832
    s_mov_b64 s[96:97], s[8:9]
    s_mov_b32 s98, s51
    s_mov_b64 s[16:17], s[56:57]
    s_mov_b32 s18, 0x700000
    s_waitcnt lgkmcnt(8)
    v_mfma_f32_32x32x16_bf16 v[72:87], v[128:131], a[220:223], v[72:87]
    ds_read_b64_tr_b16 v[124:125], v15 offset:24576
    ds_read_b64_tr_b16 v[126:127], v15 offset:24832
    s_mul_i32 s42, s25, 7
    s_and_b32 s52, s24, 3
    s_lshl_b32 s52, s52, 7
    s_add_u32 s52, s52, s42
    s_waitcnt lgkmcnt(8)
    v_mfma_f32_32x32x16_bf16 v[72:87], v[132:135], a[228:231], v[72:87]
    ds_read_b64_tr_b16 v[128:129], v13 offset:24576
    ds_read_b64_tr_b16 v[130:131], v13 offset:24832
    s_add_u32 s52, s52, 288
    v_lshrrev_b32 v209, 2, v1
    v_min_u32 v209, 6, v209
    v_add_u32 v209, s52, v209
    s_waitcnt lgkmcnt(8)
    v_mfma_f32_32x32x16_bf16 v[72:87], v[136:139], a[232:235], v[72:87]
    v_and_b32 v209, 0x1ff, v209
    v_mul_u32_u24 v209, 3584, v209
    v_and_b32 v184, 3, v1
    v_lshl_add_u32 v209, v184, 7, v209
    s_waitcnt lgkmcnt(6)
    v_mfma_f32_32x32x16_bf16 v[72:87], v[140:143], a[236:239], v[72:87]
    s_mul_i32 s52, s3, 1835008
    s_mul_i32 s42, s24, 7
    s_lshr_b32 s42, s42, 1
    s_lshl_b32 s42, s42, 7
    s_waitcnt lgkmcnt(4)
    v_mfma_f32_32x32x16_bf16 v[72:87], v[120:123], a[244:247], v[72:87]
    s_add_u32 s52, s52, s42
    s_mul_i32 s42, s25, 9
    s_and_b32 s41, s24, 3
    s_lshl_b32 s41, s41, 7
    s_waitcnt lgkmcnt(2)
    v_mfma_f32_32x32x16_bf16 v[72:87], v[124:127], a[248:251], v[72:87]
    s_add_u32 s41, s41, s42
    s_add_u32 s41, s41, 0
    v_lshrrev_b32 v4, 2, v1
    v_min_u32 v4, 8, v4
    s_waitcnt lgkmcnt(0)
    v_mfma_f32_32x32x16_bf16 v[72:87], v[128:131], a[252:255], v[72:87]
    v_add_u32 v4, s41, v4
    v_and_b32 v4, 0x1ff, v4
    v_mul_u32_u24 v4, 3584, v4
    v_and_b32 v184, 3, v1
    v_mfma_f32_32x32x16_bf16 v[72:87], v[36:39], v[32:35], v[72:87]
    v_mul_f32 v19, 0x3e8b97f6, v18
    s_nop 10
    v_pk_mul_f32 v[72:73], v[72:73], v[18:19] op_sel:[0,1] op_sel_hi:[1,1]
    v_pk_mul_f32 v[74:75], v[74:75], v[18:19] op_sel:[0,1] op_sel_hi:[1,1]
    v_pk_mul_f32 v[76:77], v[76:77], v[18:19] op_sel:[0,1] op_sel_hi:[1,1]
    v_pk_mul_f32 v[78:79], v[78:79], v[18:19] op_sel:[0,1] op_sel_hi:[1,1]
    v_pk_mul_f32 v[80:81], v[80:81], v[18:19] op_sel:[0,1] op_sel_hi:[1,1]
    v_pk_mul_f32 v[82:83], v[82:83], v[18:19] op_sel:[0,1] op_sel_hi:[1,1]
    v_pk_mul_f32 v[84:85], v[84:85], v[18:19] op_sel:[0,1] op_sel_hi:[1,1]
    v_pk_mul_f32 v[86:87], v[86:87], v[18:19] op_sel:[0,1] op_sel_hi:[1,1]
    v_cvt_pk_bf16_f32 v8, v72, v73
    v_cvt_pk_bf16_f32 v9, v74, v75
    v_cvt_pk_bf16_f32 v10, v76, v77
    v_cvt_pk_bf16_f32 v11, v78, v79
    v_cvt_pk_bf16_f32 v12, v80, v81
    v_cvt_pk_bf16_f32 v13, v82, v83
    v_cvt_pk_bf16_f32 v14, v84, v85
    v_cvt_pk_bf16_f32 v15, v86, v87
    s_mov_b32 exec_lo, 0
    v_mov_b32 v14, 0
    v_mov_b32 v15, 0
    s_mov_b32 exec_lo, -1
    ds_write_b128 v117, v[8:11]
    ds_write_b128 v117, v[12:15] offset:1024
    s_waitcnt lgkmcnt(0)
    s_barrier
    s_xor_b32 s33, s3, 3
    s_lshl_b32 s33, s33, 11
    s_add_u32 s33, s33, 135424
    v_add_u32 v117, s33, v2
    ds_read_b128 v[32:35], v117
    ds_read_b128 v[36:39], v117 offset:1024
    s_xor_b32 s33, s3, 2
    s_lshl_b32 s33, s33, 11
    s_add_u32 s33, s33, 135424
    v_add_u32 v117, s33, v2
    ds_read_b128 v[24:27], v117
    ds_read_b128 v[28:31], v117 offset:1024
    s_xor_b32 s33, s3, 1
    s_lshl_b32 s33, s33, 11
    s_add_u32 s33, s33, 135424
    v_add_u32 v117, s33, v2
    ds_read_b128 v[16:19], v117
    ds_read_b128 v[20:23], v117 offset:1024
    s_mov_b32 s33, 1048576
    buffer_load_dwordx2 v[192:193], v188, s[20:23], s47 offen sc1
Lm_p0:
    s_waitcnt vmcnt(0)
    v_cmp_ne_u64 vcc, v[192:193], v[190:191]
    s_nop 4
    s_cbranch_vccz Lm_p0e
    buffer_load_dwordx2 v[192:193], v188, s[20:23], s47 offen sc1
    s_sub_u32 s33, s33, 1
    s_cbranch_scc0 Lm_p0
Lm_p0e:
    buffer_load_dwordx4 a[0:3], v2, s[20:23], s38 offen offset:0 sc1
    buffer_load_dwordx4 a[4:7], v2, s[20:23], s38 offen offset:1024 sc1
    buffer_load_dwordx4 a[8:11], v2, s[20:23], s38 offen offset:2048 sc1
    buffer_load_dwordx4 a[12:15], v2, s[20:23], s38 offen offset:3072 sc1
    s_add_u32 s38, s38, 4096
    buffer_load_dwordx4 a[16:19], v2, s[20:23], s38 offen offset:0 sc1
    buffer_load_dwordx4 a[20:23], v2, s[20:23], s38 offen offset:1024 sc1
    buffer_load_dwordx4 a[24:27], v2, s[20:23], s38 offen offset:2048 sc1
    buffer_load_dwordx4 a[28:31], v2, s[20:23], s38 offen offset:3072 sc1
    s_add_u32 s38, s38, 4096
    buffer_load_dwordx4 a[32:35], v2, s[20:23], s38 offen offset:0 sc1
    buffer_load_dwordx4 a[36:39], v2, s[20:23], s38 offen offset:1024 sc1
    buffer_load_dwordx4 a[40:43], v2, s[20:23], s38 offen offset:2048 sc1
    buffer_load_dwordx4 a[44:47], v2, s[20:23], s38 offen offset:3072 sc1
    s_add_u32 s38, s38, 4096
    v_lshl_add_u32 v4, v184, 7, v4
    s_mul_i32 s41, s3, 1835008
    s_mul_i32 s42, s24, 7
    s_lshr_b32 s42, s42, 1
    s_lshl_b32 s42, s42, 7
    s_add_u32 s41, s41, s42
    v_lshlrev_b32 v5, 24, v1
    v_mov_b32 v196, -1
    v_mov_b32 v197, -1
    v_mov_b32 v198, -1
    v_mov_b32 v199, -1
    s_mul_i32 s42, s3, 12288
    v_add_u32 v3, s42, v2
    s_xor_b32 s42, s3, 1
    s_mul_i32 s42, s42, 12288
    s_add_u32 s42, s42, 0
    v_add_u32 v153, s42, v2
    s_xor_b32 s42, s3, 2
    s_mul_i32 s42, s42, 12288
    s_add_u32 s42, s42, 4096
    v_add_u32 v154, s42, v2
    s_xor_b32 s42, s3, 3
    s_mul_i32 s42, s42, 12288
    s_add_u32 s42, s42, 8192
    v_add_u32 v155, s42, v2
    v_lshrrev_b32 v184, 3, v1
    v_mul_u32_u24 v156, 896, v184
    v_bfe_u32 v184, v1, 4, 1
    v_lshlrev_b32 v184, 2, v184
    v_and_b32 v185, 7, v1
    v_xor_b32 v184, v184, v185
    v_lshl_add_u32 v156, v184, 4, v156
    v_lshrrev_b32 v184, 3, v1
    v_mul_u32_u24 v157, 3584, v184
    v_bfe_u32 v184, v1, 4, 1
    v_lshlrev_b32 v184, 2, v184
    v_and_b32 v185, 7, v1
    v_xor_b32 v184, v184, v185
    v_lshl_add_u32 v157, v184, 4, v157
    v_add_u32 v158, 27648, v157
    v_lshrrev_b32 v184, 3, v1
    v_mul_u32_u24 v159, 4096, v184
    v_bfe_u32 v184, v1, 4, 1
    v_lshlrev_b32 v184, 2, v184
    v_and_b32 v185, 7, v1
    v_xor_b32 v184, v184, v185
    v_lshl_add_u32 v159, v184, 4, v159
    v_add_u32 v160, 31744, v159
    v_add_u32 v204, 55296, v157
    v_add_u32 v205, 55296, v158
    v_add_u32 v206, 6144, v156
    v_add_u32 v207, 12288, v156
    v_add_u32 v208, 18432, v156
    v_lshrrev_b32 v184, 5, v1
    v_bfe_u32 v185, v1, 2, 2
    v_lshl_add_u32 v184, v184, 2, v185
    v_lshlrev_b32 v162, 7, v184
    v_bfe_u32 v184, v1, 3, 1
    v_lshl_add_u32 v162, v184, 6, v162
    v_bfe_u32 v184, v1, 4, 1
    v_lshl_add_u32 v162, v184, 5, v162
    v_and_b32 v184, 3, v1
    v_lshl_add_u32 v162, v184, 3, v162
    s_lshl_b32 s42, s11, 6
    v_xor_b32 v161, s42, v162
    v_add_u32 v161, 106496, v161
    s_lshl_b32 s42, s3, 5
    v_xor_b32 v186, s42, v162
    v_add_u32 v186, s31, v186
    v_xor_b32 v187, 64, v186
    v_and_b32 v195, 15, v1
    v_lshlrev_b32 v195, 11, v195
    s_lshl_b32 s46, s28, 15
    s_add_u32 s46, s46, 0x600000
    v_and_b32 v184, 31, v1
    v_sub_u32 v184, v184, v166
    v_mov_b32 v185, 0x3f80
    v_mov_b32 v7, 0x3f800000
    v_cmp_eq_u32 vcc, 0, v184
    s_nop 1
    v_cndmask_b32 v176, 0, v185, vcc
    v_cmp_eq_u32 vcc, 1, v184
    s_nop 1
    v_cndmask_b32 v176, v176, v7, vcc
    v_cmp_eq_u32 vcc, 2, v184
    s_nop 1
    v_cndmask_b32 v177, 0, v185, vcc
    v_cmp_eq_u32 vcc, 3, v184
    s_nop 1
    v_cndmask_b32 v177, v177, v7, vcc
    v_cmp_eq_u32 vcc, 4, v184
    s_nop 1
    v_cndmask_b32 v178, 0, v185, vcc
    v_cmp_eq_u32 vcc, 5, v184
    s_nop 1
    v_cndmask_b32 v178, v178, v7, vcc
    v_cmp_eq_u32 vcc, 6, v184
    s_nop 1
    v_cndmask_b32 v179, 0, v185, vcc
    v_cmp_eq_u32 vcc, 7, v184
    s_nop 1
    v_cndmask_b32 v179, v179, v7, vcc
    v_cmp_eq_u32 vcc, 16, v184
    s_nop 1
    v_cndmask_b32 v180, 0, v185, vcc
    v_cmp_eq_u32 vcc, 17, v184
    s_nop 1
    v_cndmask_b32 v180, v180, v7, vcc
    v_cmp_eq_u32 vcc, 18, v184
    s_nop 1
    v_cndmask_b32 v181, 0, v185, vcc
    v_cmp_eq_u32 vcc, 19, v184
    s_nop 1
    v_cndmask_b32 v181, v181, v7, vcc
    v_cmp_eq_u32 vcc, 20, v184
    s_nop 1
    v_cndmask_b32 v182, 0, v185, vcc
    v_cmp_eq_u32 vcc, 21, v184
    s_nop 1
    v_cndmask_b32 v182, v182, v7, vcc
    v_cmp_eq_u32 vcc, 22, v184
    s_nop 1
    v_cndmask_b32 v183, 0, v185, vcc
    v_cmp_eq_u32 vcc, 23, v184
    s_nop 1
    v_cndmask_b32 v183, v183, v7, vcc
    s_waitcnt vmcnt(10) lgkmcnt(0)
    v_mfma_f32_32x32x16_bf16 v[104:119], a[0:3], v[32:35], 0
    v_mfma_f32_32x32x16_bf16 v[104:119], a[4:7], v[36:39], v[104:119]
    s_waitcnt vmcnt(8)
    v_mfma_f32_32x32x16_bf16 v[120:135], a[0:3], v[24:27], 0
    buffer_load_dwordx4 a[48:51], v2, s[20:23], s38 offen offset:0 sc1
    s_nop 8
    v_exp_f32 v136, v104
    v_exp_f32 v137, v105
    v_exp_f32 v138, v106
    v_cvt_pk_bf16_f32 v144, v136, v137
    v_exp_f32 v139, v107
    buffer_load_dwordx4 a[52:55], v2, s[20:23], s38 offen offset:1024 sc1
    v_exp_f32 v140, v108
    v_exp_f32 v141, v109
    v_cvt_pk_bf16_f32 v145, v138, v139
    v_exp_f32 v142, v110
    v_cvt_pk_bf16_f32 v146, v140, v141
    v_exp_f32 v143, v111
    v_mfma_f32_32x32x16_bf16 v[120:135], a[4:7], v[28:31], v[120:135]
    buffer_load_dwordx4 a[56:59], v2, s[20:23], s38 offen offset:2048 sc1
    v_exp_f32 v136, v112
    v_exp_f32 v137, v113
    v_cvt_pk_bf16_f32 v147, v142, v143
    v_exp_f32 v138, v114
    v_cvt_pk_bf16_f32 v148, v136, v137
    v_exp_f32 v139, v115
    v_mfma_f32_32x32x16_bf16 v[88:103], a[8:11], v[144:147], 0
    s_waitcnt vmcnt(7)
    v_exp_f32 v140, v116
    v_exp_f32 v141, v117
    v_cvt_pk_bf16_f32 v149, v138, v139
    v_exp_f32 v142, v118
    v_cvt_pk_bf16_f32 v150, v140, v141
    v_exp_f32 v143, v119
    v_mfma_f32_32x32x16_bf16 v[104:119], a[16:19], v[32:35], 0
    buffer_load_dwordx4 a[60:63], v2, s[20:23], s38 offen offset:3072 sc1
    v_exp_f32 v136, v120
    v_exp_f32 v137, v121
    v_cvt_pk_bf16_f32 v151, v142, v143
    v_exp_f32 v138, v122
    v_cvt_pk_bf16_f32 v144, v136, v137
    v_exp_f32 v139, v123
    v_mfma_f32_32x32x16_bf16 v[88:103], a[12:15], v[148:151], v[88:103]
    s_add_u32 s38, s38, 4096
    v_exp_f32 v140, v124
    v_exp_f32 v141, v125
    v_cvt_pk_bf16_f32 v145, v138, v139
    v_exp_f32 v142, v126
    v_cvt_pk_bf16_f32 v146, v140, v141
    v_exp_f32 v143, v127
    v_mfma_f32_32x32x16_bf16 v[104:119], a[20:23], v[36:39], v[104:119]
    v_exp_f32 v136, v128
    v_exp_f32 v137, v129
    v_cvt_pk_bf16_f32 v147, v142, v143
    v_exp_f32 v138, v130
    v_cvt_pk_bf16_f32 v148, v136, v137
    v_exp_f32 v139, v131
    v_mfma_f32_32x32x16_bf16 v[72:87], a[8:11], v[144:147], 0
    v_exp_f32 v140, v132
    v_exp_f32 v141, v133
    v_cvt_pk_bf16_f32 v149, v138, v139
    v_exp_f32 v142, v134
    v_cvt_pk_bf16_f32 v150, v140, v141
    v_exp_f32 v143, v135
    v_mfma_f32_32x32x16_bf16 v[120:135], a[16:19], v[24:27], 0
    buffer_load_dwordx4 a[64:67], v2, s[20:23], s38 offen offset:0 sc1
    v_exp_f32 v136, v104
    v_exp_f32 v137, v105
    v_cvt_pk_bf16_f32 v151, v142, v143
    v_exp_f32 v138, v106
    v_cvt_pk_bf16_f32 v144, v136, v137
    v_exp_f32 v139, v107
    v_mfma_f32_32x32x16_bf16 v[72:87], a[12:15], v[148:151], v[72:87]
    buffer_load_dwordx4 a[68:71], v2, s[20:23], s38 offen offset:1024 sc1
    v_exp_f32 v140, v108
    v_exp_f32 v141, v109
    v_cvt_pk_bf16_f32 v145, v138, v139
    v_exp_f32 v142, v110
    v_cvt_pk_bf16_f32 v146, v140, v141
    v_exp_f32 v143, v111
    v_mfma_f32_32x32x16_bf16 v[120:135], a[20:23], v[28:31], v[120:135]
    buffer_load_dwordx4 a[72:75], v2, s[20:23], s38 offen offset:2048 sc1
    v_exp_f32 v136, v112
    v_exp_f32 v137, v113
    v_cvt_pk_bf16_f32 v147, v142, v143
    v_exp_f32 v138, v114
    v_cvt_pk_bf16_f32 v148, v136, v137
    v_exp_f32 v139, v115
    v_mfma_f32_32x32x16_bf16 v[88:103], a[24:27], v[144:147], v[88:103]
    s_waitcnt vmcnt(7)
    v_exp_f32 v140, v116
    v_exp_f32 v141, v117
    v_cvt_pk_bf16_f32 v149, v138, v139
    v_exp_f32 v142, v118
    v_cvt_pk_bf16_f32 v150, v140, v141
    v_exp_f32 v143, v119
    v_mfma_f32_32x32x16_bf16 v[104:119], a[32:35], v[32:35], 0
    buffer_load_dwordx4 a[76:79], v2, s[20:23], s38 offen offset:3072 sc1
    v_exp_f32 v136, v120
    v_exp_f32 v137, v121
    v_cvt_pk_bf16_f32 v151, v142, v143
    v_exp_f32 v138, v122
    v_cvt_pk_bf16_f32 v144, v136, v137
    v_exp_f32 v139, v123
    v_mfma_f32_32x32x16_bf16 v[88:103], a[28:31], v[148:151], v[88:103]
    s_add_u32 s38, s38, 4096
    v_exp_f32 v140, v124
    v_exp_f32 v141, v125
    v_cvt_pk_bf16_f32 v145, v138, v139
    v_exp_f32 v142, v126
    v_cvt_pk_bf16_f32 v146, v140, v141
    v_exp_f32 v143, v127
    v_mfma_f32_32x32x16_bf16 v[104:119], a[36:39], v[36:39], v[104:119]
    v_exp_f32 v136, v128
    v_exp_f32 v137, v129
    v_cvt_pk_bf16_f32 v147, v142, v143
    v_exp_f32 v138, v130
    v_cvt_pk_bf16_f32 v148, v136, v137
    v_exp_f32 v139, v131
    v_mfma_f32_32x32x16_bf16 v[72:87], a[24:27], v[144:147], v[72:87]
    v_exp_f32 v140, v132
    v_exp_f32 v141, v133
    v_cvt_pk_bf16_f32 v149, v138, v139
    v_exp_f32 v142, v134
    v_cvt_pk_bf16_f32 v150, v140, v141
    v_exp_f32 v143, v135
    v_mfma_f32_32x32x16_bf16 v[120:135], a[32:35], v[24:27], 0
    buffer_load_dwordx4 a[80:83], v2, s[20:23], s38 offen offset:0 sc1
    v_exp_f32 v136, v104
    v_exp_f32 v137, v105
    v_cvt_pk_bf16_f32 v151, v142, v143
    v_exp_f32 v138, v106
    v_cvt_pk_bf16_f32 v144, v136, v137
    v_exp_f32 v139, v107
    v_mfma_f32_32x32x16_bf16 v[72:87], a[28:31], v[148:151], v[72:87]
    buffer_load_dwordx4 a[84:87], v2, s[20:23], s38 offen offset:1024 sc1
    v_exp_f32 v140, v108
    v_exp_f32 v141, v109
    v_cvt_pk_bf16_f32 v145, v138, v139
    v_exp_f32 v142, v110
    v_cvt_pk_bf16_f32 v146, v140, v141
    v_exp_f32 v143, v111
    v_mfma_f32_32x32x16_bf16 v[120:135], a[36:39], v[28:31], v[120:135]
    buffer_load_dwordx4 a[88:91], v2, s[20:23], s38 offen offset:2048 sc1
    v_exp_f32 v136, v112
    v_exp_f32 v137, v113
    v_cvt_pk_bf16_f32 v147, v142, v143
    v_exp_f32 v138, v114
    v_cvt_pk_bf16_f32 v148, v136, v137
    v_exp_f32 v139, v115
    v_mfma_f32_32x32x16_bf16 v[88:103], a[40:43], v[144:147], v[88:103]
    s_waitcnt vmcnt(7)
    v_exp_f32 v140, v116
    v_exp_f32 v141, v117
    v_cvt_pk_bf16_f32 v149, v138, v139
    v_exp_f32 v142, v118
    v_cvt_pk_bf16_f32 v150, v140, v141
    v_exp_f32 v143, v119
    v_mfma_f32_32x32x16_bf16 v[104:119], a[48:51], v[32:35], 0
    buffer_load_dwordx4 a[92:95], v2, s[20:23], s38 offen offset:3072 sc1
    v_exp_f32 v136, v120
    v_exp_f32 v137, v121
    v_cvt_pk_bf16_f32 v151, v142, v143
    v_exp_f32 v138, v122
    v_cvt_pk_bf16_f32 v144, v136, v137
    v_exp_f32 v139, v123
    v_mfma_f32_32x32x16_bf16 v[88:103], a[44:47], v[148:151], v[88:103]
    s_add_u32 s38, s38, 4096
    v_exp_f32 v140, v124
    v_exp_f32 v141, v125
    v_cvt_pk_bf16_f32 v145, v138, v139
    v_exp_f32 v142, v126
    v_cvt_pk_bf16_f32 v146, v140, v141
    v_exp_f32 v143, v127
    v_mfma_f32_32x32x16_bf16 v[104:119], a[52:55], v[36:39], v[104:119]
    v_exp_f32 v136, v128
    v_exp_f32 v137, v129
    v_cvt_pk_bf16_f32 v147, v142, v143
    v_exp_f32 v138, v130
    v_cvt_pk_bf16_f32 v148, v136, v137
    v_exp_f32 v139, v131
    v_mfma_f32_32x32x16_bf16 v[72:87], a[40:43], v[144:147], v[72:87]
    v_exp_f32 v140, v132
    v_exp_f32 v141, v133
    v_cvt_pk_bf16_f32 v149, v138, v139
    v_exp_f32 v142, v134
    v_cvt_pk_bf16_f32 v150, v140, v141
    v_exp_f32 v143, v135
    v_mfma_f32_32x32x16_bf16 v[120:135], a[48:51], v[24:27], 0
    buffer_load_dwordx4 a[96:99], v2, s[20:23], s38 offen offset:0 sc1
    v_exp_f32 v136, v104
    v_exp_f32 v137, v105
    v_cvt_pk_bf16_f32 v151, v142, v143
    v_exp_f32 v138, v106
    v_cvt_pk_bf16_f32 v144, v136, v137
    v_exp_f32 v139, v107
    v_mfma_f32_32x32x16_bf16 v[72:87], a[44:47], v[148:151], v[72:87]
    buffer_load_dwordx4 a[100:103], v2, s[20:23], s38 offen offset:1024 sc1
    v_exp_f32 v140, v108
    v_exp_f32 v141, v109
    v_cvt_pk_bf16_f32 v145, v138, v139
    v_exp_f32 v142, v110
    v_cvt_pk_bf16_f32 v146, v140, v141
    v_exp_f32 v143, v111
    v_mfma_f32_32x32x16_bf16 v[120:135], a[52:55], v[28:31], v[120:135]
    buffer_load_dwordx4 a[104:107], v2, s[20:23], s38 offen offset:2048 sc1
    v_exp_f32 v136, v112
    v_exp_f32 v137, v113
    v_cvt_pk_bf16_f32 v147, v142, v143
    v_exp_f32 v138, v114
    v_cvt_pk_bf16_f32 v148, v136, v137
    v_exp_f32 v139, v115
    v_mfma_f32_32x32x16_bf16 v[88:103], a[56:59], v[144:147], v[88:103]
    s_waitcnt vmcnt(7)
    v_exp_f32 v140, v116
    v_exp_f32 v141, v117
    v_cvt_pk_bf16_f32 v149, v138, v139
    v_exp_f32 v142, v118
    v_cvt_pk_bf16_f32 v150, v140, v141
    v_exp_f32 v143, v119
    v_mfma_f32_32x32x16_bf16 v[104:119], a[64:67], v[32:35], 0
    buffer_load_dwordx4 a[108:111], v2, s[20:23], s38 offen offset:3072 sc1
    v_exp_f32 v136, v120
    v_exp_f32 v137, v121
    v_cvt_pk_bf16_f32 v151, v142, v143
    v_exp_f32 v138, v122
    v_cvt_pk_bf16_f32 v144, v136, v137
    v_exp_f32 v139, v123
    v_mfma_f32_32x32x16_bf16 v[88:103], a[60:63], v[148:151], v[88:103]
    s_add_u32 s38, s38, 4096
    v_exp_f32 v140, v124
    v_exp_f32 v141, v125
    v_cvt_pk_bf16_f32 v145, v138, v139
    v_exp_f32 v142, v126
    v_cvt_pk_bf16_f32 v146, v140, v141
    v_exp_f32 v143, v127
    v_mfma_f32_32x32x16_bf16 v[104:119], a[68:71], v[36:39], v[104:119]
    v_exp_f32 v136, v128
    v_exp_f32 v137, v129
    v_cvt_pk_bf16_f32 v147, v142, v143
    v_exp_f32 v138, v130
    v_cvt_pk_bf16_f32 v148, v136, v137
    v_exp_f32 v139, v131
    v_mfma_f32_32x32x16_bf16 v[72:87], a[56:59], v[144:147], v[72:87]
    v_exp_f32 v140, v132
    v_exp_f32 v141, v133
    v_cvt_pk_bf16_f32 v149, v138, v139
    v_exp_f32 v142, v134
    v_cvt_pk_bf16_f32 v150, v140, v141
    v_exp_f32 v143, v135
    v_mfma_f32_32x32x16_bf16 v[120:135], a[64:67], v[24:27], 0
    buffer_load_dwordx4 a[112:115], v2, s[20:23], s38 offen offset:0 sc1
    v_exp_f32 v136, v104
    v_exp_f32 v137, v105
    v_cvt_pk_bf16_f32 v151, v142, v143
    v_exp_f32 v138, v106
    v_cvt_pk_bf16_f32 v144, v136, v137
    v_exp_f32 v139, v107
    v_mfma_f32_32x32x16_bf16 v[72:87], a[60:63], v[148:151], v[72:87]
    buffer_load_dwordx4 a[116:119], v2, s[20:23], s38 offen offset:1024 sc1
    v_exp_f32 v140, v108
    v_exp_f32 v141, v109
    v_cvt_pk_bf16_f32 v145, v138, v139
    v_exp_f32 v142, v110
    v_cvt_pk_bf16_f32 v146, v140, v141
    v_exp_f32 v143, v111
    v_mfma_f32_32x32x16_bf16 v[120:135], a[68:71], v[28:31], v[120:135]
    buffer_load_dwordx4 a[120:123], v2, s[20:23], s38 offen offset:2048 sc1
    v_exp_f32 v136, v112
    v_exp_f32 v137, v113
    v_cvt_pk_bf16_f32 v147, v142, v143
    v_exp_f32 v138, v114
    v_cvt_pk_bf16_f32 v148, v136, v137
    v_exp_f32 v139, v115
    v_mfma_f32_32x32x16_bf16 v[88:103], a[72:75], v[144:147], v[88:103]
    s_waitcnt vmcnt(7)
    v_exp_f32 v140, v116
    v_exp_f32 v141, v117
    v_cvt_pk_bf16_f32 v149, v138, v139
    v_exp_f32 v142, v118
    v_cvt_pk_bf16_f32 v150, v140, v141
    v_exp_f32 v143, v119
    v_mfma_f32_32x32x16_bf16 v[104:119], a[80:83], v[32:35], 0
    buffer_load_dwordx4 a[124:127], v2, s[20:23], s38 offen offset:3072 sc1
    v_exp_f32 v136, v120
    v_exp_f32 v137, v121
    v_cvt_pk_bf16_f32 v151, v142, v143
    v_exp_f32 v138, v122
    v_cvt_pk_bf16_f32 v144, v136, v137
    v_exp_f32 v139, v123
    v_mfma_f32_32x32x16_bf16 v[88:103], a[76:79], v[148:151], v[88:103]
    s_add_u32 s38, s38, 4096
    v_exp_f32 v140, v124
    v_exp_f32 v141, v125
    v_cvt_pk_bf16_f32 v145, v138, v139
    v_exp_f32 v142, v126
    v_cvt_pk_bf16_f32 v146, v140, v141
    v_exp_f32 v143, v127
    v_mfma_f32_32x32x16_bf16 v[104:119], a[84:87], v[36:39], v[104:119]
    v_exp_f32 v136, v128
    v_exp_f32 v137, v129
    v_cvt_pk_bf16_f32 v147, v142, v143
    v_exp_f32 v138, v130
    v_cvt_pk_bf16_f32 v148, v136, v137
    v_exp_f32 v139, v131
    v_mfma_f32_32x32x16_bf16 v[72:87], a[72:75], v[144:147], v[72:87]
    v_exp_f32 v140, v132
    v_exp_f32 v141, v133
    v_cvt_pk_bf16_f32 v149, v138, v139
    v_exp_f32 v142, v134
    v_cvt_pk_bf16_f32 v150, v140, v141
    v_exp_f32 v143, v135
    v_mfma_f32_32x32x16_bf16 v[120:135], a[80:83], v[24:27], 0
    buffer_load_dwordx4 a[128:131], v2, s[20:23], s38 offen offset:0 sc1
    v_exp_f32 v136, v104
    v_exp_f32 v137, v105
    v_cvt_pk_bf16_f32 v151, v142, v143
    v_exp_f32 v138, v106
    v_cvt_pk_bf16_f32 v144, v136, v137
    v_exp_f32 v139, v107
    v_mfma_f32_32x32x16_bf16 v[72:87], a[76:79], v[148:151], v[72:87]
    buffer_load_dwordx4 a[132:135], v2, s[20:23], s38 offen offset:1024 sc1
    v_exp_f32 v140, v108
    v_exp_f32 v141, v109
    v_cvt_pk_bf16_f32 v145, v138, v139
    v_exp_f32 v142, v110
    v_cvt_pk_bf16_f32 v146, v140, v141
    v_exp_f32 v143, v111
    v_mfma_f32_32x32x16_bf16 v[120:135], a[84:87], v[28:31], v[120:135]
    buffer_load_dwordx4 a[136:139], v2, s[20:23], s38 offen offset:2048 sc1
    v_exp_f32 v136, v112
    v_exp_f32 v137, v113
    v_cvt_pk_bf16_f32 v147, v142, v143
    v_exp_f32 v138, v114
    v_cvt_pk_bf16_f32 v148, v136, v137
    v_exp_f32 v139, v115
    v_mfma_f32_32x32x16_bf16 v[88:103], a[88:91], v[144:147], v[88:103]
    s_waitcnt vmcnt(7)
    v_exp_f32 v140, v116
    v_exp_f32 v141, v117
    v_cvt_pk_bf16_f32 v149, v138, v139
    v_exp_f32 v142, v118
    v_cvt_pk_bf16_f32 v150, v140, v141
    v_exp_f32 v143, v119
    v_mfma_f32_32x32x16_bf16 v[104:119], a[96:99], v[32:35], 0
    buffer_load_dwordx4 a[140:143], v2, s[20:23], s38 offen offset:3072 sc1
    v_exp_f32 v136, v120
    v_exp_f32 v137, v121
    v_cvt_pk_bf16_f32 v151, v142, v143
    v_exp_f32 v138, v122
    v_cvt_pk_bf16_f32 v144, v136, v137
    v_exp_f32 v139, v123
    v_mfma_f32_32x32x16_bf16 v[88:103], a[92:95], v[148:151], v[88:103]
    s_add_u32 s38, s38, 4096
    v_exp_f32 v140, v124
    v_exp_f32 v141, v125
    v_cvt_pk_bf16_f32 v145, v138, v139
    v_exp_f32 v142, v126
    v_cvt_pk_bf16_f32 v146, v140, v141
    v_exp_f32 v143, v127
    v_mfma_f32_32x32x16_bf16 v[104:119], a[100:103], v[36:39], v[104:119]
    v_exp_f32 v136, v128
    v_exp_f32 v137, v129
    v_cvt_pk_bf16_f32 v147, v142, v143
    v_exp_f32 v138, v130
    v_cvt_pk_bf16_f32 v148, v136, v137
    v_exp_f32 v139, v131
    v_mfma_f32_32x32x16_bf16 v[72:87], a[88:91], v[144:147], v[72:87]
    v_exp_f32 v140, v132
    v_exp_f32 v141, v133
    v_cvt_pk_bf16_f32 v149, v138, v139
    v_exp_f32 v142, v134
    v_cvt_pk_bf16_f32 v150, v140, v141
    v_exp_f32 v143, v135
    v_mfma_f32_32x32x16_bf16 v[120:135], a[96:99], v[24:27], 0
    buffer_load_dwordx4 a[144:147], v2, s[20:23], s38 offen offset:0 sc1
    v_exp_f32 v136, v104
    v_exp_f32 v137, v105
    v_cvt_pk_bf16_f32 v151, v142, v143
    v_exp_f32 v138, v106
    v_cvt_pk_bf16_f32 v144, v136, v137
    v_exp_f32 v139, v107
    v_mfma_f32_32x32x16_bf16 v[72:87], a[92:95], v[148:151], v[72:87]
    buffer_load_dwordx4 a[148:151], v2, s[20:23], s38 offen offset:1024 sc1
    v_exp_f32 v140, v108
    v_exp_f32 v141, v109
    v_cvt_pk_bf16_f32 v145, v138, v139
    v_exp_f32 v142, v110
    v_cvt_pk_bf16_f32 v146, v140, v141
    v_exp_f32 v143, v111
    v_mfma_f32_32x32x16_bf16 v[120:135], a[100:103], v[28:31], v[120:135]
    buffer_load_dwordx4 a[152:155], v2, s[20:23], s38 offen offset:2048 sc1
    v_exp_f32 v136, v112
    v_exp_f32 v137, v113
    v_cvt_pk_bf16_f32 v147, v142, v143
    v_exp_f32 v138, v114
    v_cvt_pk_bf16_f32 v148, v136, v137
    v_exp_f32 v139, v115
    v_mfma_f32_32x32x16_bf16 v[88:103], a[104:107], v[144:147], v[88:103]
    s_waitcnt vmcnt(7)
    v_exp_f32 v140, v116
    v_exp_f32 v141, v117
    v_cvt_pk_bf16_f32 v149, v138, v139
    v_exp_f32 v142, v118
    v_cvt_pk_bf16_f32 v150, v140, v141
    v_exp_f32 v143, v119
    v_mfma_f32_32x32x16_bf16 v[104:119], a[112:115], v[32:35], 0
    buffer_load_dwordx4 a[156:159], v2, s[20:23], s38 offen offset:3072 sc1
    v_exp_f32 v136, v120
    v_exp_f32 v137, v121
    v_cvt_pk_bf16_f32 v151, v142, v143
    v_exp_f32 v138, v122
    v_cvt_pk_bf16_f32 v144, v136, v137
    v_exp_f32 v139, v123
    v_mfma_f32_32x32x16_bf16 v[88:103], a[108:111], v[148:151], v[88:103]
    s_add_u32 s38, s38, 4096
    v_exp_f32 v140, v124
    v_exp_f32 v141, v125
    v_cvt_pk_bf16_f32 v145, v138, v139
    v_exp_f32 v142, v126
    v_cvt_pk_bf16_f32 v146, v140, v141
    v_exp_f32 v143, v127
    v_mfma_f32_32x32x16_bf16 v[104:119], a[116:119], v[36:39], v[104:119]
    v_exp_f32 v136, v128
    v_exp_f32 v137, v129
    v_cvt_pk_bf16_f32 v147, v142, v143
    v_exp_f32 v138, v130
    v_cvt_pk_bf16_f32 v148, v136, v137
    v_exp_f32 v139, v131
    v_mfma_f32_32x32x16_bf16 v[72:87], a[104:107], v[144:147], v[72:87]
    v_exp_f32 v140, v132
    v_exp_f32 v141, v133
    v_cvt_pk_bf16_f32 v149, v138, v139
    v_exp_f32 v142, v134
    v_cvt_pk_bf16_f32 v150, v140, v141
    v_exp_f32 v143, v135
    v_mfma_f32_32x32x16_bf16 v[120:135], a[112:115], v[24:27], 0
    buffer_load_dwordx4 a[160:163], v2, s[20:23], s38 offen offset:0 sc1
    v_exp_f32 v136, v104
    v_exp_f32 v137, v105
    v_cvt_pk_bf16_f32 v151, v142, v143
    v_exp_f32 v138, v106
    v_cvt_pk_bf16_f32 v144, v136, v137
    v_exp_f32 v139, v107
    v_mfma_f32_32x32x16_bf16 v[72:87], a[108:111], v[148:151], v[72:87]
    buffer_load_dwordx4 a[164:167], v2, s[20:23], s38 offen offset:1024 sc1
    v_exp_f32 v140, v108
    v_exp_f32 v141, v109
    v_cvt_pk_bf16_f32 v145, v138, v139
    v_exp_f32 v142, v110
    v_cvt_pk_bf16_f32 v146, v140, v141
    v_exp_f32 v143, v111
    v_mfma_f32_32x32x16_bf16 v[120:135], a[116:119], v[28:31], v[120:135]
    buffer_load_dwordx4 a[168:171], v2, s[20:23], s38 offen offset:2048 sc1
    v_exp_f32 v136, v112
    v_exp_f32 v137, v113
    v_cvt_pk_bf16_f32 v147, v142, v143
    v_exp_f32 v138, v114
    v_cvt_pk_bf16_f32 v148, v136, v137
    v_exp_f32 v139, v115
    v_mfma_f32_32x32x16_bf16 v[88:103], a[120:123], v[144:147], v[88:103]
    s_waitcnt vmcnt(7)
    v_exp_f32 v140, v116
    v_exp_f32 v141, v117
    v_cvt_pk_bf16_f32 v149, v138, v139
    v_exp_f32 v142, v118
    v_cvt_pk_bf16_f32 v150, v140, v141
    v_exp_f32 v143, v119
    v_mfma_f32_32x32x16_bf16 v[104:119], a[128:131], v[32:35], 0
    buffer_load_dwordx4 a[172:175], v2, s[20:23], s38 offen offset:3072 sc1
    v_exp_f32 v136, v120
    v_exp_f32 v137, v121
    v_cvt_pk_bf16_f32 v151, v142, v143
    v_exp_f32 v138, v122
    v_cvt_pk_bf16_f32 v144, v136, v137
    v_exp_f32 v139, v123
    v_mfma_f32_32x32x16_bf16 v[88:103], a[124:127], v[148:151], v[88:103]
    s_add_u32 s38, s38, 4096
    v_exp_f32 v140, v124
    v_exp_f32 v141, v125
    v_cvt_pk_bf16_f32 v145, v138, v139
    v_exp_f32 v142, v126
    v_cvt_pk_bf16_f32 v146, v140, v141
    v_exp_f32 v143, v127
    v_mfma_f32_32x32x16_bf16 v[104:119], a[132:135], v[36:39], v[104:119]
    v_exp_f32 v136, v128
    v_exp_f32 v137, v129
    v_cvt_pk_bf16_f32 v147, v142, v143
    v_exp_f32 v138, v130
    v_cvt_pk_bf16_f32 v148, v136, v137
    v_exp_f32 v139, v131
    v_mfma_f32_32x32x16_bf16 v[72:87], a[120:123], v[144:147], v[72:87]
    v_exp_f32 v140, v132
    v_exp_f32 v141, v133
    v_cvt_pk_bf16_f32 v149, v138, v139
    v_exp_f32 v142, v134
    v_cvt_pk_bf16_f32 v150, v140, v141
    v_exp_f32 v143, v135
    v_mfma_f32_32x32x16_bf16 v[120:135], a[128:131], v[24:27], 0
    buffer_load_dwordx4 a[176:179], v2, s[20:23], s38 offen offset:0 sc1
    v_exp_f32 v136, v104
    v_exp_f32 v137, v105
    v_cvt_pk_bf16_f32 v151, v142, v143
    v_exp_f32 v138, v106
    v_cvt_pk_bf16_f32 v144, v136, v137
    v_exp_f32 v139, v107
    v_mfma_f32_32x32x16_bf16 v[72:87], a[124:127], v[148:151], v[72:87]
    buffer_load_dwordx4 a[180:183], v2, s[20:23], s38 offen offset:1024 sc1
    v_exp_f32 v140, v108
    v_exp_f32 v141, v109
    v_cvt_pk_bf16_f32 v145, v138, v139
    v_exp_f32 v142, v110
    v_cvt_pk_bf16_f32 v146, v140, v141
    v_exp_f32 v143, v111
    v_mfma_f32_32x32x16_bf16 v[120:135], a[132:135], v[28:31], v[120:135]
    buffer_load_dwordx4 a[184:187], v2, s[20:23], s38 offen offset:2048 sc1
    v_exp_f32 v136, v112
    v_exp_f32 v137, v113
    v_cvt_pk_bf16_f32 v147, v142, v143
    v_exp_f32 v138, v114
    v_cvt_pk_bf16_f32 v148, v136, v137
    v_exp_f32 v139, v115
    v_mfma_f32_32x32x16_bf16 v[88:103], a[136:139], v[144:147], v[88:103]
    s_waitcnt vmcnt(7)
    v_exp_f32 v140, v116
    v_exp_f32 v141, v117
    v_cvt_pk_bf16_f32 v149, v138, v139
    v_exp_f32 v142, v118
    v_cvt_pk_bf16_f32 v150, v140, v141
    v_exp_f32 v143, v119
    v_mfma_f32_32x32x16_bf16 v[104:119], a[144:147], v[32:35], 0
    buffer_load_dwordx4 a[188:191], v2, s[20:23], s38 offen offset:3072 sc1
    v_exp_f32 v136, v120
    v_exp_f32 v137, v121
    v_cvt_pk_bf16_f32 v151, v142, v143
    v_exp_f32 v138, v122
    v_cvt_pk_bf16_f32 v144, v136, v137
    v_exp_f32 v139, v123
    v_mfma_f32_32x32x16_bf16 v[88:103], a[140:143], v[148:151], v[88:103]
    s_add_u32 s38, s38, 4096
    v_exp_f32 v140, v124
    v_exp_f32 v141, v125
    v_cvt_pk_bf16_f32 v145, v138, v139
    v_exp_f32 v142, v126
    v_cvt_pk_bf16_f32 v146, v140, v141
    v_exp_f32 v143, v127
    v_mfma_f32_32x32x16_bf16 v[104:119], a[148:151], v[36:39], v[104:119]
    v_exp_f32 v136, v128
    v_exp_f32 v137, v129
    v_cvt_pk_bf16_f32 v147, v142, v143
    v_exp_f32 v138, v130
    v_cvt_pk_bf16_f32 v148, v136, v137
    v_exp_f32 v139, v131
    v_mfma_f32_32x32x16_bf16 v[72:87], a[136:139], v[144:147], v[72:87]
    v_exp_f32 v140, v132
    v_exp_f32 v141, v133
    v_cvt_pk_bf16_f32 v149, v138, v139
    v_exp_f32 v142, v134
    v_cvt_pk_bf16_f32 v150, v140, v141
    v_exp_f32 v143, v135
    v_mfma_f32_32x32x16_bf16 v[120:135], a[144:147], v[24:27], 0
    buffer_load_dwordx4 a[192:195], v2, s[20:23], s38 offen offset:0 sc1
    v_exp_f32 v136, v104
    v_exp_f32 v137, v105
    v_cvt_pk_bf16_f32 v151, v142, v143
    v_exp_f32 v138, v106
    v_cvt_pk_bf16_f32 v144, v136, v137
    v_exp_f32 v139, v107
    v_mfma_f32_32x32x16_bf16 v[72:87], a[140:143], v[148:151], v[72:87]
    buffer_load_dwordx4 a[196:199], v2, s[20:23], s38 offen offset:1024 sc1
    v_exp_f32 v140, v108
    v_exp_f32 v141, v109
    v_cvt_pk_bf16_f32 v145, v138, v139
    v_exp_f32 v142, v110
    v_cvt_pk_bf16_f32 v146, v140, v141
    v_exp_f32 v143, v111
    v_mfma_f32_32x32x16_bf16 v[120:135], a[148:151], v[28:31], v[120:135]
    buffer_load_dwordx4 a[200:203], v2, s[20:23], s38 offen offset:2048 sc1
    v_exp_f32 v136, v112
    v_exp_f32 v137, v113
    v_cvt_pk_bf16_f32 v147, v142, v143
    v_exp_f32 v138, v114
    v_cvt_pk_bf16_f32 v148, v136, v137
    v_exp_f32 v139, v115
    v_mfma_f32_32x32x16_bf16 v[88:103], a[152:155], v[144:147], v[88:103]
    s_waitcnt vmcnt(7)
    v_exp_f32 v140, v116
    v_exp_f32 v141, v117
    v_cvt_pk_bf16_f32 v149, v138, v139
    v_exp_f32 v142, v118
    v_cvt_pk_bf16_f32 v150, v140, v141
    v_exp_f32 v143, v119
    v_mfma_f32_32x32x16_bf16 v[104:119], a[160:163], v[32:35], 0
    buffer_load_dwordx4 a[204:207], v2, s[20:23], s38 offen offset:3072 sc1
    v_exp_f32 v136, v120
    v_exp_f32 v137, v121
    v_cvt_pk_bf16_f32 v151, v142, v143
    v_exp_f32 v138, v122
    v_cvt_pk_bf16_f32 v144, v136, v137
    v_exp_f32 v139, v123
    v_mfma_f32_32x32x16_bf16 v[88:103], a[156:159], v[148:151], v[88:103]
    s_add_u32 s38, s38, 4096
    v_exp_f32 v140, v124
    v_exp_f32 v141, v125
    v_cvt_pk_bf16_f32 v145, v138, v139
    v_exp_f32 v142, v126
    v_cvt_pk_bf16_f32 v146, v140, v141
    v_exp_f32 v143, v127
    v_mfma_f32_32x32x16_bf16 v[104:119], a[164:167], v[36:39], v[104:119]
    v_exp_f32 v136, v128
    v_exp_f32 v137, v129
    v_cvt_pk_bf16_f32 v147, v142, v143
    v_exp_f32 v138, v130
    v_cvt_pk_bf16_f32 v148, v136, v137
    v_exp_f32 v139, v131
    v_mfma_f32_32x32x16_bf16 v[72:87], a[152:155], v[144:147], v[72:87]
    v_exp_f32 v140, v132
    v_exp_f32 v141, v133
    v_cvt_pk_bf16_f32 v149, v138, v139
    v_exp_f32 v142, v134
    v_cvt_pk_bf16_f32 v150, v140, v141
    v_exp_f32 v143, v135
    v_mfma_f32_32x32x16_bf16 v[120:135], a[160:163], v[24:27], 0
    buffer_load_dwordx4 a[208:211], v2, s[20:23], s38 offen offset:0 sc1
    v_exp_f32 v136, v104
    v_exp_f32 v137, v105
    v_cvt_pk_bf16_f32 v151, v142, v143
    v_exp_f32 v138, v106
    v_cvt_pk_bf16_f32 v144, v136, v137
    v_exp_f32 v139, v107
    v_mfma_f32_32x32x16_bf16 v[72:87], a[156:159], v[148:151], v[72:87]
    buffer_load_dwordx4 a[212:215], v2, s[20:23], s38 offen offset:1024 sc1
    v_exp_f32 v140, v108
    v_exp_f32 v141, v109
    v_cvt_pk_bf16_f32 v145, v138, v139
    v_exp_f32 v142, v110
    v_cvt_pk_bf16_f32 v146, v140, v141
    v_exp_f32 v143, v111
    v_mfma_f32_32x32x16_bf16 v[120:135], a[164:167], v[28:31], v[120:135]
    buffer_load_dwordx4 a[216:219], v2, s[20:23], s38 offen offset:2048 sc1
    v_exp_f32 v136, v112
    v_exp_f32 v137, v113
    v_cvt_pk_bf16_f32 v147, v142, v143
    v_exp_f32 v138, v114
    v_cvt_pk_bf16_f32 v148, v136, v137
    v_exp_f32 v139, v115
    v_mfma_f32_32x32x16_bf16 v[88:103], a[168:171], v[144:147], v[88:103]
    s_waitcnt vmcnt(7)
    v_exp_f32 v140, v116
    v_exp_f32 v141, v117
    v_cvt_pk_bf16_f32 v149, v138, v139
    v_exp_f32 v142, v118
    v_cvt_pk_bf16_f32 v150, v140, v141
    v_exp_f32 v143, v119
    v_mfma_f32_32x32x16_bf16 v[104:119], a[176:179], v[32:35], 0
    buffer_load_dwordx4 a[220:223], v2, s[20:23], s38 offen offset:3072 sc1
    v_exp_f32 v136, v120
    v_exp_f32 v137, v121
    v_cvt_pk_bf16_f32 v151, v142, v143
    v_exp_f32 v138, v122
    v_cvt_pk_bf16_f32 v144, v136, v137
    v_exp_f32 v139, v123
    v_mfma_f32_32x32x16_bf16 v[88:103], a[172:175], v[148:151], v[88:103]
    s_add_u32 s38, s38, 4096
    v_exp_f32 v140, v124
    v_exp_f32 v141, v125
    v_cvt_pk_bf16_f32 v145, v138, v139
    v_exp_f32 v142, v126
    v_cvt_pk_bf16_f32 v146, v140, v141
    v_exp_f32 v143, v127
    v_mfma_f32_32x32x16_bf16 v[104:119], a[180:183], v[36:39], v[104:119]
    v_exp_f32 v136, v128
    v_exp_f32 v137, v129
    v_cvt_pk_bf16_f32 v147, v142, v143
    v_exp_f32 v138, v130
    v_cvt_pk_bf16_f32 v148, v136, v137
    v_exp_f32 v139, v131
    v_mfma_f32_32x32x16_bf16 v[72:87], a[168:171], v[144:147], v[72:87]
    v_exp_f32 v140, v132
    v_exp_f32 v141, v133
    v_cvt_pk_bf16_f32 v149, v138, v139
    v_exp_f32 v142, v134
    v_cvt_pk_bf16_f32 v150, v140, v141
    v_exp_f32 v143, v135
    v_mfma_f32_32x32x16_bf16 v[120:135], a[176:179], v[24:27], 0
    buffer_load_dwordx4 a[224:227], v2, s[20:23], s38 offen offset:0 sc1
    v_exp_f32 v136, v104
    v_exp_f32 v137, v105
    v_cvt_pk_bf16_f32 v151, v142, v143
    v_exp_f32 v138, v106
    v_cvt_pk_bf16_f32 v144, v136, v137
    v_exp_f32 v139, v107
    v_mfma_f32_32x32x16_bf16 v[72:87], a[172:175], v[148:151], v[72:87]
    buffer_load_dwordx4 a[228:231], v2, s[20:23], s38 offen offset:1024 sc1
    v_exp_f32 v140, v108
    v_exp_f32 v141, v109
    v_cvt_pk_bf16_f32 v145, v138, v139
    v_exp_f32 v142, v110
    v_cvt_pk_bf16_f32 v146, v140, v141
    v_exp_f32 v143, v111
    v_mfma_f32_32x32x16_bf16 v[120:135], a[180:183], v[28:31], v[120:135]
    buffer_load_dwordx4 a[232:235], v2, s[20:23], s38 offen offset:2048 sc1
    v_exp_f32 v136, v112
    v_exp_f32 v137, v113
    v_cvt_pk_bf16_f32 v147, v142, v143
    v_exp_f32 v138, v114
    v_cvt_pk_bf16_f32 v148, v136, v137
    v_exp_f32 v139, v115
    v_mfma_f32_32x32x16_bf16 v[88:103], a[184:187], v[144:147], v[88:103]
    s_waitcnt vmcnt(7)
    v_exp_f32 v140, v116
    v_exp_f32 v141, v117
    v_cvt_pk_bf16_f32 v149, v138, v139
    v_exp_f32 v142, v118
    v_cvt_pk_bf16_f32 v150, v140, v141
    v_exp_f32 v143, v119
    v_mfma_f32_32x32x16_bf16 v[104:119], a[192:195], v[32:35], 0
    buffer_load_dwordx4 a[236:239], v2, s[20:23], s38 offen offset:3072 sc1
    v_exp_f32 v136, v120
    v_exp_f32 v137, v121
    v_cvt_pk_bf16_f32 v151, v142, v143
    v_exp_f32 v138, v122
    v_cvt_pk_bf16_f32 v144, v136, v137
    v_exp_f32 v139, v123
    v_mfma_f32_32x32x16_bf16 v[88:103], a[188:191], v[148:151], v[88:103]
    s_add_u32 s38, s38, 4096
    v_exp_f32 v140, v124
    v_exp_f32 v141, v125
    v_cvt_pk_bf16_f32 v145, v138, v139
    v_exp_f32 v142, v126
    v_cvt_pk_bf16_f32 v146, v140, v141
    v_exp_f32 v143, v127
    v_mfma_f32_32x32x16_bf16 v[104:119], a[196:199], v[36:39], v[104:119]
    v_exp_f32 v136, v128
    v_exp_f32 v137, v129
    v_cvt_pk_bf16_f32 v147, v142, v143
    v_exp_f32 v138, v130
    v_cvt_pk_bf16_f32 v148, v136, v137
    v_exp_f32 v139, v131
    v_mfma_f32_32x32x16_bf16 v[72:87], a[184:187], v[144:147], v[72:87]
    v_exp_f32 v140, v132
    v_exp_f32 v141, v133
    v_cvt_pk_bf16_f32 v149, v138, v139
    v_exp_f32 v142, v134
    v_cvt_pk_bf16_f32 v150, v140, v141
    v_exp_f32 v143, v135
    v_mfma_f32_32x32x16_bf16 v[120:135], a[192:195], v[24:27], 0
    buffer_load_dwordx4 a[240:243], v2, s[20:23], s38 offen offset:0 sc1
    v_exp_f32 v136, v104
    v_exp_f32 v137, v105
    v_cvt_pk_bf16_f32 v151, v142, v143
    v_exp_f32 v138, v106
    v_cvt_pk_bf16_f32 v144, v136, v137
    v_exp_f32 v139, v107
    v_mfma_f32_32x32x16_bf16 v[72:87], a[188:191], v[148:151], v[72:87]
    buffer_load_dwordx4 a[244:247], v2, s[20:23], s38 offen offset:1024 sc1
    v_exp_f32 v140, v108
    v_exp_f32 v141, v109
    v_cvt_pk_bf16_f32 v145, v138, v139
    v_exp_f32 v142, v110
    v_cvt_pk_bf16_f32 v146, v140, v141
    v_exp_f32 v143, v111
    v_mfma_f32_32x32x16_bf16 v[120:135], a[196:199], v[28:31], v[120:135]
    buffer_load_dwordx4 a[248:251], v2, s[20:23], s38 offen offset:2048 sc1
    v_exp_f32 v136, v112
    v_exp_f32 v137, v113
    v_cvt_pk_bf16_f32 v147, v142, v143
    v_exp_f32 v138, v114
    v_cvt_pk_bf16_f32 v148, v136, v137
    v_exp_f32 v139, v115
    v_mfma_f32_32x32x16_bf16 v[88:103], a[200:203], v[144:147], v[88:103]
    s_waitcnt vmcnt(7)
    v_exp_f32 v140, v116
    v_exp_f32 v141, v117
    v_cvt_pk_bf16_f32 v149, v138, v139
    v_exp_f32 v142, v118
    v_cvt_pk_bf16_f32 v150, v140, v141
    v_exp_f32 v143, v119
    v_mfma_f32_32x32x16_bf16 v[104:119], a[208:211], v[32:35], 0
    buffer_load_dwordx4 a[252:255], v2, s[20:23], s38 offen offset:3072 sc1
    v_exp_f32 v136, v120
    v_exp_f32 v137, v121
    v_cvt_pk_bf16_f32 v151, v142, v143
    v_exp_f32 v138, v122
    v_cvt_pk_bf16_f32 v144, v136, v137
    v_exp_f32 v139, v123
    v_mfma_f32_32x32x16_bf16 v[88:103], a[204:207], v[148:151], v[88:103]
    s_add_u32 s38, s38, 4096
    v_exp_f32 v140, v124
    v_exp_f32 v141, v125
    v_cvt_pk_bf16_f32 v145, v138, v139
    v_exp_f32 v142, v126
    v_cvt_pk_bf16_f32 v146, v140, v141
    v_exp_f32 v143, v127
    v_mfma_f32_32x32x16_bf16 v[104:119], a[212:215], v[36:39], v[104:119]
    v_exp_f32 v136, v128
    v_exp_f32 v137, v129
    v_cvt_pk_bf16_f32 v147, v142, v143
    v_exp_f32 v138, v130
    v_cvt_pk_bf16_f32 v148, v136, v137
    v_exp_f32 v139, v131
    v_mfma_f32_32x32x16_bf16 v[72:87], a[200:203], v[144:147], v[72:87]
    v_exp_f32 v140, v132
    v_exp_f32 v141, v133
    v_cvt_pk_bf16_f32 v149, v138, v139
    v_exp_f32 v142, v134
    v_cvt_pk_bf16_f32 v150, v140, v141
    v_exp_f32 v143, v135
    v_mfma_f32_32x32x16_bf16 v[120:135], a[208:211], v[24:27], 0
    v_exp_f32 v136, v104
    v_exp_f32 v137, v105
    v_cvt_pk_bf16_f32 v151, v142, v143
    v_exp_f32 v138, v106
    v_cvt_pk_bf16_f32 v144, v136, v137
    v_exp_f32 v139, v107
    v_mfma_f32_32x32x16_bf16 v[72:87], a[204:207], v[148:151], v[72:87]
    v_exp_f32 v140, v108
    v_exp_f32 v141, v109
    v_cvt_pk_bf16_f32 v145, v138, v139
    v_exp_f32 v142, v110
    v_cvt_pk_bf16_f32 v146, v140, v141
    v_exp_f32 v143, v111
    v_mfma_f32_32x32x16_bf16 v[120:135], a[212:215], v[28:31], v[120:135]
    v_exp_f32 v136, v112
    v_exp_f32 v137, v113
    v_cvt_pk_bf16_f32 v147, v142, v143
    v_exp_f32 v138, v114
    v_cvt_pk_bf16_f32 v148, v136, v137
    v_exp_f32 v139, v115
    v_mfma_f32_32x32x16_bf16 v[88:103], a[216:219], v[144:147], v[88:103]
    s_waitcnt vmcnt(4)
    v_exp_f32 v140, v116
    v_exp_f32 v141, v117
    v_cvt_pk_bf16_f32 v149, v138, v139
    v_exp_f32 v142, v118
    v_cvt_pk_bf16_f32 v150, v140, v141
    v_exp_f32 v143, v119
    v_mfma_f32_32x32x16_bf16 v[104:119], a[224:227], v[32:35], 0
    v_exp_f32 v136, v120
    v_exp_f32 v137, v121
    v_cvt_pk_bf16_f32 v151, v142, v143
    v_exp_f32 v138, v122
    v_cvt_pk_bf16_f32 v144, v136, v137
    v_exp_f32 v139, v123
    v_mfma_f32_32x32x16_bf16 v[88:103], a[220:223], v[148:151], v[88:103]
    v_exp_f32 v140, v124
    v_exp_f32 v141, v125
    v_cvt_pk_bf16_f32 v145, v138, v139
    v_exp_f32 v142, v126
    v_cvt_pk_bf16_f32 v146, v140, v141
    v_exp_f32 v143, v127
    v_mfma_f32_32x32x16_bf16 v[104:119], a[228:231], v[36:39], v[104:119]
    v_exp_f32 v136, v128
    v_exp_f32 v137, v129
    v_cvt_pk_bf16_f32 v147, v142, v143
    v_exp_f32 v138, v130
    v_cvt_pk_bf16_f32 v148, v136, v137
    v_exp_f32 v139, v131
    v_mfma_f32_32x32x16_bf16 v[72:87], a[216:219], v[144:147], v[72:87]
    v_exp_f32 v140, v132
    v_exp_f32 v141, v133
    v_cvt_pk_bf16_f32 v149, v138, v139
    v_exp_f32 v142, v134
    v_cvt_pk_bf16_f32 v150, v140, v141
    v_exp_f32 v143, v135
    v_mfma_f32_32x32x16_bf16 v[120:135], a[224:227], v[24:27], 0
    v_exp_f32 v136, v104
    v_exp_f32 v137, v105
    v_cvt_pk_bf16_f32 v151, v142, v143
    v_exp_f32 v138, v106
    v_cvt_pk_bf16_f32 v144, v136, v137
    v_exp_f32 v139, v107
    v_mfma_f32_32x32x16_bf16 v[72:87], a[220:223], v[148:151], v[72:87]
    v_exp_f32 v140, v108
    v_exp_f32 v141, v109
    v_cvt_pk_bf16_f32 v145, v138, v139
    v_exp_f32 v142, v110
    v_cvt_pk_bf16_f32 v146, v140, v141
    v_exp_f32 v143, v111
    v_mfma_f32_32x32x16_bf16 v[120:135], a[228:231], v[28:31], v[120:135]
    v_exp_f32 v136, v112
    v_exp_f32 v137, v113
    v_cvt_pk_bf16_f32 v147, v142, v143
    v_exp_f32 v138, v114
    v_cvt_pk_bf16_f32 v148, v136, v137
    v_exp_f32 v139, v115
    v_mfma_f32_32x32x16_bf16 v[88:103], a[232:235], v[144:147], v[88:103]
    s_waitcnt vmcnt(0)
    v_exp_f32 v140, v116
    v_exp_f32 v141, v117
    v_cvt_pk_bf16_f32 v149, v138, v139
    v_exp_f32 v142, v118
    v_cvt_pk_bf16_f32 v150, v140, v141
    v_exp_f32 v143, v119
    v_mfma_f32_32x32x16_bf16 v[104:119], a[240:243], v[32:35], 0
    buffer_store_dwordx4 v[196:199], v2, s[20:23], s40 offen offset:0 sc1
    v_exp_f32 v136, v120
    v_exp_f32 v137, v121
    v_cvt_pk_bf16_f32 v151, v142, v143
    v_exp_f32 v138, v122
    v_cvt_pk_bf16_f32 v144, v136, v137
    v_exp_f32 v139, v123
    v_mfma_f32_32x32x16_bf16 v[88:103], a[236:239], v[148:151], v[88:103]
    v_exp_f32 v140, v124
    v_exp_f32 v141, v125
    v_cvt_pk_bf16_f32 v145, v138, v139
    v_exp_f32 v142, v126
    v_cvt_pk_bf16_f32 v146, v140, v141
    v_exp_f32 v143, v127
    v_mfma_f32_32x32x16_bf16 v[104:119], a[244:247], v[36:39], v[104:119]
    buffer_store_dwordx4 v[196:199], v2, s[20:23], s40 offen offset:1024 sc1
    v_exp_f32 v136, v128
    v_exp_f32 v137, v129
    v_cvt_pk_bf16_f32 v147, v142, v143
    v_exp_f32 v138, v130
    v_cvt_pk_bf16_f32 v148, v136, v137
    v_exp_f32 v139, v131
    v_mfma_f32_32x32x16_bf16 v[72:87], a[232:235], v[144:147], v[72:87]
    v_exp_f32 v140, v132
    v_exp_f32 v141, v133
    v_cvt_pk_bf16_f32 v149, v138, v139
    v_exp_f32 v142, v134
    v_cvt_pk_bf16_f32 v150, v140, v141
    v_exp_f32 v143, v135
    v_mfma_f32_32x32x16_bf16 v[120:135], a[240:243], v[24:27], 0
    buffer_store_dwordx4 v[196:199], v2, s[20:23], s40 offen offset:2048 sc1
    v_exp_f32 v136, v104
    v_exp_f32 v137, v105
    v_cvt_pk_bf16_f32 v151, v142, v143
    v_exp_f32 v138, v106
    v_cvt_pk_bf16_f32 v144, v136, v137
    v_exp_f32 v139, v107
    v_mfma_f32_32x32x16_bf16 v[72:87], a[236:239], v[148:151], v[72:87]
    v_exp_f32 v140, v108
    v_exp_f32 v141, v109
    v_cvt_pk_bf16_f32 v145, v138, v139
    v_exp_f32 v142, v110
    v_cvt_pk_bf16_f32 v146, v140, v141
    v_exp_f32 v143, v111
    v_mfma_f32_32x32x16_bf16 v[120:135], a[244:247], v[28:31], v[120:135]
    buffer_store_dwordx4 v[196:199], v2, s[20:23], s40 offen offset:3072 sc1
    v_exp_f32 v136, v112
    v_exp_f32 v137, v113
    v_cvt_pk_bf16_f32 v147, v142, v143
    v_exp_f32 v138, v114
    v_cvt_pk_bf16_f32 v148, v136, v137
    v_exp_f32 v139, v115
    v_mfma_f32_32x32x16_bf16 v[88:103], a[248:251], v[144:147], v[88:103]
    s_add_u32 s40, s40, 4096
    v_exp_f32 v140, v116
    v_exp_f32 v141, v117
    v_cvt_pk_bf16_f32 v149, v138, v139
    v_exp_f32 v142, v118
    v_cvt_pk_bf16_f32 v150, v140, v141
    v_exp_f32 v143, v119
    v_mfma_f32_32x32x16_bf16 v[104:119], a[0:3], v[16:19], 0
    buffer_store_dwordx4 v[196:199], v2, s[20:23], s40 offen offset:0 sc1
    v_exp_f32 v136, v120
    v_exp_f32 v137, v121
    v_cvt_pk_bf16_f32 v151, v142, v143
    v_exp_f32 v138, v122
    v_cvt_pk_bf16_f32 v144, v136, v137
    v_exp_f32 v139, v123
    v_mfma_f32_32x32x16_bf16 v[88:103], a[252:255], v[148:151], v[88:103]
    v_exp_f32 v140, v124
    v_exp_f32 v141, v125
    v_cvt_pk_bf16_f32 v145, v138, v139
    v_exp_f32 v142, v126
    v_cvt_pk_bf16_f32 v146, v140, v141
    v_exp_f32 v143, v127
    v_mfma_f32_32x32x16_bf16 v[104:119], a[4:7], v[20:23], v[104:119]
    buffer_store_dwordx4 v[196:199], v2, s[20:23], s40 offen offset:1024 sc1
    v_exp_f32 v136, v128
    v_exp_f32 v137, v129
    v_cvt_pk_bf16_f32 v147, v142, v143
    v_exp_f32 v138, v130
    v_cvt_pk_bf16_f32 v148, v136, v137
    v_exp_f32 v139, v131
    v_mfma_f32_32x32x16_bf16 v[72:87], a[248:251], v[144:147], v[72:87]
    v_exp_f32 v140, v132
    v_exp_f32 v141, v133
    v_cvt_pk_bf16_f32 v149, v138, v139
    v_exp_f32 v142, v134
    v_cvt_pk_bf16_f32 v150, v140, v141
    v_exp_f32 v143, v135
    v_mfma_f32_32x32x16_bf16 v[120:135], a[0:3], v[8:11], 0
    buffer_load_dword v7, v4, s[12:15], s41 offen
    v_exp_f32 v136, v104
    v_exp_f32 v137, v105
    v_cvt_pk_bf16_f32 v151, v142, v143
    v_exp_f32 v138, v106
    v_cvt_pk_bf16_f32 v144, v136, v137
    v_exp_f32 v139, v107
    v_mfma_f32_32x32x16_bf16 v[72:87], a[252:255], v[148:151], v[72:87]
    s_mov_b32 s14, s50
    v_exp_f32 v140, v108
    v_exp_f32 v141, v109
    v_cvt_pk_bf16_f32 v145, v138, v139
    v_exp_f32 v142, v110
    v_cvt_pk_bf16_f32 v146, v140, v141
    v_exp_f32 v143, v111
    v_mfma_f32_32x32x16_bf16 v[120:135], a[4:7], v[12:15], v[120:135]
    v_exp_f32 v136, v112
    v_exp_f32 v137, v113
    v_cvt_pk_bf16_f32 v147, v142, v143
    v_exp_f32 v138, v114
    v_cvt_pk_bf16_f32 v148, v136, v137
    v_exp_f32 v139, v115
    v_mfma_f32_32x32x16_bf16 v[56:71], a[8:11], v[144:147], 0
    v_exp_f32 v140, v116
    v_exp_f32 v141, v117
    v_cvt_pk_bf16_f32 v149, v138, v139
    v_exp_f32 v142, v118
    v_cvt_pk_bf16_f32 v150, v140, v141
    v_exp_f32 v143, v119
    v_mfma_f32_32x32x16_bf16 v[104:119], a[16:19], v[16:19], 0
    ds_write_b128 v155, v[88:91] offset:0
    v_exp_f32 v136, v120
    v_exp_f32 v137, v121
    v_cvt_pk_bf16_f32 v151, v142, v143
    v_exp_f32 v138, v122
    v_cvt_pk_bf16_f32 v144, v136, v137
    v_exp_f32 v139, v123
    v_mfma_f32_32x32x16_bf16 v[56:71], a[12:15], v[148:151], v[56:71]
    ds_write_b128 v155, v[92:95] offset:1024
    v_exp_f32 v140, v124
    v_exp_f32 v141, v125
    v_cvt_pk_bf16_f32 v145, v138, v139
    v_exp_f32 v142, v126
    v_cvt_pk_bf16_f32 v146, v140, v141
    v_exp_f32 v143, v127
    v_mfma_f32_32x32x16_bf16 v[104:119], a[20:23], v[20:23], v[104:119]
    ds_write_b128 v155, v[96:99] offset:2048
    v_exp_f32 v136, v128
    v_exp_f32 v137, v129
    v_cvt_pk_bf16_f32 v147, v142, v143
    v_exp_f32 v138, v130
    v_cvt_pk_bf16_f32 v148, v136, v137
    v_exp_f32 v139, v131
    v_mfma_f32_32x32x16_bf16 v[40:55], a[8:11], v[144:147], 0
    ds_write_b128 v155, v[100:103] offset:3072
    v_exp_f32 v140, v132
    v_exp_f32 v141, v133
    v_cvt_pk_bf16_f32 v149, v138, v139
    v_exp_f32 v142, v134
    v_cvt_pk_bf16_f32 v150, v140, v141
    v_exp_f32 v143, v135
    v_mfma_f32_32x32x16_bf16 v[120:135], a[16:19], v[8:11], 0
    ds_write_b128 v154, v[72:75] offset:0
    v_exp_f32 v136, v104
    v_exp_f32 v137, v105
    v_cvt_pk_bf16_f32 v151, v142, v143
    v_exp_f32 v138, v106
    v_cvt_pk_bf16_f32 v144, v136, v137
    v_exp_f32 v139, v107
    v_mfma_f32_32x32x16_bf16 v[40:55], a[12:15], v[148:151], v[40:55]
    ds_write_b128 v154, v[76:79] offset:1024
    v_exp_f32 v140, v108
    v_exp_f32 v141, v109
    v_cvt_pk_bf16_f32 v145, v138, v139
    v_exp_f32 v142, v110
    v_cvt_pk_bf16_f32 v146, v140, v141
    v_exp_f32 v143, v111
    v_mfma_f32_32x32x16_bf16 v[120:135], a[20:23], v[12:15], v[120:135]
    ds_write_b128 v154, v[80:83] offset:2048
    v_exp_f32 v136, v112
    v_exp_f32 v137, v113
    v_cvt_pk_bf16_f32 v147, v142, v143
    v_exp_f32 v138, v114
    v_cvt_pk_bf16_f32 v148, v136, v137
    v_exp_f32 v139, v115
    v_mfma_f32_32x32x16_bf16 v[56:71], a[24:27], v[144:147], v[56:71]
    ds_write_b128 v154, v[84:87] offset:3072
    v_exp_f32 v140, v116
    v_exp_f32 v141, v117
    v_cvt_pk_bf16_f32 v149, v138, v139
    v_exp_f32 v142, v118
    v_cvt_pk_bf16_f32 v150, v140, v141
    v_exp_f32 v143, v119
    v_mfma_f32_32x32x16_bf16 v[104:119], a[32:35], v[16:19], 0
    v_exp_f32 v136, v120
    v_exp_f32 v137, v121
    v_cvt_pk_bf16_f32 v151, v142, v143
    v_exp_f32 v138, v122
    v_cvt_pk_bf16_f32 v144, v136, v137
    v_exp_f32 v139, v123
    v_mfma_f32_32x32x16_bf16 v[56:71], a[28:31], v[148:151], v[56:71]
    v_exp_f32 v140, v124
    v_exp_f32 v141, v125
    v_cvt_pk_bf16_f32 v145, v138, v139
    v_exp_f32 v142, v126
    v_cvt_pk_bf16_f32 v146, v140, v141
    v_exp_f32 v143, v127
    v_mfma_f32_32x32x16_bf16 v[104:119], a[36:39], v[20:23], v[104:119]
    v_exp_f32 v136, v128
    v_exp_f32 v137, v129
    v_cvt_pk_bf16_f32 v147, v142, v143
    v_exp_f32 v138, v130
    v_cvt_pk_bf16_f32 v148, v136, v137
    v_exp_f32 v139, v131
    v_mfma_f32_32x32x16_bf16 v[40:55], a[24:27], v[144:147], v[40:55]
    v_exp_f32 v140, v132
    v_exp_f32 v141, v133
    v_cvt_pk_bf16_f32 v149, v138, v139
    v_exp_f32 v142, v134
    v_cvt_pk_bf16_f32 v150, v140, v141
    v_exp_f32 v143, v135
    v_mfma_f32_32x32x16_bf16 v[120:135], a[32:35], v[8:11], 0
    v_exp_f32 v136, v104
    v_exp_f32 v137, v105
    v_cvt_pk_bf16_f32 v151, v142, v143
    v_exp_f32 v138, v106
    v_cvt_pk_bf16_f32 v144, v136, v137
    v_exp_f32 v139, v107
    v_mfma_f32_32x32x16_bf16 v[40:55], a[28:31], v[148:151], v[40:55]
    v_exp_f32 v140, v108
    v_exp_f32 v141, v109
    v_cvt_pk_bf16_f32 v145, v138, v139
    v_exp_f32 v142, v110
    v_cvt_pk_bf16_f32 v146, v140, v141
    v_exp_f32 v143, v111
    v_mfma_f32_32x32x16_bf16 v[120:135], a[36:39], v[12:15], v[120:135]
    v_exp_f32 v136, v112
    v_exp_f32 v137, v113
    v_cvt_pk_bf16_f32 v147, v142, v143
    v_exp_f32 v138, v114
    v_cvt_pk_bf16_f32 v148, v136, v137
    v_exp_f32 v139, v115
    v_mfma_f32_32x32x16_bf16 v[56:71], a[40:43], v[144:147], v[56:71]
    v_exp_f32 v140, v116
    v_exp_f32 v141, v117
    v_cvt_pk_bf16_f32 v149, v138, v139
    v_exp_f32 v142, v118
    v_cvt_pk_bf16_f32 v150, v140, v141
    v_exp_f32 v143, v119
    v_mfma_f32_32x32x16_bf16 v[104:119], a[48:51], v[16:19], 0
    v_exp_f32 v136, v120
    v_exp_f32 v137, v121
    v_cvt_pk_bf16_f32 v151, v142, v143
    v_exp_f32 v138, v122
    v_cvt_pk_bf16_f32 v144, v136, v137
    v_exp_f32 v139, v123
    v_mfma_f32_32x32x16_bf16 v[56:71], a[44:47], v[148:151], v[56:71]
    v_exp_f32 v140, v124
    v_exp_f32 v141, v125
    v_cvt_pk_bf16_f32 v145, v138, v139
    v_exp_f32 v142, v126
    v_cvt_pk_bf16_f32 v146, v140, v141
    v_exp_f32 v143, v127
    v_mfma_f32_32x32x16_bf16 v[104:119], a[52:55], v[20:23], v[104:119]
    v_exp_f32 v136, v128
    v_exp_f32 v137, v129
    v_cvt_pk_bf16_f32 v147, v142, v143
    v_exp_f32 v138, v130
    v_cvt_pk_bf16_f32 v148, v136, v137
    v_exp_f32 v139, v131
    v_mfma_f32_32x32x16_bf16 v[40:55], a[40:43], v[144:147], v[40:55]
    v_exp_f32 v140, v132
    v_exp_f32 v141, v133
    v_cvt_pk_bf16_f32 v149, v138, v139
    v_exp_f32 v142, v134
    v_cvt_pk_bf16_f32 v150, v140, v141
    v_exp_f32 v143, v135
    v_mfma_f32_32x32x16_bf16 v[120:135], a[48:51], v[8:11], 0
    v_exp_f32 v136, v104
    v_exp_f32 v137, v105
    v_cvt_pk_bf16_f32 v151, v142, v143
    v_exp_f32 v138, v106
    v_cvt_pk_bf16_f32 v144, v136, v137
    v_exp_f32 v139, v107
    v_mfma_f32_32x32x16_bf16 v[40:55], a[44:47], v[148:151], v[40:55]
    v_exp_f32 v140, v108
    v_exp_f32 v141, v109
    v_cvt_pk_bf16_f32 v145, v138, v139
    v_exp_f32 v142, v110
    v_cvt_pk_bf16_f32 v146, v140, v141
    v_exp_f32 v143, v111
    v_mfma_f32_32x32x16_bf16 v[120:135], a[52:55], v[12:15], v[120:135]
    v_exp_f32 v136, v112
    v_exp_f32 v137, v113
    v_cvt_pk_bf16_f32 v147, v142, v143
    v_exp_f32 v138, v114
    v_cvt_pk_bf16_f32 v148, v136, v137
    v_exp_f32 v139, v115
    v_mfma_f32_32x32x16_bf16 v[56:71], a[56:59], v[144:147], v[56:71]
    v_exp_f32 v140, v116
    v_exp_f32 v141, v117
    v_cvt_pk_bf16_f32 v149, v138, v139
    v_exp_f32 v142, v118
    v_cvt_pk_bf16_f32 v150, v140, v141
    v_exp_f32 v143, v119
    v_mfma_f32_32x32x16_bf16 v[104:119], a[64:67], v[16:19], 0
    v_exp_f32 v136, v120
    v_exp_f32 v137, v121
    v_cvt_pk_bf16_f32 v151, v142, v143
    v_exp_f32 v138, v122
    v_cvt_pk_bf16_f32 v144, v136, v137
    v_exp_f32 v139, v123
    v_mfma_f32_32x32x16_bf16 v[56:71], a[60:63], v[148:151], v[56:71]
    v_exp_f32 v140, v124
    v_exp_f32 v141, v125
    v_cvt_pk_bf16_f32 v145, v138, v139
    v_exp_f32 v142, v126
    v_cvt_pk_bf16_f32 v146, v140, v141
    v_exp_f32 v143, v127
    v_mfma_f32_32x32x16_bf16 v[104:119], a[68:71], v[20:23], v[104:119]
    v_exp_f32 v136, v128
    v_exp_f32 v137, v129
    v_cvt_pk_bf16_f32 v147, v142, v143
    v_exp_f32 v138, v130
    v_cvt_pk_bf16_f32 v148, v136, v137
    v_exp_f32 v139, v131
    v_mfma_f32_32x32x16_bf16 v[40:55], a[56:59], v[144:147], v[40:55]
    v_exp_f32 v140, v132
    v_exp_f32 v141, v133
    v_cvt_pk_bf16_f32 v149, v138, v139
    v_exp_f32 v142, v134
    v_cvt_pk_bf16_f32 v150, v140, v141
    v_exp_f32 v143, v135
    v_mfma_f32_32x32x16_bf16 v[120:135], a[64:67], v[8:11], 0
    v_exp_f32 v136, v104
    v_exp_f32 v137, v105
    v_cvt_pk_bf16_f32 v151, v142, v143
    v_exp_f32 v138, v106
    v_cvt_pk_bf16_f32 v144, v136, v137
    v_exp_f32 v139, v107
    v_mfma_f32_32x32x16_bf16 v[40:55], a[60:63], v[148:151], v[40:55]
    v_exp_f32 v140, v108
    v_exp_f32 v141, v109
    v_cvt_pk_bf16_f32 v145, v138, v139
    v_exp_f32 v142, v110
    v_cvt_pk_bf16_f32 v146, v140, v141
    v_exp_f32 v143, v111
    v_mfma_f32_32x32x16_bf16 v[120:135], a[68:71], v[12:15], v[120:135]
    v_exp_f32 v136, v112
    v_exp_f32 v137, v113
    v_cvt_pk_bf16_f32 v147, v142, v143
    v_exp_f32 v138, v114
    v_cvt_pk_bf16_f32 v148, v136, v137
    v_exp_f32 v139, v115
    v_mfma_f32_32x32x16_bf16 v[56:71], a[72:75], v[144:147], v[56:71]
    v_exp_f32 v140, v116
    v_exp_f32 v141, v117
    v_cvt_pk_bf16_f32 v149, v138, v139
    v_exp_f32 v142, v118
    v_cvt_pk_bf16_f32 v150, v140, v141
    v_exp_f32 v143, v119
    v_mfma_f32_32x32x16_bf16 v[104:119], a[80:83], v[16:19], 0
    v_exp_f32 v136, v120
    v_exp_f32 v137, v121
    v_cvt_pk_bf16_f32 v151, v142, v143
    v_exp_f32 v138, v122
    v_cvt_pk_bf16_f32 v144, v136, v137
    v_exp_f32 v139, v123
    v_mfma_f32_32x32x16_bf16 v[56:71], a[76:79], v[148:151], v[56:71]
    v_exp_f32 v140, v124
    v_exp_f32 v141, v125
    v_cvt_pk_bf16_f32 v145, v138, v139
    v_exp_f32 v142, v126
    v_cvt_pk_bf16_f32 v146, v140, v141
    v_exp_f32 v143, v127
    v_mfma_f32_32x32x16_bf16 v[104:119], a[84:87], v[20:23], v[104:119]
    v_exp_f32 v136, v128
    v_exp_f32 v137, v129
    v_cvt_pk_bf16_f32 v147, v142, v143
    v_exp_f32 v138, v130
    v_cvt_pk_bf16_f32 v148, v136, v137
    v_exp_f32 v139, v131
    v_mfma_f32_32x32x16_bf16 v[40:55], a[72:75], v[144:147], v[40:55]
    v_exp_f32 v140, v132
    v_exp_f32 v141, v133
    v_cvt_pk_bf16_f32 v149, v138, v139
    v_exp_f32 v142, v134
    v_cvt_pk_bf16_f32 v150, v140, v141
    v_exp_f32 v143, v135
    v_mfma_f32_32x32x16_bf16 v[120:135], a[80:83], v[8:11], 0
    s_waitcnt vmcnt(1)
    v_exp_f32 v136, v104
    v_exp_f32 v137, v105
    v_cvt_pk_bf16_f32 v151, v142, v143
    v_exp_f32 v138, v106
    v_cvt_pk_bf16_f32 v144, v136, v137
    v_exp_f32 v139, v107
    v_mfma_f32_32x32x16_bf16 v[40:55], a[76:79], v[148:151], v[40:55]
    buffer_store_dword v190, v5, s[20:23], s44 offen sc1
    v_exp_f32 v140, v108
    v_exp_f32 v141, v109
    v_cvt_pk_bf16_f32 v145, v138, v139
    v_exp_f32 v142, v110
    v_cvt_pk_bf16_f32 v146, v140, v141
    v_exp_f32 v143, v111
    v_mfma_f32_32x32x16_bf16 v[120:135], a[84:87], v[12:15], v[120:135]
    v_exp_f32 v136, v112
    v_exp_f32 v137, v113
    v_cvt_pk_bf16_f32 v147, v142, v143
    v_exp_f32 v138, v114
    v_cvt_pk_bf16_f32 v148, v136, v137
    v_exp_f32 v139, v115
    v_mfma_f32_32x32x16_bf16 v[56:71], a[88:91], v[144:147], v[56:71]
    v_exp_f32 v140, v116
    v_exp_f32 v141, v117
    v_cvt_pk_bf16_f32 v149, v138, v139
    v_exp_f32 v142, v118
    v_cvt_pk_bf16_f32 v150, v140, v141
    v_exp_f32 v143, v119
    v_mfma_f32_32x32x16_bf16 v[104:119], a[96:99], v[16:19], 0
    v_exp_f32 v136, v120
    v_exp_f32 v137, v121
    v_cvt_pk_bf16_f32 v151, v142, v143
    v_exp_f32 v138, v122
    v_cvt_pk_bf16_f32 v144, v136, v137
    v_exp_f32 v139, v123
    v_mfma_f32_32x32x16_bf16 v[56:71], a[92:95], v[148:151], v[56:71]
    v_exp_f32 v140, v124
    v_exp_f32 v141, v125
    v_cvt_pk_bf16_f32 v145, v138, v139
    v_exp_f32 v142, v126
    v_cvt_pk_bf16_f32 v146, v140, v141
    v_exp_f32 v143, v127
    v_mfma_f32_32x32x16_bf16 v[104:119], a[100:103], v[20:23], v[104:119]
    v_exp_f32 v136, v128
    v_exp_f32 v137, v129
    v_cvt_pk_bf16_f32 v147, v142, v143
    v_exp_f32 v138, v130
    v_cvt_pk_bf16_f32 v148, v136, v137
    v_exp_f32 v139, v131
    v_mfma_f32_32x32x16_bf16 v[40:55], a[88:91], v[144:147], v[40:55]
    v_exp_f32 v140, v132
    v_exp_f32 v141, v133
    v_cvt_pk_bf16_f32 v149, v138, v139
    v_exp_f32 v142, v134
    v_cvt_pk_bf16_f32 v150, v140, v141
    v_exp_f32 v143, v135
    v_mfma_f32_32x32x16_bf16 v[120:135], a[96:99], v[8:11], 0
    s_add_u32 m0, s31, 0
    v_exp_f32 v136, v104
    v_exp_f32 v137, v105
    v_cvt_pk_bf16_f32 v151, v142, v143
    v_exp_f32 v138, v106
    v_cvt_pk_bf16_f32 v144, v136, v137
    v_exp_f32 v139, v107
    v_mfma_f32_32x32x16_bf16 v[40:55], a[92:95], v[148:151], v[40:55]
    buffer_load_dwordx4 v157, s[12:15], s26 offen offset:0 lds
    v_exp_f32 v140, v108
    v_exp_f32 v141, v109
    v_cvt_pk_bf16_f32 v145, v138, v139
    v_exp_f32 v142, v110
    v_cvt_pk_bf16_f32 v146, v140, v141
    v_exp_f32 v143, v111
    v_mfma_f32_32x32x16_bf16 v[120:135], a[100:103], v[12:15], v[120:135]
    buffer_load_dwordx4 v158, s[12:15], s26 offen offset:1024 lds
    v_exp_f32 v136, v112
    v_exp_f32 v137, v113
    v_cvt_pk_bf16_f32 v147, v142, v143
    v_exp_f32 v138, v114
    v_cvt_pk_bf16_f32 v148, v136, v137
    v_exp_f32 v139, v115
    v_mfma_f32_32x32x16_bf16 v[56:71], a[104:107], v[144:147], v[56:71]
    buffer_load_dwordx4 v204, s[12:15], s26 offen offset:2048 lds
    v_exp_f32 v140, v116
    v_exp_f32 v141, v117
    v_cvt_pk_bf16_f32 v149, v138, v139
    v_exp_f32 v142, v118
    v_cvt_pk_bf16_f32 v150, v140, v141
    v_exp_f32 v143, v119
    v_mfma_f32_32x32x16_bf16 v[104:119], a[112:115], v[16:19], 0
    buffer_load_dwordx4 v205, s[12:15], s26 offen offset:3072 lds
    v_exp_f32 v136, v120
    v_exp_f32 v137, v121
    v_cvt_pk_bf16_f32 v151, v142, v143
    v_exp_f32 v138, v122
    v_cvt_pk_bf16_f32 v144, v136, v137
    v_exp_f32 v139, v123
    v_mfma_f32_32x32x16_bf16 v[56:71], a[108:111], v[148:151], v[56:71]
    s_add_u32 s26, s26, 114688
    s_add_u32 m0, s31, 4096
    v_exp_f32 v140, v124
    v_exp_f32 v141, v125
    v_cvt_pk_bf16_f32 v145, v138, v139
    v_exp_f32 v142, v126
    v_cvt_pk_bf16_f32 v146, v140, v141
    v_exp_f32 v143, v127
    v_mfma_f32_32x32x16_bf16 v[104:119], a[116:119], v[20:23], v[104:119]
    buffer_load_dwordx4 v157, s[12:15], s26 offen offset:0 lds
    v_exp_f32 v136, v128
    v_exp_f32 v137, v129
    v_cvt_pk_bf16_f32 v147, v142, v143
    v_exp_f32 v138, v130
    v_cvt_pk_bf16_f32 v148, v136, v137
    v_exp_f32 v139, v131
    v_mfma_f32_32x32x16_bf16 v[40:55], a[104:107], v[144:147], v[40:55]
    buffer_load_dwordx4 v158, s[12:15], s26 offen offset:1024 lds
    v_exp_f32 v140, v132
    v_exp_f32 v141, v133
    v_cvt_pk_bf16_f32 v149, v138, v139
    v_exp_f32 v142, v134
    v_cvt_pk_bf16_f32 v150, v140, v141
    v_exp_f32 v143, v135
    v_mfma_f32_32x32x16_bf16 v[120:135], a[112:115], v[8:11], 0
    buffer_load_dwordx4 v204, s[12:15], s26 offen offset:2048 lds
    v_exp_f32 v136, v104
    v_exp_f32 v137, v105
    v_cvt_pk_bf16_f32 v151, v142, v143
    v_exp_f32 v138, v106
    v_cvt_pk_bf16_f32 v144, v136, v137
    v_exp_f32 v139, v107
    v_mfma_f32_32x32x16_bf16 v[40:55], a[108:111], v[148:151], v[40:55]
    buffer_load_dwordx4 v205, s[12:15], s26 offen offset:3072 lds
    v_exp_f32 v140, v108
    v_exp_f32 v141, v109
    v_cvt_pk_bf16_f32 v145, v138, v139
    v_exp_f32 v142, v110
    v_cvt_pk_bf16_f32 v146, v140, v141
    v_exp_f32 v143, v111
    v_mfma_f32_32x32x16_bf16 v[120:135], a[116:119], v[12:15], v[120:135]
    s_add_u32 s26, s26, 114688
    s_add_u32 m0, s31, 8192
    v_exp_f32 v136, v112
    v_exp_f32 v137, v113
    v_cvt_pk_bf16_f32 v147, v142, v143
    v_exp_f32 v138, v114
    v_cvt_pk_bf16_f32 v148, v136, v137
    v_exp_f32 v139, v115
    v_mfma_f32_32x32x16_bf16 v[56:71], a[120:123], v[144:147], v[56:71]
    buffer_load_dwordx4 v157, s[12:15], s26 offen offset:0 lds
    v_exp_f32 v140, v116
    v_exp_f32 v141, v117
    v_cvt_pk_bf16_f32 v149, v138, v139
    v_exp_f32 v142, v118
    v_cvt_pk_bf16_f32 v150, v140, v141
    v_exp_f32 v143, v119
    v_mfma_f32_32x32x16_bf16 v[104:119], a[128:131], v[16:19], 0
    buffer_load_dwordx4 v158, s[12:15], s26 offen offset:1024 lds
    v_exp_f32 v136, v120
    v_exp_f32 v137, v121
    v_cvt_pk_bf16_f32 v151, v142, v143
    v_exp_f32 v138, v122
    v_cvt_pk_bf16_f32 v144, v136, v137
    v_exp_f32 v139, v123
    v_mfma_f32_32x32x16_bf16 v[56:71], a[124:127], v[148:151], v[56:71]
    buffer_load_dwordx4 v204, s[12:15], s26 offen offset:2048 lds
    v_exp_f32 v140, v124
    v_exp_f32 v141, v125
    v_cvt_pk_bf16_f32 v145, v138, v139
    v_exp_f32 v142, v126
    v_cvt_pk_bf16_f32 v146, v140, v141
    v_exp_f32 v143, v127
    v_mfma_f32_32x32x16_bf16 v[104:119], a[132:135], v[20:23], v[104:119]
    buffer_load_dwordx4 v205, s[12:15], s26 offen offset:3072 lds
    v_exp_f32 v136, v128
    v_exp_f32 v137, v129
    v_cvt_pk_bf16_f32 v147, v142, v143
    v_exp_f32 v138, v130
    v_cvt_pk_bf16_f32 v148, v136, v137
    v_exp_f32 v139, v131
    v_mfma_f32_32x32x16_bf16 v[40:55], a[120:123], v[144:147], v[40:55]
    s_add_u32 s26, s26, 114688
    s_add_u32 m0, s31, 12288
    v_exp_f32 v140, v132
    v_exp_f32 v141, v133
    v_cvt_pk_bf16_f32 v149, v138, v139
    v_exp_f32 v142, v134
    v_cvt_pk_bf16_f32 v150, v140, v141
    v_exp_f32 v143, v135
    v_mfma_f32_32x32x16_bf16 v[120:135], a[128:131], v[8:11], 0
    buffer_load_dwordx4 v157, s[12:15], s26 offen offset:0 lds
    v_exp_f32 v136, v104
    v_exp_f32 v137, v105
    v_cvt_pk_bf16_f32 v151, v142, v143
    v_exp_f32 v138, v106
    v_cvt_pk_bf16_f32 v144, v136, v137
    v_exp_f32 v139, v107
    v_mfma_f32_32x32x16_bf16 v[40:55], a[124:127], v[148:151], v[40:55]
    buffer_load_dwordx4 v158, s[12:15], s26 offen offset:1024 lds
    v_exp_f32 v140, v108
    v_exp_f32 v141, v109
    v_cvt_pk_bf16_f32 v145, v138, v139
    v_exp_f32 v142, v110
    v_cvt_pk_bf16_f32 v146, v140, v141
    v_exp_f32 v143, v111
    v_mfma_f32_32x32x16_bf16 v[120:135], a[132:135], v[12:15], v[120:135]
    s_add_u32 s26, s26, 57344
    v_exp_f32 v136, v112
    v_exp_f32 v137, v113
    v_cvt_pk_bf16_f32 v147, v142, v143
    v_exp_f32 v138, v114
    v_cvt_pk_bf16_f32 v148, v136, v137
    v_exp_f32 v139, v115
    v_mfma_f32_32x32x16_bf16 v[56:71], a[136:139], v[144:147], v[56:71]
    s_add_u32 m0, s49, 0
    v_exp_f32 v140, v116
    v_exp_f32 v141, v117
    v_cvt_pk_bf16_f32 v149, v138, v139
    v_exp_f32 v142, v118
    v_cvt_pk_bf16_f32 v150, v140, v141
    v_exp_f32 v143, v119
    v_mfma_f32_32x32x16_bf16 v[104:119], a[144:147], v[16:19], 0
    buffer_load_dwordx4 v156, s[4:7], s48 offen offset:0 lds
    v_exp_f32 v136, v120
    v_exp_f32 v137, v121
    v_cvt_pk_bf16_f32 v151, v142, v143
    v_exp_f32 v138, v122
    v_cvt_pk_bf16_f32 v144, v136, v137
    v_exp_f32 v139, v123
    v_mfma_f32_32x32x16_bf16 v[56:71], a[140:143], v[148:151], v[56:71]
    buffer_load_dwordx4 v206, s[4:7], s48 offen offset:1024 lds
    v_exp_f32 v140, v124
    v_exp_f32 v141, v125
    v_cvt_pk_bf16_f32 v145, v138, v139
    v_exp_f32 v142, v126
    v_cvt_pk_bf16_f32 v146, v140, v141
    v_exp_f32 v143, v127
    v_mfma_f32_32x32x16_bf16 v[104:119], a[148:151], v[20:23], v[104:119]
    buffer_load_dwordx4 v207, s[4:7], s48 offen offset:2048 lds
    v_exp_f32 v136, v128
    v_exp_f32 v137, v129
    v_cvt_pk_bf16_f32 v147, v142, v143
    v_exp_f32 v138, v130
    v_cvt_pk_bf16_f32 v148, v136, v137
    v_exp_f32 v139, v131
    v_mfma_f32_32x32x16_bf16 v[40:55], a[136:139], v[144:147], v[40:55]
    buffer_load_dwordx4 v208, s[4:7], s48 offen offset:3072 lds
    v_exp_f32 v140, v132
    v_exp_f32 v141, v133
    v_cvt_pk_bf16_f32 v149, v138, v139
    v_exp_f32 v142, v134
    v_cvt_pk_bf16_f32 v150, v140, v141
    v_exp_f32 v143, v135
    v_mfma_f32_32x32x16_bf16 v[120:135], a[144:147], v[8:11], 0
    s_add_u32 m0, s49, 4096
    s_add_u32 s48, s48, 28672
    v_exp_f32 v136, v104
    v_exp_f32 v137, v105
    v_cvt_pk_bf16_f32 v151, v142, v143
    v_exp_f32 v138, v106
    v_cvt_pk_bf16_f32 v144, v136, v137
    v_exp_f32 v139, v107
    v_mfma_f32_32x32x16_bf16 v[40:55], a[140:143], v[148:151], v[40:55]
    buffer_load_dwordx4 v156, s[4:7], s48 offen offset:0 lds
    v_exp_f32 v140, v108
    v_exp_f32 v141, v109
    v_cvt_pk_bf16_f32 v145, v138, v139
    v_exp_f32 v142, v110
    v_cvt_pk_bf16_f32 v146, v140, v141
    v_exp_f32 v143, v111
    v_mfma_f32_32x32x16_bf16 v[120:135], a[148:151], v[12:15], v[120:135]
    buffer_load_dwordx4 v206, s[4:7], s48 offen offset:1024 lds
    v_exp_f32 v136, v112
    v_exp_f32 v137, v113
    v_cvt_pk_bf16_f32 v147, v142, v143
    v_exp_f32 v138, v114
    v_cvt_pk_bf16_f32 v148, v136, v137
    v_exp_f32 v139, v115
    v_mfma_f32_32x32x16_bf16 v[56:71], a[152:155], v[144:147], v[56:71]
    buffer_load_dwordx4 v207, s[4:7], s48 offen offset:2048 lds
    v_exp_f32 v140, v116
    v_exp_f32 v141, v117
    v_cvt_pk_bf16_f32 v149, v138, v139
    v_exp_f32 v142, v118
    v_cvt_pk_bf16_f32 v150, v140, v141
    v_exp_f32 v143, v119
    v_mfma_f32_32x32x16_bf16 v[104:119], a[160:163], v[16:19], 0
    buffer_load_dwordx4 v208, s[4:7], s48 offen offset:3072 lds
    v_exp_f32 v136, v120
    v_exp_f32 v137, v121
    v_cvt_pk_bf16_f32 v151, v142, v143
    v_exp_f32 v138, v122
    v_cvt_pk_bf16_f32 v144, v136, v137
    v_exp_f32 v139, v123
    v_mfma_f32_32x32x16_bf16 v[56:71], a[156:159], v[148:151], v[56:71]
    s_add_u32 m0, s49, 8192
    s_add_u32 s48, s48, 28672
    v_exp_f32 v140, v124
    v_exp_f32 v141, v125
    v_cvt_pk_bf16_f32 v145, v138, v139
    v_exp_f32 v142, v126
    v_cvt_pk_bf16_f32 v146, v140, v141
    v_exp_f32 v143, v127
    v_mfma_f32_32x32x16_bf16 v[104:119], a[164:167], v[20:23], v[104:119]
    buffer_load_dwordx4 v156, s[4:7], s48 offen offset:0 lds
    v_exp_f32 v136, v128
    v_exp_f32 v137, v129
    v_cvt_pk_bf16_f32 v147, v142, v143
    v_exp_f32 v138, v130
    v_cvt_pk_bf16_f32 v148, v136, v137
    v_exp_f32 v139, v131
    v_mfma_f32_32x32x16_bf16 v[40:55], a[152:155], v[144:147], v[40:55]
    buffer_load_dwordx4 v206, s[4:7], s48 offen offset:1024 lds
    v_exp_f32 v140, v132
    v_exp_f32 v141, v133
    v_cvt_pk_bf16_f32 v149, v138, v139
    v_exp_f32 v142, v134
    v_cvt_pk_bf16_f32 v150, v140, v141
    v_exp_f32 v143, v135
    v_mfma_f32_32x32x16_bf16 v[120:135], a[160:163], v[8:11], 0
    buffer_load_dwordx4 v207, s[4:7], s48 offen offset:2048 lds
    v_exp_f32 v136, v104
    v_exp_f32 v137, v105
    v_cvt_pk_bf16_f32 v151, v142, v143
    v_exp_f32 v138, v106
    v_cvt_pk_bf16_f32 v144, v136, v137
    v_exp_f32 v139, v107
    v_mfma_f32_32x32x16_bf16 v[40:55], a[156:159], v[148:151], v[40:55]
    buffer_load_dwordx4 v208, s[4:7], s48 offen offset:3072 lds
    v_exp_f32 v140, v108
    v_exp_f32 v141, v109
    v_cvt_pk_bf16_f32 v145, v138, v139
    v_exp_f32 v142, v110
    v_cvt_pk_bf16_f32 v146, v140, v141
    v_exp_f32 v143, v111
    v_mfma_f32_32x32x16_bf16 v[120:135], a[164:167], v[12:15], v[120:135]
    s_add_u32 m0, s49, 12288
    s_add_u32 s48, s48, 28672
    v_exp_f32 v136, v112
    v_exp_f32 v137, v113
    v_cvt_pk_bf16_f32 v147, v142, v143
    v_exp_f32 v138, v114
    v_cvt_pk_bf16_f32 v148, v136, v137
    v_exp_f32 v139, v115
    v_mfma_f32_32x32x16_bf16 v[56:71], a[168:171], v[144:147], v[56:71]
    buffer_load_dwordx4 v156, s[4:7], s48 offen offset:0 lds
    v_exp_f32 v140, v116
    v_exp_f32 v141, v117
    v_cvt_pk_bf16_f32 v149, v138, v139
    v_exp_f32 v142, v118
    v_cvt_pk_bf16_f32 v150, v140, v141
    v_exp_f32 v143, v119
    v_mfma_f32_32x32x16_bf16 v[104:119], a[176:179], v[16:19], 0
    buffer_load_dwordx4 v206, s[4:7], s48 offen offset:1024 lds
    v_exp_f32 v136, v120
    v_exp_f32 v137, v121
    v_cvt_pk_bf16_f32 v151, v142, v143
    v_exp_f32 v138, v122
    v_cvt_pk_bf16_f32 v144, v136, v137
    v_exp_f32 v139, v123
    v_mfma_f32_32x32x16_bf16 v[56:71], a[172:175], v[148:151], v[56:71]
    s_waitcnt vmcnt(14)
    v_exp_f32 v140, v124
    v_exp_f32 v141, v125
    v_cvt_pk_bf16_f32 v145, v138, v139
    v_exp_f32 v142, v126
    v_cvt_pk_bf16_f32 v146, v140, v141
    v_exp_f32 v143, v127
    v_mfma_f32_32x32x16_bf16 v[104:119], a[180:183], v[20:23], v[104:119]
    ds_read_b64_tr_b16 a[0:1], v186 offset:0
    ds_read_b64_tr_b16 a[2:3], v186 offset:1024
    v_exp_f32 v136, v128
    v_exp_f32 v137, v129
    v_cvt_pk_bf16_f32 v147, v142, v143
    v_exp_f32 v138, v130
    v_cvt_pk_bf16_f32 v148, v136, v137
    v_exp_f32 v139, v131
    v_mfma_f32_32x32x16_bf16 v[40:55], a[168:171], v[144:147], v[40:55]
    ds_read_b64_tr_b16 a[4:5], v187 offset:0
    ds_read_b64_tr_b16 a[6:7], v187 offset:1024
    v_exp_f32 v140, v132
    v_exp_f32 v141, v133
    v_cvt_pk_bf16_f32 v149, v138, v139
    v_exp_f32 v142, v134
    v_cvt_pk_bf16_f32 v150, v140, v141
    v_exp_f32 v143, v135
    v_mfma_f32_32x32x16_bf16 v[120:135], a[176:179], v[8:11], 0
    ds_read_b64_tr_b16 a[8:9], v186 offset:2048
    ds_read_b64_tr_b16 a[10:11], v186 offset:3072
    v_exp_f32 v136, v104
    v_exp_f32 v137, v105
    v_cvt_pk_bf16_f32 v151, v142, v143
    v_exp_f32 v138, v106
    v_cvt_pk_bf16_f32 v144, v136, v137
    v_exp_f32 v139, v107
    v_mfma_f32_32x32x16_bf16 v[40:55], a[172:175], v[148:151], v[40:55]
    ds_read_b64_tr_b16 a[12:13], v187 offset:2048
    ds_read_b64_tr_b16 a[14:15], v187 offset:3072
    v_exp_f32 v140, v108
    v_exp_f32 v141, v109
    v_cvt_pk_bf16_f32 v145, v138, v139
    v_exp_f32 v142, v110
    v_cvt_pk_bf16_f32 v146, v140, v141
    v_exp_f32 v143, v111
    v_mfma_f32_32x32x16_bf16 v[120:135], a[180:183], v[12:15], v[120:135]
    ds_read_b64_tr_b16 a[16:17], v186 offset:4096
    ds_read_b64_tr_b16 a[18:19], v186 offset:5120
    v_exp_f32 v136, v112
    v_exp_f32 v137, v113
    v_cvt_pk_bf16_f32 v147, v142, v143
    v_exp_f32 v138, v114
    v_cvt_pk_bf16_f32 v148, v136, v137
    v_exp_f32 v139, v115
    v_mfma_f32_32x32x16_bf16 v[56:71], a[184:187], v[144:147], v[56:71]
    ds_read_b64_tr_b16 a[20:21], v187 offset:4096
    ds_read_b64_tr_b16 a[22:23], v187 offset:5120
    v_exp_f32 v140, v116
    v_exp_f32 v141, v117
    v_cvt_pk_bf16_f32 v149, v138, v139
    v_exp_f32 v142, v118
    v_cvt_pk_bf16_f32 v150, v140, v141
    v_exp_f32 v143, v119
    v_mfma_f32_32x32x16_bf16 v[104:119], a[192:195], v[16:19], 0
    ds_read_b64_tr_b16 a[24:25], v186 offset:6144
    ds_read_b64_tr_b16 a[26:27], v186 offset:7168
    v_exp_f32 v136, v120
    v_exp_f32 v137, v121
    v_cvt_pk_bf16_f32 v151, v142, v143
    v_exp_f32 v138, v122
    v_cvt_pk_bf16_f32 v144, v136, v137
    v_exp_f32 v139, v123
    v_mfma_f32_32x32x16_bf16 v[56:71], a[188:191], v[148:151], v[56:71]
    ds_read_b64_tr_b16 a[28:29], v187 offset:6144
    ds_read_b64_tr_b16 a[30:31], v187 offset:7168
    v_exp_f32 v140, v124
    v_exp_f32 v141, v125
    v_cvt_pk_bf16_f32 v145, v138, v139
    v_exp_f32 v142, v126
    v_cvt_pk_bf16_f32 v146, v140, v141
    v_exp_f32 v143, v127
    v_mfma_f32_32x32x16_bf16 v[104:119], a[196:199], v[20:23], v[104:119]
    ds_read_b64_tr_b16 a[32:33], v186 offset:8192
    ds_read_b64_tr_b16 a[34:35], v186 offset:9216
    v_exp_f32 v136, v128
    v_exp_f32 v137, v129
    v_cvt_pk_bf16_f32 v147, v142, v143
    v_exp_f32 v138, v130
    v_cvt_pk_bf16_f32 v148, v136, v137
    v_exp_f32 v139, v131
    v_mfma_f32_32x32x16_bf16 v[40:55], a[184:187], v[144:147], v[40:55]
    ds_read_b64_tr_b16 a[36:37], v187 offset:8192
    ds_read_b64_tr_b16 a[38:39], v187 offset:9216
    v_exp_f32 v140, v132
    v_exp_f32 v141, v133
    v_cvt_pk_bf16_f32 v149, v138, v139
    v_exp_f32 v142, v134
    v_cvt_pk_bf16_f32 v150, v140, v141
    v_exp_f32 v143, v135
    v_mfma_f32_32x32x16_bf16 v[120:135], a[192:195], v[8:11], 0
    ds_read_b64_tr_b16 a[40:41], v186 offset:10240
    ds_read_b64_tr_b16 a[42:43], v186 offset:11264
    v_exp_f32 v136, v104
    v_exp_f32 v137, v105
    v_cvt_pk_bf16_f32 v151, v142, v143
    v_exp_f32 v138, v106
    v_cvt_pk_bf16_f32 v144, v136, v137
    v_exp_f32 v139, v107
    v_mfma_f32_32x32x16_bf16 v[40:55], a[188:191], v[148:151], v[40:55]
    ds_read_b64_tr_b16 a[44:45], v187 offset:10240
    ds_read_b64_tr_b16 a[46:47], v187 offset:11264
    v_exp_f32 v140, v108
    v_exp_f32 v141, v109
    v_cvt_pk_bf16_f32 v145, v138, v139
    v_exp_f32 v142, v110
    v_cvt_pk_bf16_f32 v146, v140, v141
    v_exp_f32 v143, v111
    v_mfma_f32_32x32x16_bf16 v[120:135], a[196:199], v[12:15], v[120:135]
    ds_read_b64_tr_b16 a[48:49], v186 offset:12288
    ds_read_b64_tr_b16 a[50:51], v186 offset:13312
    v_exp_f32 v136, v112
    v_exp_f32 v137, v113
    v_cvt_pk_bf16_f32 v147, v142, v143
    v_exp_f32 v138, v114
    v_cvt_pk_bf16_f32 v148, v136, v137
    v_exp_f32 v139, v115
    v_mfma_f32_32x32x16_bf16 v[56:71], a[200:203], v[144:147], v[56:71]
    ds_read_b64_tr_b16 a[52:53], v187 offset:12288
    ds_read_b64_tr_b16 a[54:55], v187 offset:13312
    v_exp_f32 v140, v116
    v_exp_f32 v141, v117
    v_cvt_pk_bf16_f32 v149, v138, v139
    v_exp_f32 v142, v118
    v_cvt_pk_bf16_f32 v150, v140, v141
    v_exp_f32 v143, v119
    v_mfma_f32_32x32x16_bf16 v[104:119], a[208:211], v[16:19], 0
    buffer_load_dwordx4 v[200:203], v189, s[20:23], s45 offen sc1
    v_exp_f32 v136, v120
    v_exp_f32 v137, v121
    v_cvt_pk_bf16_f32 v151, v142, v143
    v_exp_f32 v138, v122
    v_cvt_pk_bf16_f32 v144, v136, v137
    v_exp_f32 v139, v123
    v_mfma_f32_32x32x16_bf16 v[56:71], a[204:207], v[148:151], v[56:71]
    s_waitcnt lgkmcnt(0)
    v_exp_f32 v140, v124
    v_exp_f32 v141, v125
    v_cvt_pk_bf16_f32 v145, v138, v139
    v_exp_f32 v142, v126
    v_cvt_pk_bf16_f32 v146, v140, v141
    v_exp_f32 v143, v127
    v_mfma_f32_32x32x16_bf16 v[104:119], a[212:215], v[20:23], v[104:119]
    s_add_u32 m0, s31, 0
    v_exp_f32 v136, v128
    v_exp_f32 v137, v129
    v_cvt_pk_bf16_f32 v147, v142, v143
    v_exp_f32 v138, v130
    v_cvt_pk_bf16_f32 v148, v136, v137
    v_exp_f32 v139, v131
    v_mfma_f32_32x32x16_bf16 v[40:55], a[200:203], v[144:147], v[40:55]
    buffer_load_dwordx4 v157, s[12:15], s26 offen offset:0 lds
    v_exp_f32 v140, v132
    v_exp_f32 v141, v133
    v_cvt_pk_bf16_f32 v149, v138, v139
    v_exp_f32 v142, v134
    v_cvt_pk_bf16_f32 v150, v140, v141
    v_exp_f32 v143, v135
    v_mfma_f32_32x32x16_bf16 v[120:135], a[208:211], v[8:11], 0
    buffer_load_dwordx4 v158, s[12:15], s26 offen offset:1024 lds
    v_exp_f32 v136, v104
    v_exp_f32 v137, v105
    v_cvt_pk_bf16_f32 v151, v142, v143
    v_exp_f32 v138, v106
    v_cvt_pk_bf16_f32 v144, v136, v137
    v_exp_f32 v139, v107
    v_mfma_f32_32x32x16_bf16 v[40:55], a[204:207], v[148:151], v[40:55]
    s_add_u32 s26, s26, 57344
    s_cmp_ge_u32 s26, s54
    s_cselect_b32 s42, 1835008, 0
    s_sub_u32 s26, s26, s42
    s_add_u32 m0, s31, 2048
    v_exp_f32 v140, v108
    v_exp_f32 v141, v109
    v_cvt_pk_bf16_f32 v145, v138, v139
    v_exp_f32 v142, v110
    v_cvt_pk_bf16_f32 v146, v140, v141
    v_exp_f32 v143, v111
    v_mfma_f32_32x32x16_bf16 v[120:135], a[212:215], v[12:15], v[120:135]
    buffer_load_dwordx4 v157, s[12:15], s26 offen offset:0 lds
    v_exp_f32 v136, v112
    v_exp_f32 v137, v113
    v_cvt_pk_bf16_f32 v147, v142, v143
    v_exp_f32 v138, v114
    v_cvt_pk_bf16_f32 v148, v136, v137
    v_exp_f32 v139, v115
    v_mfma_f32_32x32x16_bf16 v[56:71], a[216:219], v[144:147], v[56:71]
    buffer_load_dwordx4 v158, s[12:15], s26 offen offset:1024 lds
    v_exp_f32 v140, v116
    v_exp_f32 v141, v117
    v_cvt_pk_bf16_f32 v149, v138, v139
    v_exp_f32 v142, v118
    v_cvt_pk_bf16_f32 v150, v140, v141
    v_exp_f32 v143, v119
    v_mfma_f32_32x32x16_bf16 v[104:119], a[224:227], v[16:19], 0
    buffer_load_dwordx4 v204, s[12:15], s26 offen offset:2048 lds
    v_exp_f32 v136, v120
    v_exp_f32 v137, v121
    v_cvt_pk_bf16_f32 v151, v142, v143
    v_exp_f32 v138, v122
    v_cvt_pk_bf16_f32 v144, v136, v137
    v_exp_f32 v139, v123
    v_mfma_f32_32x32x16_bf16 v[56:71], a[220:223], v[148:151], v[56:71]
    buffer_load_dwordx4 v205, s[12:15], s26 offen offset:3072 lds
    v_exp_f32 v140, v124
    v_exp_f32 v141, v125
    v_cvt_pk_bf16_f32 v145, v138, v139
    v_exp_f32 v142, v126
    v_cvt_pk_bf16_f32 v146, v140, v141
    v_exp_f32 v143, v127
    v_mfma_f32_32x32x16_bf16 v[104:119], a[228:231], v[20:23], v[104:119]
    s_add_u32 s26, s26, 114688
    s_add_u32 m0, s31, 6144
    v_exp_f32 v136, v128
    v_exp_f32 v137, v129
    v_cvt_pk_bf16_f32 v147, v142, v143
    v_exp_f32 v138, v130
    v_cvt_pk_bf16_f32 v148, v136, v137
    v_exp_f32 v139, v131
    v_mfma_f32_32x32x16_bf16 v[40:55], a[216:219], v[144:147], v[40:55]
    buffer_load_dwordx4 v157, s[12:15], s26 offen offset:0 lds
    v_exp_f32 v140, v132
    v_exp_f32 v141, v133
    v_cvt_pk_bf16_f32 v149, v138, v139
    v_exp_f32 v142, v134
    v_cvt_pk_bf16_f32 v150, v140, v141
    v_exp_f32 v143, v135
    v_mfma_f32_32x32x16_bf16 v[120:135], a[224:227], v[8:11], 0
    buffer_load_dwordx4 v158, s[12:15], s26 offen offset:1024 lds
    v_exp_f32 v136, v104
    v_exp_f32 v137, v105
    v_cvt_pk_bf16_f32 v151, v142, v143
    v_exp_f32 v138, v106
    v_cvt_pk_bf16_f32 v144, v136, v137
    v_exp_f32 v139, v107
    v_mfma_f32_32x32x16_bf16 v[40:55], a[220:223], v[148:151], v[40:55]
    buffer_load_dwordx4 v204, s[12:15], s26 offen offset:2048 lds
    v_exp_f32 v140, v108
    v_exp_f32 v141, v109
    v_cvt_pk_bf16_f32 v145, v138, v139
    v_exp_f32 v142, v110
    v_cvt_pk_bf16_f32 v146, v140, v141
    v_exp_f32 v143, v111
    v_mfma_f32_32x32x16_bf16 v[120:135], a[228:231], v[12:15], v[120:135]
    buffer_load_dwordx4 v205, s[12:15], s26 offen offset:3072 lds
    v_exp_f32 v136, v112
    v_exp_f32 v137, v113
    v_cvt_pk_bf16_f32 v147, v142, v143
    v_exp_f32 v138, v114
    v_cvt_pk_bf16_f32 v148, v136, v137
    v_exp_f32 v139, v115
    v_mfma_f32_32x32x16_bf16 v[56:71], a[232:235], v[144:147], v[56:71]
    s_add_u32 s26, s26, 114688
    s_add_u32 m0, s31, 10240
    v_exp_f32 v140, v116
    v_exp_f32 v141, v117
    v_cvt_pk_bf16_f32 v149, v138, v139
    v_exp_f32 v142, v118
    v_cvt_pk_bf16_f32 v150, v140, v141
    v_exp_f32 v143, v119
    v_mfma_f32_32x32x16_bf16 v[104:119], a[240:243], v[16:19], 0
    buffer_load_dwordx4 v157, s[12:15], s26 offen offset:0 lds
    v_exp_f32 v136, v120
    v_exp_f32 v137, v121
    v_cvt_pk_bf16_f32 v151, v142, v143
    v_exp_f32 v138, v122
    v_cvt_pk_bf16_f32 v144, v136, v137
    v_exp_f32 v139, v123
    v_mfma_f32_32x32x16_bf16 v[56:71], a[236:239], v[148:151], v[56:71]
    buffer_load_dwordx4 v158, s[12:15], s26 offen offset:1024 lds
    v_exp_f32 v140, v124
    v_exp_f32 v141, v125
    v_cvt_pk_bf16_f32 v145, v138, v139
    v_exp_f32 v142, v126
    v_cvt_pk_bf16_f32 v146, v140, v141
    v_exp_f32 v143, v127
    v_mfma_f32_32x32x16_bf16 v[104:119], a[244:247], v[20:23], v[104:119]
    buffer_load_dwordx4 v204, s[12:15], s26 offen offset:2048 lds
    v_exp_f32 v136, v128
    v_exp_f32 v137, v129
    v_cvt_pk_bf16_f32 v147, v142, v143
    v_exp_f32 v138, v130
    v_cvt_pk_bf16_f32 v148, v136, v137
    v_exp_f32 v139, v131
    v_mfma_f32_32x32x16_bf16 v[40:55], a[232:235], v[144:147], v[40:55]
    buffer_load_dwordx4 v205, s[12:15], s26 offen offset:3072 lds
    v_exp_f32 v140, v132
    v_exp_f32 v141, v133
    v_cvt_pk_bf16_f32 v149, v138, v139
    v_exp_f32 v142, v134
    v_cvt_pk_bf16_f32 v150, v140, v141
    v_exp_f32 v143, v135
    v_mfma_f32_32x32x16_bf16 v[120:135], a[240:243], v[8:11], 0
    s_add_u32 s26, s26, 114688
    v_exp_f32 v136, v104
    v_exp_f32 v137, v105
    v_cvt_pk_bf16_f32 v151, v142, v143
    v_exp_f32 v138, v106
    v_cvt_pk_bf16_f32 v144, v136, v137
    v_exp_f32 v139, v107
    v_mfma_f32_32x32x16_bf16 v[40:55], a[236:239], v[148:151], v[40:55]
    s_mov_b32 s14, 0x700000
    buffer_load_dword v7, v209, s[12:15], s52 offen
    s_mov_b32 s14, s50
    v_exp_f32 v140, v108
    v_exp_f32 v141, v109
    v_cvt_pk_bf16_f32 v145, v138, v139
    v_exp_f32 v142, v110
    v_cvt_pk_bf16_f32 v146, v140, v141
    v_exp_f32 v143, v111
    v_mfma_f32_32x32x16_bf16 v[120:135], a[244:247], v[12:15], v[120:135]
    v_exp_f32 v136, v112
    v_exp_f32 v137, v113
    v_cvt_pk_bf16_f32 v147, v142, v143
    v_exp_f32 v138, v114
    v_cvt_pk_bf16_f32 v148, v136, v137
    v_exp_f32 v139, v115
    v_mfma_f32_32x32x16_bf16 v[56:71], a[248:251], v[144:147], v[56:71]
    v_exp_f32 v140, v116
    v_exp_f32 v141, v117
    v_cvt_pk_bf16_f32 v149, v138, v139
    v_exp_f32 v142, v118
    v_cvt_pk_bf16_f32 v150, v140, v141
    v_exp_f32 v143, v119
    v_exp_f32 v136, v120
    v_exp_f32 v137, v121
    v_cvt_pk_bf16_f32 v151, v142, v143
    v_exp_f32 v138, v122
    v_cvt_pk_bf16_f32 v144, v136, v137
    v_exp_f32 v139, v123
    v_mfma_f32_32x32x16_bf16 v[56:71], a[252:255], v[148:151], v[56:71]
    v_exp_f32 v140, v124
    v_exp_f32 v141, v125
    v_cvt_pk_bf16_f32 v145, v138, v139
    v_exp_f32 v142, v126
    v_cvt_pk_bf16_f32 v146, v140, v141
    v_exp_f32 v143, v127
    v_exp_f32 v136, v128
    v_exp_f32 v137, v129
    v_cvt_pk_bf16_f32 v147, v142, v143
    v_exp_f32 v138, v130
    v_cvt_pk_bf16_f32 v148, v136, v137
    v_exp_f32 v139, v131
    v_mfma_f32_32x32x16_bf16 v[40:55], a[248:251], v[144:147], v[40:55]
    v_exp_f32 v140, v132
    v_exp_f32 v141, v133
    v_cvt_pk_bf16_f32 v149, v138, v139
    v_exp_f32 v142, v134
    v_cvt_pk_bf16_f32 v150, v140, v141
    v_exp_f32 v143, v135
    s_nop 0
    v_cvt_pk_bf16_f32 v151, v142, v143
    ds_write_b128 v153, v[56:59] offset:0
    ds_write_b128 v153, v[60:63] offset:1024
    ds_write_b128 v153, v[64:67] offset:2048
    ds_write_b128 v153, v[68:71] offset:3072
    v_mfma_f32_32x32x16_bf16 v[40:55], a[252:255], v[148:151], v[40:55]
    s_mov_b32 s10, 1048576
    s_waitcnt vmcnt(15)
Lm_pa:
    v_xor_b32 v200, v200, v190
    v_xor_b32 v201, v201, v190
    v_xor_b32 v202, v202, v190
    v_xor_b32 v203, v203, v190
    v_or3_b32 v200, v200, v201, v202
    v_or_b32 v200, v200, v203
    v_cmp_ne_u32 vcc, 0, v200
    s_nop 4
    s_cbranch_vccz Lm_pae
    buffer_load_dwordx4 v[200:203], v189, s[20:23], s45 offen sc1
    s_sub_u32 s10, s10, 1
    s_waitcnt vmcnt(0)
    s_cbranch_scc0 Lm_pa
Lm_pae:
    s_waitcnt lgkmcnt(0)
    s_barrier
    ds_read_b128 v[56:59], v3 offset:0
    ds_read_b128 v[60:63], v3 offset:1024
    ds_read_b128 v[64:67], v3 offset:2048
    ds_read_b128 v[68:71], v3 offset:3072
    ds_read_b128 v[72:75], v3 offset:4096
    ds_read_b128 v[76:79], v3 offset:5120
    ds_read_b128 v[80:83], v3 offset:6144
    ds_read_b128 v[84:87], v3 offset:7168
    ds_read_b128 v[88:91], v3 offset:8192
    ds_read_b128 v[92:95], v3 offset:9216
    ds_read_b128 v[96:99], v3 offset:10240
    ds_read_b128 v[100:103], v3 offset:11264
    s_waitcnt lgkmcnt(11)
    v_pk_add_f32 v[40:41], v[40:41], v[56:57]
    v_pk_add_f32 v[42:43], v[42:43], v[58:59]
    s_waitcnt lgkmcnt(10)
    v_pk_add_f32 v[44:45], v[44:45], v[60:61]
    v_pk_add_f32 v[46:47], v[46:47], v[62:63]
    s_waitcnt lgkmcnt(9)
    v_pk_add_f32 v[48:49], v[48:49], v[64:65]
    v_pk_add_f32 v[50:51], v[50:51], v[66:67]
    s_waitcnt lgkmcnt(8)
    v_pk_add_f32 v[52:53], v[52:53], v[68:69]
    v_pk_add_f32 v[54:55], v[54:55], v[70:71]
    s_waitcnt lgkmcnt(7)
    v_pk_add_f32 v[40:41], v[40:41], v[72:73]
    v_pk_add_f32 v[42:43], v[42:43], v[74:75]
    s_waitcnt lgkmcnt(6)
    v_pk_add_f32 v[44:45], v[44:45], v[76:77]
    v_pk_add_f32 v[46:47], v[46:47], v[78:79]
    s_waitcnt lgkmcnt(5)
    v_pk_add_f32 v[48:49], v[48:49], v[80:81]
    v_pk_add_f32 v[50:51], v[50:51], v[82:83]
    s_waitcnt lgkmcnt(4)
    v_pk_add_f32 v[52:53], v[52:53], v[84:85]
    v_pk_add_f32 v[54:55], v[54:55], v[86:87]
    s_waitcnt lgkmcnt(3)
    v_pk_add_f32 v[40:41], v[40:41], v[88:89]
    v_pk_add_f32 v[42:43], v[42:43], v[90:91]
    s_waitcnt lgkmcnt(2)
    v_pk_add_f32 v[44:45], v[44:45], v[92:93]
    v_pk_add_f32 v[46:47], v[46:47], v[94:95]
    s_waitcnt lgkmcnt(1)
    v_pk_add_f32 v[48:49], v[48:49], v[96:97]
    v_pk_add_f32 v[50:51], v[50:51], v[98:99]
    s_waitcnt lgkmcnt(0)
    v_pk_add_f32 v[52:53], v[52:53], v[100:101]
    v_pk_add_f32 v[54:55], v[54:55], v[102:103]
    v_mov_b32 v152, v52
    v_mov_b32 v5, v52
    v_pk_mul_f32 v[104:105], v[40:41], 0
    v_pk_fma_f32 v[104:105], v[42:43], 0, v[104:105]
    v_pk_fma_f32 v[104:105], v[44:45], 0, v[104:105]
    v_pk_fma_f32 v[104:105], v[46:47], 0, v[104:105]
    v_pk_fma_f32 v[104:105], v[48:49], 0, v[104:105]
    v_pk_fma_f32 v[104:105], v[50:51], 0, v[104:105]
    v_pk_fma_f32 v[104:105], v[52:53], 0, v[104:105]
    v_pk_fma_f32 v[104:105], v[54:55], 0, v[104:105]
    v_add_f32 v4, v104, v105
    v_permlane32_swap_b32 v5, v152
    s_mov_b32 s41, 0x5d800000
    s_mov_b32 s42, 0x21800000
    v_add_f32 v5, v152, v4
    v_cmp_nle_f32 vcc, v5, s41
    v_cmp_nge_f32 s[10:11], v5, s42
    s_nop 0
    s_or_b64 vcc, vcc, s[10:11]
    s_nop 1
    s_cbranch_vccnz Lm_slow
Lm_fin:
    v_rcp_f32 v152, v152
    s_mov_b32 s10, 0
    s_mov_b32 s11, -1
    v_pk_mul_f32 v[40:41], v[40:41], v[152:153] op_sel_hi:[1,0]
    v_pk_mul_f32 v[42:43], v[42:43], v[152:153] op_sel_hi:[1,0]
    v_pk_mul_f32 v[44:45], v[44:45], v[152:153] op_sel_hi:[1,0]
    v_pk_mul_f32 v[46:47], v[46:47], v[152:153] op_sel_hi:[1,0]
    v_cvt_pk_bf16_f32 v144, v40, v41
    v_cvt_pk_bf16_f32 v145, v42, v43
    v_cvt_pk_bf16_f32 v146, v44, v45
    v_cvt_pk_bf16_f32 v147, v46, v47
    v_min_u32 v144, -2, v144
    v_min_u32 v145, -2, v145
    v_min_u32 v146, -2, v146
    v_min_u32 v147, -2, v147
    buffer_store_dwordx4 v[144:147], v2, s[20:23], s39 offen offset:0 sc1
    v_pk_mul_f32 v[48:49], v[48:49], v[152:153] op_sel_hi:[1,0]
    v_pk_mul_f32 v[50:51], v[50:51], v[152:153] op_sel_hi:[1,0]
    v_pk_mul_f32 v[52:53], v[52:53], v[152:153] op_sel_hi:[1,0]
    v_pk_mul_f32 v[54:55], v[54:55], v[152:153] op_sel_hi:[1,0]
    v_cvt_pk_bf16_f32 v148, v48, v49
    v_cvt_pk_bf16_f32 v149, v50, v51
    v_cvt_pk_bf16_f32 v150, v52, v53
    v_cvt_pk_bf16_f32 v151, v54, v55
    v_min_u32 v148, -2, v148
    v_min_u32 v149, -2, v149
    v_min_u32 v150, -2, v150
    v_min_u32 v151, -2, v151
    v_cndmask_b32 v150, v150, 0, s[10:11]
    v_cndmask_b32 v151, v151, 0, s[10:11]
    buffer_store_dwordx4 v[148:151], v2, s[20:23], s39 offen offset:1024 sc1
    s_cmp_ge_u32 s25, 28
    s_cbranch_scc1 Lm_idle
    s_waitcnt vmcnt(3)
    ds_read_b64_tr_b16 a[56:57], v186 offset:0
    ds_read_b64_tr_b16 a[58:59], v186 offset:1024
    ds_read_b64_tr_b16 a[60:61], v187 offset:0
    ds_read_b64_tr_b16 a[62:63], v187 offset:1024
    ds_read_b64_tr_b16 a[64:65], v186 offset:2048
    ds_read_b64_tr_b16 a[66:67], v186 offset:3072
    ds_read_b64_tr_b16 a[68:69], v187 offset:2048
    ds_read_b64_tr_b16 a[70:71], v187 offset:3072
    ds_read_b64_tr_b16 a[72:73], v186 offset:4096
    ds_read_b64_tr_b16 a[74:75], v186 offset:5120
    ds_read_b64_tr_b16 a[76:77], v187 offset:4096
    ds_read_b64_tr_b16 a[78:79], v187 offset:5120
    ds_read_b64_tr_b16 a[80:81], v186 offset:6144
    ds_read_b64_tr_b16 a[82:83], v186 offset:7168
    ds_read_b64_tr_b16 a[84:85], v187 offset:6144
    ds_read_b64_tr_b16 a[86:87], v187 offset:7168
    ds_read_b64_tr_b16 a[88:89], v186 offset:8192
    ds_read_b64_tr_b16 a[90:91], v186 offset:9216
    ds_read_b64_tr_b16 a[92:93], v187 offset:8192
    ds_read_b64_tr_b16 a[94:95], v187 offset:9216
    ds_read_b64_tr_b16 a[96:97], v186 offset:10240
    ds_read_b64_tr_b16 a[98:99], v186 offset:11264
    ds_read_b64_tr_b16 a[100:101], v187 offset:10240
    ds_read_b64_tr_b16 a[102:103], v187 offset:11264
    ds_read_b64_tr_b16 a[104:105], v186 offset:12288
    ds_read_b64_tr_b16 a[106:107], v186 offset:13312
    ds_read_b64_tr_b16 a[108:109], v187 offset:12288
    ds_read_b64_tr_b16 a[110:111], v187 offset:13312
    s_waitcnt lgkmcnt(0)
    s_barrier
    s_mul_i32 s31, s3, 10240
    s_mov_b32 s33, s46
    s_lshr_b32 s35, s3, 1
    s_lshl_b32 s35, s35, 10
    s_add_u32 s34, s33, s35
    s_and_b32 s41, s3, 1
    s_lshl_b32 s41, s41, 15
    s_add_u32 s41, s41, 40960
    v_add_u32 v3, s41, v2
    s_add_u32 s35, s35, s41
    s_mov_b32 s10, 1048576
    v_mfma_f32_32x32x16_bf16 v[240:255], v[176:179], v[168:171], 0
    v_mfma_f32_32x32x16_bf16 v[240:255], v[180:183], v[172:175], v[240:255]
    s_add_u32 m0, s31, 0
    s_nop 0
    buffer_load_dwordx4 v157, s[12:15], s26 offen lds
    ds_read_b64_tr_b16 v[8:9], v161 offset:0
    ds_read_b64_tr_b16 v[10:11], v161 offset:1024
    ds_read_b64_tr_b16 v[12:13], v161 offset:2048
    ds_read_b64_tr_b16 v[14:15], v161 offset:3072
    ds_read_b64_tr_b16 v[16:17], v161 offset:3584
    ds_read_b64_tr_b16 v[18:19], v161 offset:4608
    buffer_load_dwordx4 v158, s[12:15], s26 offen offset:1024 lds
    s_add_u32 s26, s26, 57344
    ds_read_b64_tr_b16 v[20:21], v161 offset:5632
    ds_read_b64_tr_b16 v[22:23], v161 offset:6656
    ds_read_b64_tr_b16 v[24:25], v161 offset:7168
    ds_read_b64_tr_b16 v[26:27], v161 offset:8192
    ds_read_b64_tr_b16 v[28:29], v161 offset:9216
    ds_read_b64_tr_b16 v[30:31], v161 offset:10240
    s_add_u32 m0, s31, 2048
    s_nop 0
    buffer_load_dwordx4 v157, s[12:15], s26 offen lds
    ds_read_b64_tr_b16 v[32:33], v161 offset:10752
    ds_read_b64_tr_b16 v[34:35], v161 offset:11776
    ds_read_b64_tr_b16 v[36:37], v161 offset:12800
    ds_read_b64_tr_b16 v[38:39], v161 offset:13824
    ds_read_b64_tr_b16 v[40:41], v161 offset:14336
    ds_read_b64_tr_b16 v[42:43], v161 offset:15360
    ds_read_b64_tr_b16 v[44:45], v161 offset:16384
    buffer_load_dwordx4 v158, s[12:15], s26 offen offset:1024 lds
    s_add_u32 s26, s26, 57344
    s_cmp_ge_u32 s26, s54
    s_cselect_b32 s42, 1835008, 0
    s_sub_u32 s26, s26, s42
    ds_read_b64_tr_b16 v[46:47], v161 offset:17408
    ds_read_b64_tr_b16 v[48:49], v161 offset:17920
    ds_read_b64_tr_b16 v[50:51], v161 offset:18944
    ds_read_b64_tr_b16 v[52:53], v161 offset:19968
    ds_read_b64_tr_b16 v[54:55], v161 offset:20992
    ds_read_b64_tr_b16 v[56:57], v161 offset:21504
    s_add_u32 m0, s31, 4096
    s_nop 0
    buffer_load_dwordx4 v157, s[12:15], s26 offen lds
    ds_read_b64_tr_b16 v[58:59], v161 offset:22528
    ds_read_b64_tr_b16 v[60:61], v161 offset:23552
    ds_read_b64_tr_b16 v[62:63], v161 offset:24576
    ds_read_b64_tr_b16 v[64:65], v161 offset:25088
    ds_read_b64_tr_b16 v[66:67], v161 offset:26112
    ds_read_b64_tr_b16 v[68:69], v161 offset:27136
    ds_read_b64_tr_b16 v[70:71], v161 offset:28160
    buffer_load_dwordx4 v158, s[12:15], s26 offen offset:1024 lds
    s_add_u32 s26, s26, 57344
    ds_read_b64_tr_b16 v[72:73], v161 offset:28672
    ds_read_b64_tr_b16 v[74:75], v161 offset:29696
    ds_read_b64_tr_b16 v[76:77], v161 offset:30720
    ds_read_b64_tr_b16 v[78:79], v161 offset:31744
    ds_read_b64_tr_b16 v[80:81], v161 offset:32256
    ds_read_b64_tr_b16 v[82:83], v161 offset:33280
    s_add_u32 m0, s31, 6144
    s_nop 0
    buffer_load_dwordx4 v157, s[12:15], s26 offen lds
    ds_read_b64_tr_b16 v[84:85], v161 offset:34304
    ds_read_b64_tr_b16 v[86:87], v161 offset:35328
    ds_read_b64_tr_b16 v[88:89], v161 offset:35840
    ds_read_b64_tr_b16 v[90:91], v161 offset:36864
    ds_read_b64_tr_b16 v[92:93], v161 offset:37888
    ds_read_b64_tr_b16 v[94:95], v161 offset:38912
    buffer_load_dwordx4 v158, s[12:15], s26 offen offset:1024 lds
    s_add_u32 s26, s26, 57344
    ds_read_b64_tr_b16 v[96:97], v161 offset:39424
    ds_read_b64_tr_b16 v[98:99], v161 offset:40448
    ds_read_b64_tr_b16 v[100:101], v161 offset:41472
    ds_read_b64_tr_b16 v[102:103], v161 offset:42496
    ds_read_b64_tr_b16 v[104:105], v161 offset:43008
    ds_read_b64_tr_b16 v[106:107], v161 offset:44032
    ds_read_b64_tr_b16 v[108:109], v161 offset:45056
    s_add_u32 m0, s31, 8192
    s_nop 0
    buffer_load_dwordx4 v157, s[12:15], s26 offen lds
    ds_read_b64_tr_b16 v[110:111], v161 offset:46080
    ds_read_b64_tr_b16 v[112:113], v161 offset:46592
    ds_read_b64_tr_b16 v[114:115], v161 offset:47616
    ds_read_b64_tr_b16 v[116:117], v161 offset:48640
    ds_read_b64_tr_b16 v[118:119], v161 offset:49664
    ds_read_b64_tr_b16 v[120:121], v161 offset:50176
    buffer_load_dwordx4 v158, s[12:15], s26 offen offset:1024 lds
    s_add_u32 s26, s26, 57344
    ds_read_b64_tr_b16 v[122:123], v161 offset:51200
    ds_read_b64_tr_b16 v[124:125], v161 offset:52224
    ds_read_b64_tr_b16 v[126:127], v161 offset:53248
    ds_read_b64_tr_b16 v[128:129], v161 offset:53760
    ds_read_b64_tr_b16 v[130:131], v161 offset:54784
    ds_read_b64_tr_b16 v[132:133], v161 offset:55808
    ds_read_b64_tr_b16 v[134:135], v161 offset:56832
    s_lshl_b32 s42, s3, 5
    v_xor_b32 v163, s42, v162
    v_add_u32 v163, s31, v163
    v_xor_b32 v164, 64, v163
    v_and_b32 v5, 31, v1
    v_lshlrev_b32 v152, 3, v1
    v_lshrrev_b32 v6, 5, v1
    s_lshl_b32 s40, s28, 12
    s_add_u32 s40, s40, 0xb90000
    s_lshl_b32 s39, s29, 8
    s_add_u32 s39, s39, s40
    s_mul_i32 s11, s3, 40960
    s_add_u32 s11, s11, 38912
    v_bfe_u32 v212, v1, 1, 3
    v_xor_b32 v212, v212, v6
    v_lshlrev_b32 v212, 3, v212
    v_lshl_add_u32 v212, v5, 6, v212
    v_add_u32 v214, s11, v212
    v_xor_b32 v215, 16, v214
    v_xor_b32 v216, 32, v214
    v_xor_b32 v217, 48, v214
    v_bfe_u32 v212, v1, 2, 2
    v_lshl_add_u32 v212, v6, 2, v212
    v_bfe_u32 v213, v1, 4, 1
    v_and_b32 v218, 3, v1
    v_lshl_add_u32 v213, v213, 2, v218
    v_lshrrev_b32 v218, 1, v212
    v_xor_b32 v213, v213, v218
    v_lshlrev_b32 v213, 3, v213
    v_lshl_add_u32 v212, v212, 6, v213
    v_add_u32 v218, s11, v212
    v_xor_b32 v219, 32, v218
    s_mul_i32 s38, s29, 149760
    s_lshr_b32 s11, s28, 4
    s_mul_i32 s11, s11, 4352
    s_add_u32 s38, s38, s11
    s_lshl_b32 s11, s28, 11
    s_add_u32 s38, s38, s11
    s_add_u32 s38, s38, 0x800000
    v_mov_b32 v220, 0
    s_waitcnt vmcnt(8)
    ds_read_b64_tr_b16 a[112:113], v163 offset:0
    ds_read_b64_tr_b16 a[114:115], v163 offset:1024
    ds_read_b64_tr_b16 a[116:117], v164 offset:0
    ds_read_b64_tr_b16 a[118:119], v164 offset:1024
    s_waitcnt vmcnt(6)
    ds_read_b64_tr_b16 a[120:121], v163 offset:2048
    ds_read_b64_tr_b16 a[122:123], v163 offset:3072
    ds_read_b64_tr_b16 a[124:125], v164 offset:2048
    ds_read_b64_tr_b16 a[126:127], v164 offset:3072
    s_waitcnt lgkmcnt(4)
    s_add_u32 m0, s31, 0
    s_nop 0
    buffer_load_dwordx4 v157, s[12:15], s26 offen lds
    buffer_load_dwordx4 v158, s[12:15], s26 offen offset:1024 lds
    s_add_u32 s26, s26, 57344
    s_waitcnt vmcnt(6)
    ds_read_b64_tr_b16 a[128:129], v163 offset:4096
    ds_read_b64_tr_b16 a[130:131], v163 offset:5120
    ds_read_b64_tr_b16 a[132:133], v164 offset:4096
    ds_read_b64_tr_b16 a[134:135], v164 offset:5120
    s_waitcnt lgkmcnt(4)
    buffer_load_dword v7, v195, s[20:23], s46 offen offset:2032 sc1
    s_add_u32 m0, s31, 2048
    s_nop 0
    buffer_load_dwordx4 v157, s[12:15], s26 offen lds
    buffer_load_dwordx4 v158, s[12:15], s26 offen offset:1024 lds
    s_add_u32 s26, s26, 57344
    s_waitcnt vmcnt(7)
    ds_read_b64_tr_b16 a[136:137], v163 offset:6144
    ds_read_b64_tr_b16 a[138:139], v163 offset:7168
    ds_read_b64_tr_b16 a[140:141], v164 offset:6144
    ds_read_b64_tr_b16 a[142:143], v164 offset:7168
    s_waitcnt lgkmcnt(4)
    s_add_u32 m0, s31, 4096
    s_nop 0
    buffer_load_dwordx4 v157, s[12:15], s26 offen lds
    buffer_load_dwordx4 v158, s[12:15], s26 offen offset:1024 lds
    s_add_u32 s26, s26, 57344
    s_waitcnt vmcnt(7)
    ds_read_b64_tr_b16 a[144:145], v163 offset:8192
    ds_read_b64_tr_b16 a[146:147], v163 offset:9216
    ds_read_b64_tr_b16 a[148:149], v164 offset:8192
    ds_read_b64_tr_b16 a[150:151], v164 offset:9216
    s_waitcnt lgkmcnt(4)
    s_add_u32 m0, s31, 6144
    s_nop 0
    buffer_load_dwordx4 v157, s[12:15], s26 offen lds
    buffer_load_dwordx4 v158, s[12:15], s26 offen offset:1024 lds
    s_add_u32 s26, s26, 57344
    s_waitcnt lgkmcnt(0)
    s_add_u32 m0, s31, 8192
    s_nop 0
    buffer_load_dwordx4 v157, s[12:15], s26 offen lds
    buffer_load_dwordx4 v158, s[12:15], s26 offen offset:1024 lds
    s_add_u32 s26, s26, 57344
    s_cmp_ge_u32 s26, s54
    s_cselect_b32 s42, 1835008, 0
    s_sub_u32 s26, s26, s42
    s_waitcnt vmcnt(8)
    s_branch Lm_ochk
Lm_oagain:
    buffer_load_dword v7, v195, s[20:23], s33 offen offset:2032 sc1
    s_waitcnt vmcnt(0)
Lm_ochk:
    s_sub_u32 s10, s10, 1
    s_cbranch_scc1 Lm_ogo
    v_cmp_eq_u32 vcc, -1, v7
    s_nop 4
    s_cbranch_vccnz Lm_oagain
Lm_ogo:
    s_add_u32 m0, s35, 0
    s_add_u32 s41, s34, 0
    buffer_load_dwordx4 v2, s[20:23], s41 offen offset:0 sc1 lds
    buffer_load_dwordx4 v2, s[20:23], s41 offen offset:2048 sc1 lds
    s_add_u32 m0, s35, 4096
    s_add_u32 s41, s34, 4096
    buffer_load_dwordx4 v2, s[20:23], s41 offen offset:0 sc1 lds
    buffer_load_dwordx4 v2, s[20:23], s41 offen offset:2048 sc1 lds
    s_add_u32 m0, s35, 8192
    s_add_u32 s41, s34, 8192
    buffer_load_dwordx4 v2, s[20:23], s41 offen offset:0 sc1 lds
    buffer_load_dwordx4 v2, s[20:23], s41 offen offset:2048 sc1 lds
    s_add_u32 m0, s35, 12288
    s_add_u32 s41, s34, 12288
    buffer_load_dwordx4 v2, s[20:23], s41 offen offset:0 sc1 lds
    buffer_load_dwordx4 v2, s[20:23], s41 offen offset:2048 sc1 lds
    s_add_u32 m0, s35, 16384
    s_add_u32 s41, s34, 16384
    buffer_load_dwordx4 v2, s[20:23], s41 offen offset:0 sc1 lds
    buffer_load_dwordx4 v2, s[20:23], s41 offen offset:2048 sc1 lds
    s_waitcnt vmcnt(10)
    ds_read_b64_tr_b16 a[152:153], v163 offset:0
    ds_read_b64_tr_b16 a[154:155], v163 offset:1024
    ds_read_b64_tr_b16 a[156:157], v164 offset:0
    ds_read_b64_tr_b16 a[158:159], v164 offset:1024
    ds_read_b64_tr_b16 a[160:161], v163 offset:2048
    ds_read_b64_tr_b16 a[162:163], v163 offset:3072
    ds_read_b64_tr_b16 a[164:165], v164 offset:2048
    ds_read_b64_tr_b16 a[166:167], v164 offset:3072
    ds_read_b64_tr_b16 a[168:169], v163 offset:4096
    ds_read_b64_tr_b16 a[170:171], v163 offset:5120
    ds_read_b64_tr_b16 a[172:173], v164 offset:4096
    ds_read_b64_tr_b16 a[174:175], v164 offset:5120
    ds_read_b64_tr_b16 a[176:177], v163 offset:6144
    ds_read_b64_tr_b16 a[178:179], v163 offset:7168
    ds_read_b64_tr_b16 a[180:181], v164 offset:6144
    ds_read_b64_tr_b16 a[182:183], v164 offset:7168
    ds_read_b64_tr_b16 a[184:185], v163 offset:8192
    ds_read_b64_tr_b16 a[186:187], v163 offset:9216
    ds_read_b64_tr_b16 a[188:189], v164 offset:8192
    ds_read_b64_tr_b16 a[190:191], v164 offset:9216
    s_add_u32 m0, s35, 20480
    s_add_u32 s41, s34, 20480
    buffer_load_dwordx4 v2, s[20:23], s41 offen offset:0 sc1 lds
    buffer_load_dwordx4 v2, s[20:23], s41 offen offset:2048 sc1 lds
    s_add_u32 m0, s35, 24576
    s_add_u32 s41, s34, 24576
    buffer_load_dwordx4 v2, s[20:23], s41 offen offset:0 sc1 lds
    buffer_load_dwordx4 v2, s[20:23], s41 offen offset:2048 sc1 lds
    s_add_u32 m0, s35, 28672
    s_add_u32 s41, s34, 28672
    buffer_load_dwordx4 v2, s[20:23], s41 offen offset:0 sc1 lds
    buffer_load_dwordx4 v2, s[20:23], s41 offen offset:2048 sc1 lds
    s_mov_b32 s36, s31
    v_mov_b32 v186, v163
    v_mov_b32 v187, v164
    s_mul_i32 s31, s3, 40960
    s_lshl_b32 s42, s3, 5
    v_xor_b32 v163, s42, v162
    v_add_u32 v163, s31, v163
    v_xor_b32 v164, 64, v163
    s_waitcnt lgkmcnt(0)
    s_waitcnt vmcnt(12)
    s_barrier
    ds_read_b128 v[136:139], v3 offset:0
    ds_read_b128 v[140:143], v3 offset:1024
    ds_read_b128 v[144:147], v3 offset:2048
    s_waitcnt lgkmcnt(2)
    v_mfma_f32_32x32x16_bf16 v[240:255], v[8:11], v[136:139], v[240:255]
    ds_read_b128 v[148:151], v3 offset:3072
    v_max3_u32 v220, v220, v136, v137
    v_max3_u32 v220, v220, v138, v139
    s_waitcnt lgkmcnt(2)
    v_mfma_f32_32x32x16_bf16 v[240:255], v[12:15], v[140:143], v[240:255]
    ds_read_b128 v[136:139], v3 offset:4096
    v_max3_u32 v220, v220, v140, v141
    v_max3_u32 v220, v220, v142, v143
    s_waitcnt lgkmcnt(2)
    v_mfma_f32_32x32x16_bf16 v[240:255], v[16:19], v[144:147], v[240:255]
    ds_read_b128 v[140:143], v3 offset:5120
    v_max3_u32 v220, v220, v144, v145
    v_max3_u32 v220, v220, v146, v147
    s_waitcnt lgkmcnt(2)
    v_mfma_f32_32x32x16_bf16 v[240:255], v[20:23], v[148:151], v[240:255]
    ds_read_b128 v[144:147], v3 offset:6144
    v_max3_u32 v220, v220, v148, v149
    v_max3_u32 v220, v220, v150, v151
    s_waitcnt lgkmcnt(2)
    v_mfma_f32_32x32x16_bf16 v[240:255], v[24:27], v[136:139], v[240:255]
    ds_read_b128 v[148:151], v3 offset:7168
    v_max3_u32 v220, v220, v136, v137
    v_max3_u32 v220, v220, v138, v139
    s_waitcnt lgkmcnt(2)
    v_mfma_f32_32x32x16_bf16 v[240:255], v[28:31], v[140:143], v[240:255]
    s_waitcnt vmcnt(8)
    s_barrier
    ds_read_b128 v[136:139], v3 offset:8192
    v_max3_u32 v220, v220, v140, v141
    v_max3_u32 v220, v220, v142, v143
    s_waitcnt lgkmcnt(2)
    v_mfma_f32_32x32x16_bf16 v[240:255], v[32:35], v[144:147], v[240:255]
    ds_read_b128 v[140:143], v3 offset:9216
    s_add_u32 m0, s36, 0
    s_nop 0
    buffer_load_dwordx4 v157, s[12:15], s26 offen lds
    v_max3_u32 v220, v220, v144, v145
    v_max3_u32 v220, v220, v146, v147
    s_waitcnt lgkmcnt(2)
    v_mfma_f32_32x32x16_bf16 v[240:255], v[36:39], v[148:151], v[240:255]
    ds_read_b128 v[144:147], v3 offset:10240
    v_max3_u32 v220, v220, v148, v149
    v_max3_u32 v220, v220, v150, v151
    s_waitcnt lgkmcnt(2)
    v_mfma_f32_32x32x16_bf16 v[240:255], v[40:43], v[136:139], v[240:255]
    ds_read_b128 v[148:151], v3 offset:11264
    buffer_load_dwordx4 v158, s[12:15], s26 offen offset:1024 lds
    s_add_u32 s26, s26, 57344
    v_max3_u32 v220, v220, v136, v137
    v_max3_u32 v220, v220, v138, v139
    s_waitcnt lgkmcnt(2)
    v_mfma_f32_32x32x16_bf16 v[240:255], v[44:47], v[140:143], v[240:255]
    ds_read_b128 v[136:139], v3 offset:12288
    v_max3_u32 v220, v220, v140, v141
    v_max3_u32 v220, v220, v142, v143
    s_waitcnt lgkmcnt(2)
    v_mfma_f32_32x32x16_bf16 v[240:255], v[48:51], v[144:147], v[240:255]
    ds_read_b128 v[140:143], v3 offset:13312
    v_max3_u32 v220, v220, v144, v145
    v_max3_u32 v220, v220, v146, v147
    s_waitcnt lgkmcnt(2)
    v_mfma_f32_32x32x16_bf16 v[240:255], v[52:55], v[148:151], v[240:255]
    ds_read_b128 v[144:147], v3 offset:14336
    s_add_u32 m0, s36, 2048
    s_nop 0
    buffer_load_dwordx4 v157, s[12:15], s26 offen lds
    v_max3_u32 v220, v220, v148, v149
    v_max3_u32 v220, v220, v150, v151
    s_waitcnt lgkmcnt(2)
    v_mfma_f32_32x32x16_bf16 v[240:255], v[56:59], v[136:139], v[240:255]
    ds_read_b128 v[148:151], v3 offset:15360
    v_max3_u32 v220, v220, v136, v137
    v_max3_u32 v220, v220, v138, v139
    s_waitcnt lgkmcnt(2)
    v_mfma_f32_32x32x16_bf16 v[240:255], v[60:63], v[140:143], v[240:255]
    s_waitcnt vmcnt(7)
    s_barrier
    ds_read_b128 v[136:139], v3 offset:16384
    buffer_load_dwordx4 v158, s[12:15], s26 offen offset:1024 lds
    s_add_u32 s26, s26, 57344
    v_max3_u32 v220, v220, v140, v141
    v_max3_u32 v220, v220, v142, v143
    s_waitcnt lgkmcnt(2)
    v_mfma_f32_32x32x16_bf16 v[240:255], v[64:67], v[144:147], v[240:255]
    ds_read_b128 v[140:143], v3 offset:17408
    v_max3_u32 v220, v220, v144, v145
    v_max3_u32 v220, v220, v146, v147
    s_waitcnt lgkmcnt(2)
    v_mfma_f32_32x32x16_bf16 v[240:255], v[68:71], v[148:151], v[240:255]
    ds_read_b128 v[144:147], v3 offset:18432
    v_max3_u32 v220, v220, v148, v149
    v_max3_u32 v220, v220, v150, v151
    s_waitcnt lgkmcnt(2)
    v_mfma_f32_32x32x16_bf16 v[240:255], v[72:75], v[136:139], v[240:255]
    ds_read_b128 v[148:151], v3 offset:19456
    s_add_u32 m0, s36, 4096
    s_nop 0
    buffer_load_dwordx4 v157, s[12:15], s26 offen lds
    v_max3_u32 v220, v220, v136, v137
    v_max3_u32 v220, v220, v138, v139
    s_waitcnt lgkmcnt(2)
    v_mfma_f32_32x32x16_bf16 v[240:255], v[76:79], v[140:143], v[240:255]
    ds_read_b128 v[136:139], v3 offset:20480
    v_max3_u32 v220, v220, v140, v141
    v_max3_u32 v220, v220, v142, v143
    s_waitcnt lgkmcnt(2)
    v_mfma_f32_32x32x16_bf16 v[240:255], v[80:83], v[144:147], v[240:255]
    ds_read_b128 v[140:143], v3 offset:21504
    v_max3_u32 v220, v220, v144, v145
    v_max3_u32 v220, v220, v146, v147
    s_waitcnt lgkmcnt(2)
    v_mfma_f32_32x32x16_bf16 v[240:255], v[84:87], v[148:151], v[240:255]
    ds_read_b128 v[144:147], v3 offset:22528
    buffer_load_dwordx4 v158, s[12:15], s26 offen offset:1024 lds
    s_add_u32 s26, s26, 57344
    v_max3_u32 v220, v220, v148, v149
    v_max3_u32 v220, v220, v150, v151
    s_waitcnt lgkmcnt(2)
    v_mfma_f32_32x32x16_bf16 v[240:255], v[88:91], v[136:139], v[240:255]
    ds_read_b128 v[148:151], v3 offset:23552
    v_max3_u32 v220, v220, v136, v137
    v_max3_u32 v220, v220, v138, v139
    s_waitcnt lgkmcnt(2)
    v_mfma_f32_32x32x16_bf16 v[240:255], v[92:95], v[140:143], v[240:255]
    s_waitcnt vmcnt(6)
    s_barrier
    ds_read_b128 v[136:139], v3 offset:24576
    s_add_u32 m0, s36, 6144
    s_nop 0
    buffer_load_dwordx4 v157, s[12:15], s26 offen lds
    v_max3_u32 v220, v220, v140, v141
    v_max3_u32 v220, v220, v142, v143
    s_waitcnt lgkmcnt(2)
    v_mfma_f32_32x32x16_bf16 v[240:255], v[96:99], v[144:147], v[240:255]
    ds_read_b128 v[140:143], v3 offset:25600
    v_max3_u32 v220, v220, v144, v145
    v_max3_u32 v220, v220, v146, v147
    s_waitcnt lgkmcnt(2)
    v_mfma_f32_32x32x16_bf16 v[240:255], v[100:103], v[148:151], v[240:255]
    ds_read_b128 v[144:147], v3 offset:26624
    v_max3_u32 v220, v220, v148, v149
    v_max3_u32 v220, v220, v150, v151
    s_waitcnt lgkmcnt(2)
    v_mfma_f32_32x32x16_bf16 v[240:255], v[104:107], v[136:139], v[240:255]
    ds_read_b128 v[148:151], v3 offset:27648
    buffer_load_dwordx4 v158, s[12:15], s26 offen offset:1024 lds
    s_add_u32 s26, s26, 57344
    v_max3_u32 v220, v220, v136, v137
    v_max3_u32 v220, v220, v138, v139
    s_waitcnt lgkmcnt(2)
    v_mfma_f32_32x32x16_bf16 v[240:255], v[108:111], v[140:143], v[240:255]
    ds_read_b128 v[136:139], v3 offset:28672
    v_max3_u32 v220, v220, v140, v141
    v_max3_u32 v220, v220, v142, v143
    s_waitcnt lgkmcnt(2)
    v_mfma_f32_32x32x16_bf16 v[240:255], v[112:115], v[144:147], v[240:255]
    ds_read_b128 v[140:143], v3 offset:29696
    s_add_u32 m0, s36, 8192
    s_nop 0
    buffer_load_dwordx4 v157, s[12:15], s26 offen lds
    v_max3_u32 v220, v220, v144, v145
    v_max3_u32 v220, v220, v146, v147
    s_waitcnt lgkmcnt(2)
    v_mfma_f32_32x32x16_bf16 v[240:255], v[116:119], v[148:151], v[240:255]
    ds_read_b128 v[144:147], v3 offset:30720
    v_max3_u32 v220, v220, v148, v149
    v_max3_u32 v220, v220, v150, v151
    s_waitcnt lgkmcnt(2)
    v_mfma_f32_32x32x16_bf16 v[240:255], v[120:123], v[136:139], v[240:255]
    ds_read_b128 v[148:151], v3 offset:31744
    v_max3_u32 v220, v220, v136, v137
    v_max3_u32 v220, v220, v138, v139
    s_waitcnt lgkmcnt(2)
    v_mfma_f32_32x32x16_bf16 v[240:255], v[124:127], v[140:143], v[240:255]
    buffer_load_dwordx4 v158, s[12:15], s26 offen offset:1024 lds
    s_add_u32 s26, s26, 57344
    v_max3_u32 v220, v220, v140, v141
    v_max3_u32 v220, v220, v142, v143
    s_waitcnt lgkmcnt(1)
    v_mfma_f32_32x32x16_bf16 v[240:255], v[128:131], v[144:147], v[240:255]
    v_max3_u32 v220, v220, v144, v145
    v_max3_u32 v220, v220, v146, v147
    s_waitcnt lgkmcnt(0)
    v_mfma_f32_32x32x16_bf16 v[240:255], v[132:135], v[148:151], v[240:255]
    v_max3_u32 v220, v220, v148, v149
    v_max3_u32 v220, v220, v150, v151
    v_cmp_eq_u32 vcc, -1, v220
    s_nop 4
    s_cbranch_vccnz Lm_oslow
Lm_odone:
    s_nop 2
    v_pk_add_f32 v[10:11], v[240:241], v[242:243]
    v_pk_mul_f32 v[12:13], v[240:241], v[240:241]
    v_pk_fma_f32 v[12:13], v[242:243], v[242:243], v[12:13]
    v_pk_fma_f32 v[12:13], v[244:245], v[244:245], v[12:13]
    v_pk_add_f32 v[10:11], v[10:11], v[244:245]
    v_pk_fma_f32 v[12:13], v[246:247], v[246:247], v[12:13]
    v_pk_add_f32 v[10:11], v[10:11], v[246:247]
    v_pk_fma_f32 v[12:13], v[248:249], v[248:249], v[12:13]
    v_pk_add_f32 v[10:11], v[10:11], v[248:249]
    v_pk_fma_f32 v[12:13], v[250:251], v[250:251], v[12:13]
    v_pk_add_f32 v[10:11], v[10:11], v[250:251]
    v_pk_fma_f32 v[12:13], v[252:253], v[252:253], v[12:13]
    v_pk_add_f32 v[10:11], v[10:11], v[252:253]
    v_pk_fma_f32 v[12:13], v[254:255], v[254:255], v[12:13]
    v_pk_add_f32 v[10:11], v[10:11], v[254:255]
    v_add_f32 v8, v10, v11
    v_add_f32 v9, v12, v13
    v_mov_b32 v10, v8
    v_mov_b32 v11, v9
    s_nop 0
    v_permlane32_swap_b32 v8, v10
    v_permlane32_swap_b32 v9, v11
    v_add_f32 v8, v8, v10
    v_add_f32 v9, v9, v11
    v_min_u32 v8, -2, v8
    v_min_u32 v9, -2, v9
    s_mov_b32 exec_hi, 0
    buffer_store_dwordx2 v[8:9], v152, s[20:23], s39 offen sc1
    s_mov_b32 exec_hi, -1
    s_waitcnt vmcnt(1)
    ds_read_b64_tr_b16 a[192:193], v186 offset:0
    ds_read_b64_tr_b16 a[194:195], v186 offset:1024
    ds_read_b64_tr_b16 a[196:197], v187 offset:0
    ds_read_b64_tr_b16 a[198:199], v187 offset:1024
    ds_read_b64_tr_b16 a[200:201], v186 offset:2048
    ds_read_b64_tr_b16 a[202:203], v186 offset:3072
    ds_read_b64_tr_b16 a[204:205], v187 offset:2048
    ds_read_b64_tr_b16 a[206:207], v187 offset:3072
    ds_read_b64_tr_b16 a[208:209], v186 offset:4096
    ds_read_b64_tr_b16 a[210:211], v186 offset:5120
    ds_read_b64_tr_b16 a[212:213], v187 offset:4096
    ds_read_b64_tr_b16 a[214:215], v187 offset:5120
    ds_read_b64_tr_b16 a[216:217], v186 offset:6144
    ds_read_b64_tr_b16 a[218:219], v186 offset:7168
    ds_read_b64_tr_b16 a[220:221], v187 offset:6144
    ds_read_b64_tr_b16 a[222:223], v187 offset:7168
    ds_read_b64_tr_b16 a[224:225], v186 offset:8192
    ds_read_b64_tr_b16 a[226:227], v186 offset:9216
    ds_read_b64_tr_b16 a[228:229], v187 offset:8192
    ds_read_b64_tr_b16 a[230:231], v187 offset:9216
    s_waitcnt lgkmcnt(0)
    s_barrier
    s_add_u32 m0, s31, 20480
    s_nop 0
    buffer_load_dwordx4 v157, s[12:15], s26 offen lds
    buffer_load_dwordx4 v158, s[12:15], s26 offen offset:1024 lds
    s_add_u32 s26, s26, 57344
    s_add_u32 m0, s31, 22528
    s_nop 0
    buffer_load_dwordx4 v157, s[12:15], s26 offen lds
    buffer_load_dwordx4 v158, s[12:15], s26 offen offset:1024 lds
    s_add_u32 s26, s26, 57344
    s_add_u32 m0, s31, 24576
    s_nop 0
    buffer_load_dwordx4 v157, s[12:15], s26 offen lds
    buffer_load_dwordx4 v158, s[12:15], s26 offen offset:1024 lds
    s_add_u32 s26, s26, 57344
    s_add_u32 m0, s31, 26624
    s_nop 0
    buffer_load_dwordx4 v159, s[16:19], s27 offen lds
    buffer_load_dwordx4 v160, s[16:19], s27 offen offset:1024 lds
    s_add_u32 s27, s27, 65536
    s_add_u32 m0, s31, 28672
    s_nop 0
    buffer_load_dwordx4 v159, s[16:19], s27 offen lds
    buffer_load_dwordx4 v160, s[16:19], s27 offen offset:1024 lds
    s_add_u32 s27, s27, 65536
    buffer_load_dwordx2 v[20:21], v152, s[20:23], s40 offen offset:0 sc1
    buffer_load_dwordx2 v[22:23], v152, s[20:23], s40 offen offset:512 sc1
    buffer_load_dwordx2 v[24:25], v152, s[20:23], s40 offen offset:1024 sc1
    buffer_load_dwordx2 v[26:27], v152, s[20:23], s40 offen offset:1536 sc1
    buffer_load_dwordx2 v[28:29], v152, s[20:23], s40 offen offset:2048 sc1
    buffer_load_dwordx2 v[30:31], v152, s[20:23], s40 offen offset:2560 sc1
    buffer_load_dwordx2 v[32:33], v152, s[20:23], s40 offen offset:3072 sc1
    s_add_u32 m0, s31, 30720
    s_nop 0
    buffer_load_dwordx4 v159, s[16:19], s27 offen lds
    buffer_load_dwordx4 v160, s[16:19], s27 offen offset:1024 lds
    s_add_u32 s27, s27, 65536
    s_add_u32 m0, s31, 32768
    s_nop 0
    buffer_load_dwordx4 v159, s[16:19], s27 offen lds
    buffer_load_dwordx4 v160, s[16:19], s27 offen offset:1024 lds
    s_add_u32 s27, s27, 65536
    s_add_u32 m0, s31, 34816
    s_nop 0
    buffer_load_dwordx4 v159, s[16:19], s27 offen lds
    buffer_load_dwordx4 v160, s[16:19], s27 offen offset:1024 lds
    s_add_u32 s27, s27, 65536
    s_add_u32 m0, s31, 36864
    s_nop 0
    buffer_load_dwordx4 v159, s[16:19], s27 offen lds
    buffer_load_dwordx4 v160, s[16:19], s27 offen offset:1024 lds
    s_add_u32 s27, s27, 65536
    s_add_u32 m0, s31, 0
    s_nop 0
    buffer_load_dwordx4 v159, s[16:19], s27 offen lds
    buffer_load_dwordx4 v160, s[16:19], s27 offen offset:1024 lds
    s_add_u32 s27, s27, 65536
    s_cmp_ge_u32 s27, s55
    s_cselect_b32 s42, 1835008, 0
    s_sub_u32 s27, s27, s42
    s_mov_b32 s10, 1048576
    s_waitcnt vmcnt(10)
    s_branch Lm_pchk
Lm_pst:
    buffer_load_dwordx2 v[20:21], v152, s[20:23], s40 offen offset:0 sc1
    buffer_load_dwordx2 v[22:23], v152, s[20:23], s40 offen offset:512 sc1
    buffer_load_dwordx2 v[24:25], v152, s[20:23], s40 offen offset:1024 sc1
    buffer_load_dwordx2 v[26:27], v152, s[20:23], s40 offen offset:1536 sc1
    buffer_load_dwordx2 v[28:29], v152, s[20:23], s40 offen offset:2048 sc1
    buffer_load_dwordx2 v[30:31], v152, s[20:23], s40 offen offset:2560 sc1
    buffer_load_dwordx2 v[32:33], v152, s[20:23], s40 offen offset:3072 sc1
    s_waitcnt vmcnt(0)
Lm_pchk:
    v_max3_u32 v10, v20, v21, v22
    v_max3_u32 v11, v23, v24, v25
    v_max3_u32 v10, v10, v26, v27
    v_max3_u32 v11, v11, v28, v29
    v_max3_u32 v10, v10, v30, v31
    v_max3_u32 v11, v11, v32, v33
    v_max_u32 v10, v10, v11
    s_sub_u32 s10, s10, 1
    s_cbranch_scc1 Lm_pste
    v_cmp_eq_u32 vcc, -1, v10
    s_nop 4
    s_cbranch_vccnz Lm_pst
Lm_pste:
    v_pk_add_f32 v[20:21], v[20:21], v[28:29]
    v_pk_add_f32 v[22:23], v[22:23], v[30:31]
    v_pk_add_f32 v[24:25], v[24:25], v[32:33]
    v_pk_add_f32 v[20:21], v[20:21], v[26:27]
    v_pk_add_f32 v[22:23], v[22:23], v[24:25]
    v_pk_add_f32 v[8:9], v[20:21], v[22:23]
    v_mov_b32 v10, v8
    v_mov_b32 v11, v9
    s_mov_b32 s41, 0x3727c5ac
    v_permlane32_swap_b32 v8, v10
    v_permlane32_swap_b32 v9, v11
    v_add_f32 v8, v8, v10
    v_add_f32 v9, v9, v11
    v_mul_f32 v8, 0xbb124925, v8
    v_mul_f32 v9, 0x3b124925, v9
    v_fma_f32 v9, -v8, v8, v9
    v_max_f32 v9, 0, v9
    v_add_f32 v10, s41, v9
    v_fma_f32 v9, v10, s41, v9
    v_rsq_f32 v9, v9
    s_nop 0
    v_mul_f32 v8, v8, v9
    v_pk_fma_f32 v[20:21], v[240:241], v[8:9], v[8:9] op_sel:[0,1,0] op_sel_hi:[1,1,0]
    v_pk_fma_f32 v[22:23], v[242:243], v[8:9], v[8:9] op_sel:[0,1,0] op_sel_hi:[1,1,0]
    v_cvt_pk_bf16_f32 v36, v20, v21
    v_cvt_pk_bf16_f32 v37, v22, v23
    ds_write_b64 v214, v[36:37]
    v_pk_fma_f32 v[24:25], v[244:245], v[8:9], v[8:9] op_sel:[0,1,0] op_sel_hi:[1,1,0]
    v_pk_fma_f32 v[26:27], v[246:247], v[8:9], v[8:9] op_sel:[0,1,0] op_sel_hi:[1,1,0]
    v_cvt_pk_bf16_f32 v38, v24, v25
    v_cvt_pk_bf16_f32 v39, v26, v27
    ds_write_b64 v215, v[38:39]
    v_pk_fma_f32 v[28:29], v[248:249], v[8:9], v[8:9] op_sel:[0,1,0] op_sel_hi:[1,1,0]
    v_pk_fma_f32 v[30:31], v[250:251], v[8:9], v[8:9] op_sel:[0,1,0] op_sel_hi:[1,1,0]
    v_cvt_pk_bf16_f32 v40, v28, v29
    v_cvt_pk_bf16_f32 v41, v30, v31
    ds_write_b64 v216, v[40:41]
    v_pk_fma_f32 v[32:33], v[252:253], v[8:9], v[8:9] op_sel:[0,1,0] op_sel_hi:[1,1,0]
    v_pk_fma_f32 v[34:35], v[254:255], v[8:9], v[8:9] op_sel:[0,1,0] op_sel_hi:[1,1,0]
    v_cvt_pk_bf16_f32 v42, v32, v33
    v_cvt_pk_bf16_f32 v43, v34, v35
    ds_write_b64 v217, v[42:43]
    ds_read_b64_tr_b16 v[44:45], v218 offset:0
    ds_read_b64_tr_b16 v[46:47], v219 offset:512
    ds_read_b64_tr_b16 v[48:49], v218 offset:1024
    ds_read_b64_tr_b16 v[50:51], v219 offset:1536
    s_waitcnt lgkmcnt(2)
    v_min_u32 v44, -2, v44
    v_min_u32 v45, -2, v45
    v_min_u32 v46, -2, v46
    v_min_u32 v47, -2, v47
    buffer_store_dwordx4 v[44:47], v2, s[20:23], s38 offen offset:0 sc1
    s_waitcnt lgkmcnt(0)
    v_min_u32 v48, -2, v48
    v_min_u32 v49, -2, v49
    v_min_u32 v50, -2, v50
    v_min_u32 v51, -2, v51
    buffer_store_dwordx4 v[48:51], v2, s[20:23], s38 offen offset:1024 sc1
    s_waitcnt vmcnt(2)
    s_lshl_b32 s42, s3, 6
    s_and_b32 s42, s42, 64
    v_xor_b32 v154, s42, v162
    v_add_u32 v154, s31, v154
    v_xor_b32 v155, 64, v154
    s_add_u32 m0, s31, 2048
    s_nop 0
    buffer_load_dwordx4 v159, s[16:19], s27 offen lds
    s_and_b32 s30, s30, 14
    ds_read_b64_tr_b16 a[232:233], v163 offset:20480
    s_mul_i32 s41, s3, 37120
    s_mul_i32 s33, s30, 149760
    ds_read_b64_tr_b16 a[234:235], v163 offset:21504
    s_add_u32 s33, s33, s41
    s_add_u32 s33, s33, 0x800000
    buffer_load_dwordx4 v160, s[16:19], s27 offen offset:1024 lds
    s_add_u32 s27, s27, 65536
    s_mul_i32 s36, s53, 8192
    s_add_u32 s36, s36, s33
    ds_read_b64_tr_b16 a[236:237], v164 offset:20480
    v_bfe_u32 v153, v1, 4, 1
    v_mul_u32_u24 v153, 149760, v153
    ds_read_b64_tr_b16 a[238:239], v164 offset:21504
    v_and_b32 v5, 15, v1
    v_lshl_add_u32 v153, v5, 11, v153
    s_add_u32 m0, s31, 4096
    s_nop 0
    buffer_load_dwordx4 v159, s[16:19], s27 offen lds
    s_mov_b32 s10, 1048576
    s_xor_b32 s40, s3, 1
    ds_read_b64_tr_b16 a[240:241], v163 offset:22528
    s_mul_i32 s40, s40, 40960
    s_add_u32 s40, s40, 28672
    ds_read_b64_tr_b16 a[242:243], v163 offset:23552
    v_add_u32 v4, s40, v2
    s_xor_b32 s40, s3, 2
    buffer_load_dwordx4 v160, s[16:19], s27 offen offset:1024 lds
    s_add_u32 s27, s27, 65536
    s_mul_i32 s40, s40, 40960
    s_add_u32 s40, s40, 30720
    ds_read_b64_tr_b16 a[244:245], v164 offset:22528
    v_add_u32 v5, s40, v2
    ds_read_b64_tr_b16 a[246:247], v164 offset:23552
    s_xor_b32 s40, s3, 3
    s_mul_i32 s40, s40, 40960
    s_add_u32 m0, s31, 6144
    s_nop 0
    buffer_load_dwordx4 v159, s[16:19], s27 offen lds
    s_add_u32 s40, s40, 32768
    v_add_u32 v6, s40, v2
    ds_read_b64_tr_b16 a[248:249], v163 offset:24576
    s_add_u32 s40, s31, 28672
    v_add_u32 v3, s40, v2
    ds_read_b64_tr_b16 a[250:251], v163 offset:25600
    v_lshlrev_b32 v136, 16, v232
    v_and_b32 v137, 0xffff0000, v232
    buffer_load_dwordx4 v160, s[16:19], s27 offen offset:1024 lds
    s_add_u32 s27, s27, 65536
    v_lshlrev_b32 v138, 16, v233
    v_and_b32 v139, 0xffff0000, v233
    ds_read_b64_tr_b16 a[252:253], v164 offset:24576
    v_lshlrev_b32 v140, 16, v234
    v_and_b32 v141, 0xffff0000, v234
    ds_read_b64_tr_b16 a[254:255], v164 offset:25600
    v_lshlrev_b32 v142, 16, v235
    v_and_b32 v143, 0xffff0000, v235
    s_add_u32 m0, s31, 8192
    s_nop 0
    buffer_load_dwordx4 v159, s[16:19], s27 offen lds
    v_mov_b32 v144, 0
    v_mov_b32 v145, 0
    ds_read_b64_tr_b16 v[168:169], v154 offset:26624
    v_mov_b32 v146, 0
    v_mov_b32 v147, 0
    ds_read_b64_tr_b16 v[170:171], v154 offset:27648
    v_mov_b32 v148, 0
    v_mov_b32 v149, 0
    buffer_load_dwordx4 v160, s[16:19], s27 offen offset:1024 lds
    s_add_u32 s27, s27, 65536
    v_mov_b32 v150, 0
    ds_read_b64_tr_b16 v[172:173], v155 offset:26624
    v_mov_b32 v151, 0
    v_mov_b32 v224, 0xbdd2d3e8
    ds_read_b64_tr_b16 v[174:175], v155 offset:27648
    v_mov_b32 v226, 0xc0135761
    s_mul_i32 s39, s30, 56
    s_add_u32 m0, s31, 10240
    s_nop 0
    buffer_load_dwordx4 v159, s[16:19], s27 offen lds
    s_add_u32 s39, s39, s32
    s_lshl_b32 s39, s39, 1
    ds_read_b64_tr_b16 v[176:177], v154 offset:28672
    s_and_b32 s40, s3, 1
    s_add_u32 s39, s39, s40
    ds_read_b64_tr_b16 v[178:179], v154 offset:29696
    s_lshl_b32 s39, s39, 10
    s_add_u32 s39, s39, 0xa00000
    buffer_load_dwordx4 v160, s[16:19], s27 offen offset:1024 lds
    s_add_u32 s27, s27, 65536
    s_and_b32 s40, s29, 14
    s_mul_i32 s35, s40, 114688
    ds_read_b64_tr_b16 v[180:181], v155 offset:28672
    s_mul_i32 s40, s3, 28672
    s_add_u32 s35, s35, s40
    ds_read_b64_tr_b16 v[182:183], v155 offset:29696
    s_add_u32 s35, s35, 0xa00000
    s_add_u32 s37, s35, 114688
    s_add_u32 m0, s31, 12288
    s_nop 0
    buffer_load_dwordx4 v159, s[16:19], s27 offen lds
    v_min_u32 v228, 27, v1
    v_lshlrev_b32 v228, 10, v228
    ds_read_b64_tr_b16 v[184:185], v154 offset:30720
    v_lshlrev_b32 v231, 16, v231
    v_add_f32 v240, v240, v231
    ds_read_b64_tr_b16 v[186:187], v154 offset:31744
    v_add_f32 v241, v241, v231
    buffer_load_dwordx4 v160, s[16:19], s27 offen offset:1024 lds
    s_add_u32 s27, s27, 65536
    v_add_f32 v242, v242, v231
    v_add_f32 v243, v243, v231
    ds_read_b64_tr_b16 v[188:189], v155 offset:30720
    v_add_f32 v244, v244, v231
    v_add_f32 v245, v245, v231
    ds_read_b64_tr_b16 v[190:191], v155 offset:31744
    v_add_f32 v246, v246, v231
    v_add_f32 v247, v247, v231
    s_add_u32 m0, s31, 14336
    s_nop 0
    buffer_load_dwordx4 v159, s[16:19], s27 offen lds
    v_add_f32 v248, v248, v231
    v_add_f32 v249, v249, v231
    ds_read_b64_tr_b16 v[192:193], v154 offset:32768
    v_add_f32 v250, v250, v231
    v_add_f32 v251, v251, v231
    ds_read_b64_tr_b16 v[194:195], v154 offset:33792
    v_add_f32 v252, v252, v231
    v_add_f32 v253, v253, v231
    buffer_load_dwordx4 v160, s[16:19], s27 offen offset:1024 lds
    s_add_u32 s27, s27, 65536
    s_cmp_ge_u32 s27, s55
    s_cselect_b32 s42, 1835008, 0
    s_sub_u32 s27, s27, s42
    v_add_f32 v254, v254, v231
    v_add_f32 v255, v255, v231
    ds_read_b64_tr_b16 v[196:197], v155 offset:32768
    s_and_b32 s40, s3, 1
    s_xor_b32 s40, s40, 0
    ds_read_b64_tr_b16 v[198:199], v155 offset:33792
    s_mul_i32 s40, s40, 40960
    s_lshl_b32 s11, s3, 12
    s_add_u32 m0, s31, 16384
    s_nop 0
    buffer_load_dwordx4 v159, s[16:19], s27 offen lds
    s_add_u32 s40, s40, s11
    v_add_u32 v216, s40, v2
    ds_read_b64_tr_b16 v[200:201], v154 offset:34816
    s_and_b32 s40, s3, 1
    ds_read_b64_tr_b16 v[202:203], v154 offset:35840
    s_xor_b32 s40, s40, 1
    s_mul_i32 s40, s40, 40960
    buffer_load_dwordx4 v160, s[16:19], s27 offen offset:1024 lds
    s_add_u32 s27, s27, 65536
    s_lshl_b32 s11, s3, 12
    s_add_u32 s40, s40, s11
    ds_read_b64_tr_b16 v[204:205], v155 offset:34816
    v_add_u32 v217, s40, v2
    s_and_b32 s40, s3, 1
    ds_read_b64_tr_b16 v[206:207], v155 offset:35840
    s_xor_b32 s40, s40, 2
    s_mul_i32 s40, s40, 40960
    s_add_u32 m0, s31, 18432
    s_nop 0
    buffer_load_dwordx4 v159, s[16:19], s27 offen lds
    s_lshl_b32 s11, s3, 12
    s_add_u32 s40, s40, s11
    ds_read_b64_tr_b16 v[208:209], v154 offset:36864
    v_add_u32 v218, s40, v2
    s_and_b32 s40, s3, 1
    ds_read_b64_tr_b16 v[210:211], v154 offset:37888
    s_xor_b32 s40, s40, 3
    s_mul_i32 s40, s40, 40960
    buffer_load_dwordx4 v160, s[16:19], s27 offen offset:1024 lds
    s_add_u32 s27, s27, 65536
    s_lshl_b32 s11, s3, 12
    s_add_u32 s40, s40, s11
    ds_read_b64_tr_b16 v[212:213], v155 offset:36864
    v_add_u32 v219, s40, v2
    v_add_u32 v220, s31, v2
    ds_read_b64_tr_b16 v[214:215], v155 offset:37888
    s_mov_b64 s[4:5], s[100:101]
    s_mov_b32 s6, 0x1c0000
    s_mov_b32 s38, s27
    s_waitcnt lgkmcnt(0)
    s_barrier
    buffer_load_dword v7, v153, s[96:99], s33 offen offset:2044 sc1
    s_add_u32 s34, s36, 0
    s_add_u32 s41, s33, 32768
    buffer_load_dwordx4 v[72:75], v2, s[96:99], s34 offen offset:0 sc1
    buffer_load_dwordx4 v[76:79], v2, s[96:99], s34 offen offset:1024 sc1
    buffer_load_dwordx4 v[80:83], v2, s[96:99], s34 offen offset:2048 sc1
    buffer_load_dwordx4 v[84:87], v2, s[96:99], s34 offen offset:3072 sc1
    s_add_u32 s34, s34, 4096
    buffer_load_dwordx4 v[88:91], v2, s[96:99], s34 offen offset:0 sc1
    buffer_load_dwordx4 v[92:95], v2, s[96:99], s34 offen offset:1024 sc1
    buffer_load_dwordx4 v[96:99], v2, s[96:99], s34 offen offset:2048 sc1
    buffer_load_dwordx4 v[100:103], v2, s[96:99], s34 offen offset:3072 sc1
    s_add_u32 s34, s34, 4096
    s_cmp_ge_u32 s34, s41
    s_cselect_b32 s11, 32768, 0
    s_sub_u32 s34, s34, s11
    buffer_load_dwordx4 v[104:107], v2, s[96:99], s34 offen offset:0 sc1
    buffer_load_dwordx4 v[108:111], v2, s[96:99], s34 offen offset:1024 sc1
    buffer_load_dwordx4 v[112:115], v2, s[96:99], s34 offen offset:2048 sc1
    buffer_load_dwordx4 v[116:119], v2, s[96:99], s34 offen offset:3072 sc1
    s_add_u32 s34, s34, 4096
    s_waitcnt vmcnt(12) lgkmcnt(0)
    v_cmp_eq_u32 vcc, -1, v7
    s_nop 4
    s_cbranch_vccz Lm_g1_run
Lm_g1_again:
    buffer_load_dword v7, v153, s[96:99], s33 offen offset:2044 sc1
    s_sub_u32 s10, s10, 1
    s_cbranch_scc1 Lm_g1_againe
    s_waitcnt vmcnt(0)
    v_cmp_eq_u32 vcc, -1, v7
    s_nop 4
    s_cbranch_vccnz Lm_g1_again
Lm_g1_againe:
    s_add_u32 s34, s36, 0
    s_add_u32 s41, s33, 32768
    buffer_load_dwordx4 v[72:75], v2, s[96:99], s34 offen offset:0 sc1
    buffer_load_dwordx4 v[76:79], v2, s[96:99], s34 offen offset:1024 sc1
    buffer_load_dwordx4 v[80:83], v2, s[96:99], s34 offen offset:2048 sc1
    buffer_load_dwordx4 v[84:87], v2, s[96:99], s34 offen offset:3072 sc1
    s_add_u32 s34, s34, 4096
    buffer_load_dwordx4 v[88:91], v2, s[96:99], s34 offen offset:0 sc1
    buffer_load_dwordx4 v[92:95], v2, s[96:99], s34 offen offset:1024 sc1
    buffer_load_dwordx4 v[96:99], v2, s[96:99], s34 offen offset:2048 sc1
    buffer_load_dwordx4 v[100:103], v2, s[96:99], s34 offen offset:3072 sc1
    s_add_u32 s34, s34, 4096
    s_cmp_ge_u32 s34, s41
    s_cselect_b32 s11, 32768, 0
    s_sub_u32 s34, s34, s11
    buffer_load_dwordx4 v[104:107], v2, s[96:99], s34 offen offset:0 sc1
    buffer_load_dwordx4 v[108:111], v2, s[96:99], s34 offen offset:1024 sc1
    buffer_load_dwordx4 v[112:115], v2, s[96:99], s34 offen offset:2048 sc1
    buffer_load_dwordx4 v[116:119], v2, s[96:99], s34 offen offset:3072 sc1
    s_add_u32 s34, s34, 4096
Lm_g1_run:
    v_mov_b32 v152, 0
    s_waitcnt vmcnt(11)
    v_mfma_f32_32x32x16_bf16 v[8:23], a[0:3], v[72:75], v[136:151]
    buffer_load_dwordx4 v[120:123], v2, s[96:99], s34 offen offset:0 sc1
    v_mfma_f32_32x32x16_bf16 v[24:39], a[4:7], v[72:75], 0
    v_max3_u32 v152, v152, v72, v73
    v_max3_u32 v152, v152, v74, v75
    s_waitcnt vmcnt(11)
    v_mfma_f32_32x32x16_bf16 v[8:23], a[8:11], v[76:79], v[8:23]
    buffer_load_dwordx4 v[124:127], v2, s[96:99], s34 offen offset:1024 sc1
    v_mfma_f32_32x32x16_bf16 v[24:39], a[12:15], v[76:79], v[24:39]
    v_max3_u32 v152, v152, v76, v77
    v_max3_u32 v152, v152, v78, v79
    s_waitcnt vmcnt(11)
    v_mfma_f32_32x32x16_bf16 v[8:23], a[16:19], v[80:83], v[8:23]
    buffer_load_dwordx4 v[128:131], v2, s[96:99], s34 offen offset:2048 sc1
    v_mfma_f32_32x32x16_bf16 v[24:39], a[20:23], v[80:83], v[24:39]
    v_max3_u32 v152, v152, v80, v81
    v_max3_u32 v152, v152, v82, v83
    s_waitcnt vmcnt(11)
    v_mfma_f32_32x32x16_bf16 v[8:23], a[24:27], v[84:87], v[8:23]
    buffer_load_dwordx4 v[132:135], v2, s[96:99], s34 offen offset:3072 sc1
    s_add_u32 s34, s34, 4096
    s_cmp_ge_u32 s34, s41
    s_cselect_b32 s11, 32768, 0
    s_sub_u32 s34, s34, s11
    v_mfma_f32_32x32x16_bf16 v[24:39], a[28:31], v[84:87], v[24:39]
    v_max3_u32 v152, v152, v84, v85
    v_max3_u32 v152, v152, v86, v87
    s_waitcnt vmcnt(11)
    v_mfma_f32_32x32x16_bf16 v[8:23], a[32:35], v[88:91], v[8:23]
    buffer_load_dwordx4 v[72:75], v2, s[96:99], s34 offen offset:0 sc1
    v_mfma_f32_32x32x16_bf16 v[24:39], a[36:39], v[88:91], v[24:39]
    v_max3_u32 v152, v152, v88, v89
    v_max3_u32 v152, v152, v90, v91
    s_waitcnt vmcnt(11)
    v_mfma_f32_32x32x16_bf16 v[8:23], a[40:43], v[92:95], v[8:23]
    buffer_load_dwordx4 v[76:79], v2, s[96:99], s34 offen offset:1024 sc1
    v_mfma_f32_32x32x16_bf16 v[24:39], a[44:47], v[92:95], v[24:39]
    v_max3_u32 v152, v152, v92, v93
    v_max3_u32 v152, v152, v94, v95
    s_waitcnt vmcnt(11)
    v_mfma_f32_32x32x16_bf16 v[8:23], a[48:51], v[96:99], v[8:23]
    buffer_load_dwordx4 v[80:83], v2, s[96:99], s34 offen offset:2048 sc1
    v_mfma_f32_32x32x16_bf16 v[24:39], a[52:55], v[96:99], v[24:39]
    v_max3_u32 v152, v152, v96, v97
    v_max3_u32 v152, v152, v98, v99
    s_waitcnt vmcnt(11)
    v_mfma_f32_32x32x16_bf16 v[8:23], a[56:59], v[100:103], v[8:23]
    buffer_load_dwordx4 v[84:87], v2, s[96:99], s34 offen offset:3072 sc1
    s_add_u32 s34, s34, 4096
    v_mfma_f32_32x32x16_bf16 v[24:39], a[60:63], v[100:103], v[24:39]
    v_max3_u32 v152, v152, v100, v101
    v_max3_u32 v152, v152, v102, v103
    s_waitcnt vmcnt(11)
    v_mfma_f32_32x32x16_bf16 v[8:23], a[64:67], v[104:107], v[8:23]
    buffer_load_dwordx4 v[88:91], v2, s[96:99], s34 offen offset:0 sc1
    v_mfma_f32_32x32x16_bf16 v[24:39], a[68:71], v[104:107], v[24:39]
    v_max3_u32 v152, v152, v104, v105
    v_max3_u32 v152, v152, v106, v107
    s_waitcnt vmcnt(11)
    v_mfma_f32_32x32x16_bf16 v[8:23], a[72:75], v[108:111], v[8:23]
    buffer_load_dwordx4 v[92:95], v2, s[96:99], s34 offen offset:1024 sc1
    v_mfma_f32_32x32x16_bf16 v[24:39], a[76:79], v[108:111], v[24:39]
    v_max3_u32 v152, v152, v108, v109
    v_max3_u32 v152, v152, v110, v111
    s_waitcnt vmcnt(11)
    v_mfma_f32_32x32x16_bf16 v[8:23], a[80:83], v[112:115], v[8:23]
    buffer_load_dwordx4 v[96:99], v2, s[96:99], s34 offen offset:2048 sc1
    v_mfma_f32_32x32x16_bf16 v[24:39], a[84:87], v[112:115], v[24:39]
    v_max3_u32 v152, v152, v112, v113
    v_max3_u32 v152, v152, v114, v115
    s_waitcnt vmcnt(11)
    v_mfma_f32_32x32x16_bf16 v[8:23], a[88:91], v[116:119], v[8:23]
    buffer_load_dwordx4 v[100:103], v2, s[96:99], s34 offen offset:3072 sc1
    s_add_u32 s34, s34, 4096
    s_cmp_ge_u32 s34, s41
    s_cselect_b32 s11, 32768, 0
    s_sub_u32 s34, s34, s11
    v_mfma_f32_32x32x16_bf16 v[24:39], a[92:95], v[116:119], v[24:39]
    v_max3_u32 v152, v152, v116, v117
    v_max3_u32 v152, v152, v118, v119
    s_waitcnt vmcnt(11)
    v_mfma_f32_32x32x16_bf16 v[8:23], a[96:99], v[120:123], v[8:23]
    buffer_load_dwordx4 v[104:107], v2, s[96:99], s34 offen offset:0 sc1
    v_mfma_f32_32x32x16_bf16 v[24:39], a[100:103], v[120:123], v[24:39]
    v_max3_u32 v152, v152, v120, v121
    v_max3_u32 v152, v152, v122, v123
    v_cmp_eq_u32 vcc, -1, v152
    s_waitcnt vmcnt(11)
    v_mfma_f32_32x32x16_bf16 v[8:23], a[104:107], v[124:127], v[8:23]
    buffer_load_dwordx4 v[108:111], v2, s[96:99], s34 offen offset:1024 sc1
    v_mfma_f32_32x32x16_bf16 v[24:39], a[108:111], v[124:127], v[24:39]
    v_max3_u32 v152, v152, v124, v125
    v_max3_u32 v152, v152, v126, v127
    s_cbranch_vccnz Lm_g1_redoe
Lm_g1_oke:
    s_waitcnt vmcnt(11)
    v_mfma_f32_32x32x16_bf16 v[8:23], a[112:115], v[128:131], v[8:23]
    buffer_load_dwordx4 v[112:115], v2, s[96:99], s34 offen offset:2048 sc1
    v_mfma_f32_32x32x16_bf16 v[24:39], a[116:119], v[128:131], v[24:39]
    v_max3_u32 v152, v152, v128, v129
    v_max3_u32 v152, v152, v130, v131
    s_waitcnt vmcnt(11)
    v_mfma_f32_32x32x16_bf16 v[8:23], a[120:123], v[132:135], v[8:23]
    buffer_load_dwordx4 v[116:119], v2, s[96:99], s34 offen offset:3072 sc1
    s_add_u32 s34, s34, 4096
    v_mfma_f32_32x32x16_bf16 v[24:39], a[124:127], v[132:135], v[24:39]
    v_max3_u32 v152, v152, v132, v133
    v_max3_u32 v152, v152, v134, v135
    s_waitcnt vmcnt(11)
    v_mfma_f32_32x32x16_bf16 v[8:23], a[128:131], v[72:75], v[8:23]
    buffer_load_dwordx4 v[120:123], v2, s[96:99], s34 offen offset:0 sc1
    v_mfma_f32_32x32x16_bf16 v[24:39], a[132:135], v[72:75], v[24:39]
    v_max3_u32 v152, v152, v72, v73
    v_max3_u32 v152, v152, v74, v75
    s_waitcnt vmcnt(11)
    v_mfma_f32_32x32x16_bf16 v[8:23], a[136:139], v[76:79], v[8:23]
    buffer_load_dwordx4 v[124:127], v2, s[96:99], s34 offen offset:1024 sc1
    v_mfma_f32_32x32x16_bf16 v[24:39], a[140:143], v[76:79], v[24:39]
    v_max3_u32 v152, v152, v76, v77
    v_max3_u32 v152, v152, v78, v79
    s_waitcnt vmcnt(11)
    v_mfma_f32_32x32x16_bf16 v[8:23], a[144:147], v[80:83], v[8:23]
    buffer_load_dwordx4 v[128:131], v2, s[96:99], s34 offen offset:2048 sc1
    v_mfma_f32_32x32x16_bf16 v[24:39], a[148:151], v[80:83], v[24:39]
    v_max3_u32 v152, v152, v80, v81
    v_max3_u32 v152, v152, v82, v83
    s_waitcnt vmcnt(11)
    v_mfma_f32_32x32x16_bf16 v[8:23], a[152:155], v[84:87], v[8:23]
    buffer_load_dwordx4 v[132:135], v2, s[96:99], s34 offen offset:3072 sc1
    s_add_u32 s34, s36, 149760
    s_add_u32 s41, s41, 149760
    v_mfma_f32_32x32x16_bf16 v[24:39], a[156:159], v[84:87], v[24:39]
    v_max3_u32 v152, v152, v84, v85
    v_max3_u32 v152, v152, v86, v87
    s_waitcnt vmcnt(11)
    v_mfma_f32_32x32x16_bf16 v[8:23], a[160:163], v[88:91], v[8:23]
    buffer_load_dwordx4 v[72:75], v2, s[96:99], s34 offen offset:0 sc1
    v_mfma_f32_32x32x16_bf16 v[24:39], a[164:167], v[88:91], v[24:39]
    v_max3_u32 v152, v152, v88, v89
    v_max3_u32 v152, v152, v90, v91
    s_waitcnt vmcnt(11)
    v_mfma_f32_32x32x16_bf16 v[8:23], a[168:171], v[92:95], v[8:23]
    buffer_load_dwordx4 v[76:79], v2, s[96:99], s34 offen offset:1024 sc1
    v_mfma_f32_32x32x16_bf16 v[24:39], a[172:175], v[92:95], v[24:39]
    v_max3_u32 v152, v152, v92, v93
    v_max3_u32 v152, v152, v94, v95
    s_waitcnt vmcnt(11)
    v_mfma_f32_32x32x16_bf16 v[8:23], a[176:179], v[96:99], v[8:23]
    buffer_load_dwordx4 v[80:83], v2, s[96:99], s34 offen offset:2048 sc1
    v_mfma_f32_32x32x16_bf16 v[24:39], a[180:183], v[96:99], v[24:39]
    v_max3_u32 v152, v152, v96, v97
    v_max3_u32 v152, v152, v98, v99
    s_waitcnt vmcnt(11)
    v_mfma_f32_32x32x16_bf16 v[8:23], a[184:187], v[100:103], v[8:23]
    buffer_load_dwordx4 v[84:87], v2, s[96:99], s34 offen offset:3072 sc1
    s_add_u32 s34, s34, 4096
    v_mfma_f32_32x32x16_bf16 v[24:39], a[188:191], v[100:103], v[24:39]
    v_max3_u32 v152, v152, v100, v101
    v_max3_u32 v152, v152, v102, v103
    s_waitcnt vmcnt(11)
    v_mfma_f32_32x32x16_bf16 v[8:23], a[192:195], v[104:107], v[8:23]
    buffer_load_dwordx4 v[88:91], v2, s[96:99], s34 offen offset:0 sc1
    v_mfma_f32_32x32x16_bf16 v[24:39], a[196:199], v[104:107], v[24:39]
    v_max3_u32 v152, v152, v104, v105
    v_max3_u32 v152, v152, v106, v107
    s_waitcnt vmcnt(11)
    v_mfma_f32_32x32x16_bf16 v[8:23], a[200:203], v[108:111], v[8:23]
    buffer_load_dwordx4 v[92:95], v2, s[96:99], s34 offen offset:1024 sc1
    v_mfma_f32_32x32x16_bf16 v[24:39], a[204:207], v[108:111], v[24:39]
    v_max3_u32 v152, v152, v108, v109
    v_max3_u32 v152, v152, v110, v111
    s_waitcnt vmcnt(11)
    v_mfma_f32_32x32x16_bf16 v[8:23], a[208:211], v[112:115], v[8:23]
    buffer_load_dwordx4 v[96:99], v2, s[96:99], s34 offen offset:2048 sc1
    v_mfma_f32_32x32x16_bf16 v[24:39], a[212:215], v[112:115], v[24:39]
    v_max3_u32 v152, v152, v112, v113
    v_max3_u32 v152, v152, v114, v115
    s_waitcnt vmcnt(11)
    v_mfma_f32_32x32x16_bf16 v[8:23], a[216:219], v[116:119], v[8:23]
    buffer_load_dwordx4 v[100:103], v2, s[96:99], s34 offen offset:3072 sc1
    s_add_u32 s34, s34, 4096
    s_cmp_ge_u32 s34, s41
    s_cselect_b32 s11, 32768, 0
    s_sub_u32 s34, s34, s11
    v_mfma_f32_32x32x16_bf16 v[24:39], a[220:223], v[116:119], v[24:39]
    v_max3_u32 v152, v152, v116, v117
    v_max3_u32 v152, v152, v118, v119
    s_waitcnt vmcnt(11)
    v_mfma_f32_32x32x16_bf16 v[8:23], a[224:227], v[120:123], v[8:23]
    buffer_load_dwordx4 v[104:107], v2, s[96:99], s34 offen offset:0 sc1
    v_mfma_f32_32x32x16_bf16 v[24:39], a[228:231], v[120:123], v[24:39]
    v_max3_u32 v152, v152, v120, v121
    v_max3_u32 v152, v152, v122, v123
    s_waitcnt vmcnt(11)
    v_mfma_f32_32x32x16_bf16 v[8:23], a[232:235], v[124:127], v[8:23]
    buffer_load_dwordx4 v[108:111], v2, s[96:99], s34 offen offset:1024 sc1
    v_mfma_f32_32x32x16_bf16 v[24:39], a[236:239], v[124:127], v[24:39]
    v_max3_u32 v152, v152, v124, v125
    v_max3_u32 v152, v152, v126, v127
    s_waitcnt vmcnt(11)
    v_mfma_f32_32x32x16_bf16 v[8:23], a[240:243], v[128:131], v[8:23]
    buffer_load_dwordx4 v[112:115], v2, s[96:99], s34 offen offset:2048 sc1
    v_mfma_f32_32x32x16_bf16 v[24:39], a[244:247], v[128:131], v[24:39]
    v_max3_u32 v152, v152, v128, v129
    v_max3_u32 v152, v152, v130, v131
    s_waitcnt vmcnt(11)
    v_mfma_f32_32x32x16_bf16 v[24:39], a[252:255], v[132:135], v[24:39]
    v_mfma_f32_32x32x16_bf16 v[8:23], a[248:251], v[132:135], v[8:23]
    buffer_load_dwordx4 v[116:119], v2, s[96:99], s34 offen offset:3072 sc1
    s_add_u32 s34, s34, 4096
    v_max3_u32 v152, v152, v132, v133
    v_max3_u32 v152, v152, v134, v135
    v_cmp_eq_u32 vcc, -1, v152
    s_waitcnt vmcnt(11)
    v_mfma_f32_32x32x16_bf16 v[40:55], a[0:3], v[72:75], v[136:151]
    buffer_load_dwordx4 v[120:123], v2, s[96:99], s34 offen offset:0 sc1
    v_mfma_f32_32x32x16_bf16 v[56:71], a[4:7], v[72:75], 0
    s_nop 0
    s_cbranch_vccnz Lm_g1_redo0
Lm_g1_ok0:
    v_max3_u32 v152, v152, v72, v73
    v_max3_u32 v152, v152, v74, v75
    s_waitcnt vmcnt(11)
    v_mfma_f32_32x32x16_bf16 v[40:55], a[8:11], v[76:79], v[40:55]
    buffer_load_dwordx4 v[124:127], v2, s[96:99], s34 offen offset:1024 sc1
    ds_write_b128 v6, v[32:35] offset:0
    ds_write_b128 v6, v[36:39] offset:1024
    ds_write_b128 v5, v[24:27] offset:0
    ds_write_b128 v5, v[28:31] offset:1024
    ds_write_b128 v4, v[16:19] offset:0
    v_mfma_f32_32x32x16_bf16 v[56:71], a[12:15], v[76:79], v[56:71]
    ds_write_b128 v4, v[20:23] offset:1024
    v_max3_u32 v152, v152, v76, v77
    v_max3_u32 v152, v152, v78, v79
    s_waitcnt vmcnt(11)
    v_mfma_f32_32x32x16_bf16 v[40:55], a[16:19], v[80:83], v[40:55]
    buffer_load_dwordx4 v[128:131], v2, s[96:99], s34 offen offset:2048 sc1
    s_waitcnt lgkmcnt(0)
    s_barrier
    ds_read_b128 v[16:19], v3 offset:0
    v_mfma_f32_32x32x16_bf16 v[56:71], a[20:23], v[80:83], v[56:71]
    ds_read_b128 v[20:23], v3 offset:1024
    ds_read_b128 v[24:27], v3 offset:2048
    ds_read_b128 v[28:31], v3 offset:3072
    ds_read_b128 v[32:35], v3 offset:4096
    ds_read_b128 v[36:39], v3 offset:5120
    v_max3_u32 v152, v152, v80, v81
    v_max3_u32 v152, v152, v82, v83
    s_waitcnt vmcnt(11)
    v_mfma_f32_32x32x16_bf16 v[40:55], a[24:27], v[84:87], v[40:55]
    buffer_load_dwordx4 v[132:135], v2, s[96:99], s34 offen offset:3072 sc1
    s_add_u32 s34, s34, 4096
    s_cmp_ge_u32 s34, s41
    s_cselect_b32 s11, 32768, 0
    s_sub_u32 s34, s34, s11
    v_mfma_f32_32x32x16_bf16 v[56:71], a[28:31], v[84:87], v[56:71]
    s_waitcnt lgkmcnt(0)
    v_add_f32 v8, v8, v16
    v_add_f32 v9, v9, v17
    v_add_f32 v10, v10, v18
    v_add_f32 v11, v11, v19
    v_add_f32 v12, v12, v20
    v_max3_u32 v152, v152, v84, v85
    v_max3_u32 v152, v152, v86, v87
    s_waitcnt vmcnt(11)
    v_mfma_f32_32x32x16_bf16 v[40:55], a[32:35], v[88:91], v[40:55]
    buffer_load_dwordx4 v[72:75], v2, s[96:99], s34 offen offset:0 sc1
    v_add_f32 v13, v13, v21
    v_add_f32 v14, v14, v22
    v_add_f32 v15, v15, v23
    v_add_f32 v8, v8, v24
    v_add_f32 v9, v9, v25
    v_mfma_f32_32x32x16_bf16 v[56:71], a[36:39], v[88:91], v[56:71]
    v_add_f32 v10, v10, v26
    v_add_f32 v11, v11, v27
    v_add_f32 v12, v12, v28
    v_add_f32 v13, v13, v29
    v_add_f32 v14, v14, v30
    v_add_f32 v15, v15, v31
    v_max3_u32 v152, v152, v88, v89
    v_max3_u32 v152, v152, v90, v91
    s_waitcnt vmcnt(11)
    v_mfma_f32_32x32x16_bf16 v[40:55], a[40:43], v[92:95], v[40:55]
    buffer_load_dwordx4 v[76:79], v2, s[96:99], s34 offen offset:1024 sc1
    v_add_f32 v8, v8, v32
    v_add_f32 v9, v9, v33
    v_add_f32 v10, v10, v34
    v_add_f32 v11, v11, v35
    v_add_f32 v12, v12, v36
    v_mfma_f32_32x32x16_bf16 v[56:71], a[44:47], v[92:95], v[56:71]
    v_add_f32 v13, v13, v37
    v_add_f32 v14, v14, v38
    v_add_f32 v15, v15, v39
    v_mul_f32 v16, v8, v8
    v_mul_f32 v17, v9, v9
    v_mul_f32 v18, v10, v10
    v_max3_u32 v152, v152, v92, v93
    v_max3_u32 v152, v152, v94, v95
    s_waitcnt vmcnt(11)
    v_mfma_f32_32x32x16_bf16 v[40:55], a[48:51], v[96:99], v[40:55]
    buffer_load_dwordx4 v[80:83], v2, s[96:99], s34 offen offset:2048 sc1
    v_mul_f32 v19, v11, v11
    v_mul_f32 v20, v12, v12
    v_mul_f32 v21, v13, v13
    v_mul_f32 v22, v14, v14
    v_mul_f32 v23, v15, v15
    v_mfma_f32_32x32x16_bf16 v[56:71], a[52:55], v[96:99], v[56:71]
    v_fma_f32 v16, v16, v224, v226
    v_fma_f32 v17, v17, v224, v226
    v_fma_f32 v18, v18, v224, v226
    v_fma_f32 v19, v19, v224, v226
    v_fma_f32 v20, v20, v224, v226
    v_fma_f32 v21, v21, v224, v226
    v_max3_u32 v152, v152, v96, v97
    v_max3_u32 v152, v152, v98, v99
    s_waitcnt vmcnt(11)
    v_mfma_f32_32x32x16_bf16 v[40:55], a[56:59], v[100:103], v[40:55]
    buffer_load_dwordx4 v[84:87], v2, s[96:99], s34 offen offset:3072 sc1
    s_add_u32 s34, s34, 4096
    v_fma_f32 v22, v22, v224, v226
    v_fma_f32 v23, v23, v224, v226
    v_mul_f32 v16, v16, v8
    v_mul_f32 v17, v17, v9
    v_mul_f32 v18, v18, v10
    v_mul_f32 v19, v19, v11
    v_mfma_f32_32x32x16_bf16 v[56:71], a[60:63], v[100:103], v[56:71]
    v_mul_f32 v20, v20, v12
    v_mul_f32 v21, v21, v13
    v_mul_f32 v22, v22, v14
    v_mul_f32 v23, v23, v15
    v_exp_f32 v16, v16
    v_max3_u32 v152, v152, v100, v101
    v_max3_u32 v152, v152, v102, v103
    s_waitcnt vmcnt(11)
    v_mfma_f32_32x32x16_bf16 v[40:55], a[64:67], v[104:107], v[40:55]
    buffer_load_dwordx4 v[88:91], v2, s[96:99], s34 offen offset:0 sc1
    v_exp_f32 v17, v17
    v_exp_f32 v18, v18
    v_exp_f32 v19, v19
    v_mfma_f32_32x32x16_bf16 v[56:71], a[68:71], v[104:107], v[56:71]
    v_exp_f32 v20, v20
    v_exp_f32 v21, v21
    v_max3_u32 v152, v152, v104, v105
    v_max3_u32 v152, v152, v106, v107
    s_waitcnt vmcnt(11)
    v_mfma_f32_32x32x16_bf16 v[40:55], a[72:75], v[108:111], v[40:55]
    buffer_load_dwordx4 v[92:95], v2, s[96:99], s34 offen offset:1024 sc1
    v_exp_f32 v22, v22
    v_exp_f32 v23, v23
    v_add_f32 v16, 1.0, v16
    v_add_f32 v17, 1.0, v17
    v_mfma_f32_32x32x16_bf16 v[56:71], a[76:79], v[108:111], v[56:71]
    v_add_f32 v18, 1.0, v18
    v_add_f32 v19, 1.0, v19
    v_add_f32 v20, 1.0, v20
    v_add_f32 v21, 1.0, v21
    v_add_f32 v22, 1.0, v22
    v_max3_u32 v152, v152, v108, v109
    v_max3_u32 v152, v152, v110, v111
    s_waitcnt vmcnt(11)
    v_mfma_f32_32x32x16_bf16 v[40:55], a[80:83], v[112:115], v[40:55]
    buffer_load_dwordx4 v[96:99], v2, s[96:99], s34 offen offset:2048 sc1
    v_add_f32 v23, 1.0, v23
    v_rcp_f32 v16, v16
    v_rcp_f32 v17, v17
    v_rcp_f32 v18, v18
    v_mfma_f32_32x32x16_bf16 v[56:71], a[84:87], v[112:115], v[56:71]
    v_rcp_f32 v19, v19
    v_rcp_f32 v20, v20
    v_max3_u32 v152, v152, v112, v113
    v_max3_u32 v152, v152, v114, v115
    s_waitcnt vmcnt(11)
    v_mfma_f32_32x32x16_bf16 v[40:55], a[88:91], v[116:119], v[40:55]
    buffer_load_dwordx4 v[100:103], v2, s[96:99], s34 offen offset:3072 sc1
    s_add_u32 s34, s34, 4096
    s_cmp_ge_u32 s34, s41
    s_cselect_b32 s11, 32768, 0
    s_sub_u32 s34, s34, s11
    v_rcp_f32 v21, v21
    v_rcp_f32 v22, v22
    v_rcp_f32 v23, v23
    v_mfma_f32_32x32x16_bf16 v[56:71], a[92:95], v[116:119], v[56:71]
    v_mul_f32 v8, v8, v16
    v_mul_f32 v9, v9, v17
    v_mul_f32 v10, v10, v18
    v_mul_f32 v11, v11, v19
    v_mul_f32 v12, v12, v20
    v_max3_u32 v152, v152, v116, v117
    v_max3_u32 v152, v152, v118, v119
    s_waitcnt vmcnt(11)
    v_mfma_f32_32x32x16_bf16 v[40:55], a[96:99], v[120:123], v[40:55]
    buffer_load_dwordx4 v[104:107], v2, s[96:99], s34 offen offset:0 sc1
    v_mul_f32 v13, v13, v21
    v_mul_f32 v14, v14, v22
    v_mul_f32 v15, v15, v23
    v_cvt_pk_bf16_f32 v24, v8, v9
    v_cvt_pk_bf16_f32 v25, v10, v11
    v_cvt_pk_bf16_f32 v26, v12, v13
    v_mfma_f32_32x32x16_bf16 v[56:71], a[100:103], v[120:123], v[56:71]
    s_add_u32 m0, s31, 20480
    s_nop 0
    buffer_load_dwordx4 v159, s[16:19], s27 offen lds
    v_cvt_pk_bf16_f32 v27, v14, v15
    v_min_u32 v24, -2, v24
    v_min_u32 v25, -2, v25
    v_min_u32 v26, -2, v26
    v_min_u32 v27, -2, v27
    buffer_store_dwordx4 v[24:27], v2, s[96:99], s39 offen sc1
    s_add_u32 s39, s39, 114688
    v_max3_u32 v152, v152, v120, v121
    v_max3_u32 v152, v152, v122, v123
    s_waitcnt vmcnt(13)
    v_mfma_f32_32x32x16_bf16 v[40:55], a[104:107], v[124:127], v[40:55]
    buffer_load_dwordx4 v[108:111], v2, s[96:99], s34 offen offset:1024 sc1
    v_mfma_f32_32x32x16_bf16 v[56:71], a[108:111], v[124:127], v[56:71]
    buffer_load_dwordx4 v160, s[16:19], s27 offen offset:1024 lds
    s_add_u32 s27, s27, 65536
    v_max3_u32 v152, v152, v124, v125
    v_max3_u32 v152, v152, v126, v127
    s_waitcnt vmcnt(14)
    v_mfma_f32_32x32x16_bf16 v[40:55], a[112:115], v[128:131], v[40:55]
    buffer_load_dwordx4 v[112:115], v2, s[96:99], s34 offen offset:2048 sc1
    v_mfma_f32_32x32x16_bf16 v[56:71], a[116:119], v[128:131], v[56:71]
    s_add_u32 m0, s31, 22528
    s_nop 0
    buffer_load_dwordx4 v159, s[16:19], s27 offen lds
    v_max3_u32 v152, v152, v128, v129
    v_max3_u32 v152, v152, v130, v131
    s_waitcnt vmcnt(15)
    v_mfma_f32_32x32x16_bf16 v[40:55], a[120:123], v[132:135], v[40:55]
    buffer_load_dwordx4 v[116:119], v2, s[96:99], s34 offen offset:3072 sc1
    s_add_u32 s34, s34, 4096
    v_mfma_f32_32x32x16_bf16 v[56:71], a[124:127], v[132:135], v[56:71]
    v_max3_u32 v152, v152, v132, v133
    v_max3_u32 v152, v152, v134, v135
    s_waitcnt vmcnt(15)
    v_mfma_f32_32x32x16_bf16 v[40:55], a[128:131], v[72:75], v[40:55]
    buffer_load_dwordx4 v[120:123], v2, s[96:99], s34 offen offset:0 sc1
    v_mfma_f32_32x32x16_bf16 v[56:71], a[132:135], v[72:75], v[56:71]
    buffer_load_dwordx4 v160, s[16:19], s27 offen offset:1024 lds
    s_add_u32 s27, s27, 65536
    v_max3_u32 v152, v152, v72, v73
    v_max3_u32 v152, v152, v74, v75
    s_waitcnt vmcnt(16)
    v_mfma_f32_32x32x16_bf16 v[40:55], a[136:139], v[76:79], v[40:55]
    buffer_load_dwordx4 v[124:127], v2, s[96:99], s34 offen offset:1024 sc1
    v_mfma_f32_32x32x16_bf16 v[56:71], a[140:143], v[76:79], v[56:71]
    s_add_u32 m0, s31, 24576
    s_nop 0
    buffer_load_dwordx4 v159, s[16:19], s27 offen lds
    v_max3_u32 v152, v152, v76, v77
    v_max3_u32 v152, v152, v78, v79
    s_waitcnt vmcnt(17)
    v_mfma_f32_32x32x16_bf16 v[40:55], a[144:147], v[80:83], v[40:55]
    buffer_load_dwordx4 v[128:131], v2, s[96:99], s34 offen offset:2048 sc1
    v_mfma_f32_32x32x16_bf16 v[56:71], a[148:151], v[80:83], v[56:71]
    v_max3_u32 v152, v152, v80, v81
    v_max3_u32 v152, v152, v82, v83
    s_waitcnt vmcnt(17)
    v_mfma_f32_32x32x16_bf16 v[40:55], a[152:155], v[84:87], v[40:55]
    buffer_load_dwordx4 v[132:135], v2, s[96:99], s34 offen offset:3072 sc1
    v_mfma_f32_32x32x16_bf16 v[56:71], a[156:159], v[84:87], v[56:71]
    buffer_load_dwordx4 v160, s[16:19], s27 offen offset:1024 lds
    s_add_u32 s27, s27, 65536
    v_max3_u32 v152, v152, v84, v85
    v_max3_u32 v152, v152, v86, v87
    s_waitcnt vmcnt(18)
    v_mfma_f32_32x32x16_bf16 v[40:55], a[160:163], v[88:91], v[40:55]
    v_mfma_f32_32x32x16_bf16 v[56:71], a[164:167], v[88:91], v[56:71]
    s_add_u32 m0, s31, 26624
    s_nop 0
    buffer_load_dwordx4 v159, s[16:19], s27 offen lds
    v_max3_u32 v152, v152, v88, v89
    v_max3_u32 v152, v152, v90, v91
    s_waitcnt vmcnt(18)
    v_mfma_f32_32x32x16_bf16 v[40:55], a[168:171], v[92:95], v[40:55]
    v_mfma_f32_32x32x16_bf16 v[56:71], a[172:175], v[92:95], v[56:71]
    v_max3_u32 v152, v152, v92, v93
    v_max3_u32 v152, v152, v94, v95
    s_waitcnt vmcnt(17)
    v_mfma_f32_32x32x16_bf16 v[40:55], a[176:179], v[96:99], v[40:55]
    v_mfma_f32_32x32x16_bf16 v[56:71], a[180:183], v[96:99], v[56:71]
    buffer_load_dwordx4 v160, s[16:19], s27 offen offset:1024 lds
    s_add_u32 s27, s27, 65536
    v_max3_u32 v152, v152, v96, v97
    v_max3_u32 v152, v152, v98, v99
    s_waitcnt vmcnt(17)
    v_mfma_f32_32x32x16_bf16 v[40:55], a[184:187], v[100:103], v[40:55]
    v_mfma_f32_32x32x16_bf16 v[56:71], a[188:191], v[100:103], v[56:71]
    s_add_u32 m0, s31, 28672
    s_nop 0
    buffer_load_dwordx4 v159, s[16:19], s27 offen lds
    v_max3_u32 v152, v152, v100, v101
    v_max3_u32 v152, v152, v102, v103
    s_waitcnt vmcnt(17)
    v_mfma_f32_32x32x16_bf16 v[40:55], a[192:195], v[104:107], v[40:55]
    v_mfma_f32_32x32x16_bf16 v[56:71], a[196:199], v[104:107], v[56:71]
    buffer_load_dwordx4 v160, s[16:19], s27 offen offset:1024 lds
    s_add_u32 s27, s27, 65536
    s_cmp_ge_u32 s27, s55
    s_cselect_b32 s42, 1835008, 0
    s_sub_u32 s27, s27, s42
    v_max3_u32 v152, v152, v104, v105
    v_max3_u32 v152, v152, v106, v107
    s_waitcnt vmcnt(15)
    v_mfma_f32_32x32x16_bf16 v[40:55], a[200:203], v[108:111], v[40:55]
    v_mfma_f32_32x32x16_bf16 v[56:71], a[204:207], v[108:111], v[56:71]
    v_max3_u32 v152, v152, v108, v109
    v_max3_u32 v152, v152, v110, v111
    s_waitcnt vmcnt(13)
    v_mfma_f32_32x32x16_bf16 v[40:55], a[208:211], v[112:115], v[40:55]
    v_mfma_f32_32x32x16_bf16 v[56:71], a[212:215], v[112:115], v[56:71]
    s_add_u32 m0, s31, 30720
    s_nop 0
    buffer_load_dwordx4 v159, s[16:19], s27 offen lds
    v_max3_u32 v152, v152, v112, v113
    v_max3_u32 v152, v152, v114, v115
    s_waitcnt vmcnt(12)
    v_mfma_f32_32x32x16_bf16 v[40:55], a[216:219], v[116:119], v[40:55]
    v_mfma_f32_32x32x16_bf16 v[56:71], a[220:223], v[116:119], v[56:71]
    buffer_load_dwordx4 v160, s[16:19], s27 offen offset:1024 lds
    s_add_u32 s27, s27, 65536
    v_max3_u32 v152, v152, v116, v117
    v_max3_u32 v152, v152, v118, v119
    s_waitcnt vmcnt(12)
    v_mfma_f32_32x32x16_bf16 v[40:55], a[224:227], v[120:123], v[40:55]
    buffer_load_dword v229, v228, s[20:23], s35 offen offset:1020 sc1
    v_mfma_f32_32x32x16_bf16 v[56:71], a[228:231], v[120:123], v[56:71]
    v_max3_u32 v152, v152, v120, v121
    v_max3_u32 v152, v152, v122, v123
    s_waitcnt vmcnt(11)
    v_mfma_f32_32x32x16_bf16 v[40:55], a[232:235], v[124:127], v[40:55]
    v_mfma_f32_32x32x16_bf16 v[56:71], a[236:239], v[124:127], v[56:71]
    s_add_u32 m0, s31, 32768
    s_nop 0
    buffer_load_dwordx4 v159, s[16:19], s27 offen lds
    v_max3_u32 v152, v152, v124, v125
    v_max3_u32 v152, v152, v126, v127
    s_waitcnt vmcnt(10)
    v_mfma_f32_32x32x16_bf16 v[40:55], a[240:243], v[128:131], v[40:55]
    v_mfma_f32_32x32x16_bf16 v[56:71], a[244:247], v[128:131], v[56:71]
    buffer_load_dwordx4 v160, s[16:19], s27 offen offset:1024 lds
    s_add_u32 s27, s27, 65536
    v_max3_u32 v152, v152, v128, v129
    v_max3_u32 v152, v152, v130, v131
    s_waitcnt vmcnt(10)
    v_mfma_f32_32x32x16_bf16 v[56:71], a[252:255], v[132:135], v[56:71]
    v_mfma_f32_32x32x16_bf16 v[40:55], a[248:251], v[132:135], v[40:55]
    v_max3_u32 v152, v152, v132, v133
    v_max3_u32 v152, v152, v134, v135
Lm_g1_fin:
    v_cmp_eq_u32 vcc, -1, v152
    s_nop 7
    ds_write_b128 v6, v[64:67] offset:6144
    ds_write_b128 v6, v[68:71] offset:7168
    ds_write_b128 v5, v[56:59] offset:6144
    ds_write_b128 v5, v[60:63] offset:7168
    s_cbranch_vccnz Lm_g1_redo1
Lm_g1_ok1:
    ds_write_b128 v4, v[48:51] offset:6144
    ds_write_b128 v4, v[52:55] offset:7168
    s_waitcnt vmcnt(2)
    v_cmp_eq_u32 vcc, -1, v229
    s_mov_b32 s33, s35
    s_mul_i32 s36, s53, 7168
    s_add_u32 s36, s36, s33
    s_add_u32 s34, s36, 0
    s_add_u32 s41, s33, 28672
    s_cbranch_vccnz Lm_g2_wa
Lm_g2_wae2:
    buffer_load_dwordx4 v[72:75], v2, s[20:23], s34 offen offset:0 sc1
    buffer_load_dwordx4 v[76:79], v2, s[20:23], s34 offen offset:1024 sc1
    buffer_load_dwordx4 v[80:83], v2, s[20:23], s34 offen offset:2048 sc1
    buffer_load_dwordx4 v[84:87], v2, s[20:23], s34 offen offset:3072 sc1
    s_add_u32 s34, s34, 4096
    buffer_load_dwordx4 v[88:91], v2, s[20:23], s34 offen offset:0 sc1
    buffer_load_dwordx4 v[92:95], v2, s[20:23], s34 offen offset:1024 sc1
    s_waitcnt lgkmcnt(0)
    s_barrier
    ds_read_b128 v[48:51], v3 offset:6144
    ds_read_b128 v[52:55], v3 offset:7168
    ds_read_b128 v[56:59], v3 offset:8192
    ds_read_b128 v[60:63], v3 offset:9216
    ds_read_b128 v[64:67], v3 offset:10240
    ds_read_b128 v[68:71], v3 offset:11264
    buffer_load_dwordx4 v[96:99], v2, s[20:23], s34 offen offset:2048 sc1
    s_add_u32 s34, s34, 3072
    s_cmp_ge_u32 s34, s41
    s_cselect_b32 s11, 28672, 0
    s_sub_u32 s34, s34, s11
    buffer_load_dwordx4 v[100:103], v2, s[20:23], s34 offen offset:0 sc1
    buffer_load_dwordx4 v[104:107], v2, s[20:23], s34 offen offset:1024 sc1
    buffer_load_dwordx4 v[108:111], v2, s[20:23], s34 offen offset:2048 sc1
    buffer_load_dwordx4 v[112:115], v2, s[20:23], s34 offen offset:3072 sc1
    s_add_u32 s34, s34, 4096
    buffer_load_dwordx4 v[116:119], v2, s[20:23], s34 offen offset:0 sc1
    s_waitcnt lgkmcnt(4)
    v_pk_add_f32 v[40:41], v[40:41], v[48:49]
    v_pk_add_f32 v[42:43], v[42:43], v[50:51]
    v_pk_add_f32 v[44:45], v[44:45], v[52:53]
    v_pk_add_f32 v[46:47], v[46:47], v[54:55]
    s_waitcnt lgkmcnt(2)
    v_pk_add_f32 v[40:41], v[40:41], v[56:57]
    v_pk_add_f32 v[42:43], v[42:43], v[58:59]
    v_pk_add_f32 v[44:45], v[44:45], v[60:61]
    v_pk_add_f32 v[46:47], v[46:47], v[62:63]
    s_waitcnt lgkmcnt(0)
    v_pk_add_f32 v[40:41], v[40:41], v[64:65]
    v_pk_add_f32 v[42:43], v[42:43], v[66:67]
    v_pk_add_f32 v[44:45], v[44:45], v[68:69]
    v_pk_add_f32 v[46:47], v[46:47], v[70:71]
    v_pk_mul_f32 v[48:49], v[40:41], v[40:41]
    v_pk_mul_f32 v[50:51], v[42:43], v[42:43]
    v_pk_mul_f32 v[52:53], v[44:45], v[44:45]
    v_pk_mul_f32 v[54:55], v[46:47], v[46:47]
    v_pk_fma_f32 v[48:49], v[48:49], v[224:225], v[226:227] op_sel_hi:[1,0,0]
    v_pk_fma_f32 v[50:51], v[50:51], v[224:225], v[226:227] op_sel_hi:[1,0,0]
    v_pk_fma_f32 v[52:53], v[52:53], v[224:225], v[226:227] op_sel_hi:[1,0,0]
    v_pk_fma_f32 v[54:55], v[54:55], v[224:225], v[226:227] op_sel_hi:[1,0,0]
    v_pk_mul_f32 v[48:49], v[48:49], v[40:41]
    v_pk_mul_f32 v[50:51], v[50:51], v[42:43]
    v_pk_mul_f32 v[52:53], v[52:53], v[44:45]
    v_pk_mul_f32 v[54:55], v[54:55], v[46:47]
    v_exp_f32 v48, v48
    v_exp_f32 v49, v49
    v_exp_f32 v50, v50
    v_exp_f32 v51, v51
    v_exp_f32 v52, v52
    v_exp_f32 v53, v53
    v_exp_f32 v54, v54
    v_exp_f32 v55, v55
    v_pk_add_f32 v[48:49], v[48:49], 1.0 op_sel_hi:[1,0]
    v_pk_add_f32 v[50:51], v[50:51], 1.0 op_sel_hi:[1,0]
    v_pk_add_f32 v[52:53], v[52:53], 1.0 op_sel_hi:[1,0]
    v_pk_add_f32 v[54:55], v[54:55], 1.0 op_sel_hi:[1,0]
    v_rcp_f32 v48, v48
    v_rcp_f32 v49, v49
    v_rcp_f32 v50, v50
    v_rcp_f32 v51, v51
    v_rcp_f32 v52, v52
    v_rcp_f32 v53, v53
    v_rcp_f32 v54, v54
    v_rcp_f32 v55, v55
    v_pk_mul_f32 v[40:41], v[40:41], v[48:49]
    v_pk_mul_f32 v[42:43], v[42:43], v[50:51]
    v_pk_mul_f32 v[44:45], v[44:45], v[52:53]
    v_pk_mul_f32 v[46:47], v[46:47], v[54:55]
    v_cvt_pk_bf16_f32 v56, v40, v41
    v_cvt_pk_bf16_f32 v57, v42, v43
    v_cvt_pk_bf16_f32 v58, v44, v45
    v_cvt_pk_bf16_f32 v59, v46, v47
    v_min_u32 v56, -2, v56
    v_min_u32 v57, -2, v57
    v_min_u32 v58, -2, v58
    v_min_u32 v59, -2, v59
    buffer_store_dwordx4 v[56:59], v2, s[96:99], s39 offen sc1
    s_add_u32 m0, s31, 34816
    s_nop 0
    buffer_load_dwordx4 v159, s[16:19], s27 offen lds
    buffer_load_dwordx4 v160, s[16:19], s27 offen offset:1024 lds
    s_add_u32 s27, s27, 65536
    s_add_u32 m0, s31, 36864
    s_nop 0
    buffer_load_dwordx4 v159, s[16:19], s27 offen lds
    buffer_load_dwordx4 v160, s[16:19], s27 offen offset:1024 lds
    s_add_u32 s27, s27, 65536
    s_add_u32 m0, s31, 38912
    s_nop 0
    buffer_load_dwordx4 v159, s[16:19], s27 offen lds
    buffer_load_dwordx4 v160, s[16:19], s27 offen offset:1024 lds
    s_add_u32 s27, s27, 65536
    v_mov_b32 v152, 0
    s_waitcnt vmcnt(19)
    ds_read_b64_tr_b16 a[48:49], v154 offset:0
    ds_read_b64_tr_b16 a[50:51], v154 offset:1024
    ds_read_b64_tr_b16 a[52:53], v155 offset:0
    ds_read_b64_tr_b16 a[54:55], v155 offset:1024
    ds_read_b64_tr_b16 a[56:57], v154 offset:2048
    ds_read_b64_tr_b16 a[58:59], v154 offset:3072
    ds_read_b64_tr_b16 a[60:61], v155 offset:2048
    ds_read_b64_tr_b16 a[62:63], v155 offset:3072
    ds_read_b64_tr_b16 a[64:65], v154 offset:4096
    ds_read_b64_tr_b16 a[66:67], v154 offset:5120
    ds_read_b64_tr_b16 a[68:69], v155 offset:4096
    ds_read_b64_tr_b16 a[70:71], v155 offset:5120
    s_waitcnt vmcnt(18)
    v_mfma_f32_32x32x16_bf16 v[8:23], v[72:75], v[168:171], 0
    buffer_load_dwordx4 v[120:123], v2, s[20:23], s34 offen offset:1024 sc1
    v_mfma_f32_32x32x16_bf16 v[24:39], v[72:75], v[172:175], 0
    ds_read_b64_tr_b16 a[72:73], v154 offset:6144
    ds_read_b64_tr_b16 a[74:75], v154 offset:7168
    ds_read_b64_tr_b16 a[76:77], v155 offset:6144
    ds_read_b64_tr_b16 a[78:79], v155 offset:7168
    v_max3_u32 v152, v152, v72, v73
    v_max3_u32 v152, v152, v74, v75
    s_waitcnt vmcnt(18)
    v_mfma_f32_32x32x16_bf16 v[8:23], v[76:79], v[176:179], v[8:23]
    buffer_load_dwordx4 v[124:127], v2, s[20:23], s34 offen offset:2048 sc1
    s_add_u32 s34, s34, 3072
    s_cmp_ge_u32 s34, s41
    s_cselect_b32 s11, 28672, 0
    s_sub_u32 s34, s34, s11
    v_mfma_f32_32x32x16_bf16 v[24:39], v[76:79], v[180:183], v[24:39]
    s_waitcnt lgkmcnt(8)
    s_add_u32 m0, s31, 0
    s_nop 0
    buffer_load_dwordx4 v159, s[16:19], s27 offen lds
    buffer_load_dwordx4 v160, s[16:19], s27 offen offset:1024 lds
    s_add_u32 s27, s27, 65536
    s_add_u32 m0, s31, 2048
    s_nop 0
    buffer_load_dwordx4 v159, s[16:19], s27 offen lds
    buffer_load_dwordx4 v160, s[16:19], s27 offen offset:1024 lds
    s_add_u32 s27, s27, 65536
    ds_read_b64_tr_b16 a[80:81], v154 offset:8192
    ds_read_b64_tr_b16 a[82:83], v154 offset:9216
    ds_read_b64_tr_b16 a[84:85], v155 offset:8192
    ds_read_b64_tr_b16 a[86:87], v155 offset:9216
    v_max3_u32 v152, v152, v76, v77
    v_max3_u32 v152, v152, v78, v79
    s_waitcnt vmcnt(22)
    v_mfma_f32_32x32x16_bf16 v[8:23], v[80:83], v[184:187], v[8:23]
    buffer_load_dwordx4 v[128:131], v2, s[20:23], s34 offen offset:0 sc1
    v_mfma_f32_32x32x16_bf16 v[24:39], v[80:83], v[188:191], v[24:39]
    ds_read_b64_tr_b16 a[88:89], v154 offset:10240
    ds_read_b64_tr_b16 a[90:91], v154 offset:11264
    ds_read_b64_tr_b16 a[92:93], v155 offset:10240
    ds_read_b64_tr_b16 a[94:95], v155 offset:11264
    v_max3_u32 v152, v152, v80, v81
    v_max3_u32 v152, v152, v82, v83
    s_waitcnt vmcnt(22)
    v_mfma_f32_32x32x16_bf16 v[8:23], v[84:87], v[192:195], v[8:23]
    buffer_load_dwordx4 v[132:135], v2, s[20:23], s34 offen offset:1024 sc1
    v_mfma_f32_32x32x16_bf16 v[24:39], v[84:87], v[196:199], v[24:39]
    ds_read_b64_tr_b16 a[96:97], v154 offset:12288
    ds_read_b64_tr_b16 a[98:99], v154 offset:13312
    ds_read_b64_tr_b16 a[100:101], v155 offset:12288
    ds_read_b64_tr_b16 a[102:103], v155 offset:13312
    v_max3_u32 v152, v152, v84, v85
    v_max3_u32 v152, v152, v86, v87
    s_waitcnt vmcnt(22)
    v_mfma_f32_32x32x16_bf16 v[8:23], v[88:91], v[200:203], v[8:23]
    buffer_load_dwordx4 v[72:75], v2, s[20:23], s34 offen offset:2048 sc1
    v_mfma_f32_32x32x16_bf16 v[24:39], v[88:91], v[204:207], v[24:39]
    ds_read_b64_tr_b16 a[104:105], v154 offset:14336
    ds_read_b64_tr_b16 a[106:107], v154 offset:15360
    ds_read_b64_tr_b16 a[108:109], v155 offset:14336
    ds_read_b64_tr_b16 a[110:111], v155 offset:15360
    v_max3_u32 v152, v152, v88, v89
    v_max3_u32 v152, v152, v90, v91
    s_waitcnt vmcnt(22)
    v_mfma_f32_32x32x16_bf16 v[8:23], v[92:95], v[208:211], v[8:23]
    buffer_load_dwordx4 v[76:79], v2, s[20:23], s34 offen offset:3072 sc1
    s_add_u32 s34, s34, 4096
    v_mfma_f32_32x32x16_bf16 v[24:39], v[92:95], v[212:215], v[24:39]
    ds_read_b64_tr_b16 a[112:113], v154 offset:16384
    ds_read_b64_tr_b16 a[114:115], v154 offset:17408
    ds_read_b64_tr_b16 a[116:117], v155 offset:16384
    ds_read_b64_tr_b16 a[118:119], v155 offset:17408
    v_max3_u32 v152, v152, v92, v93
    v_max3_u32 v152, v152, v94, v95
    s_waitcnt vmcnt(22) lgkmcnt(12)
    v_mfma_f32_32x32x16_bf16 v[8:23], v[96:99], a[48:51], v[8:23]
    buffer_load_dwordx4 v[80:83], v2, s[20:23], s34 offen offset:0 sc1
    v_mfma_f32_32x32x16_bf16 v[24:39], v[96:99], a[52:55], v[24:39]
    ds_read_b64_tr_b16 a[120:121], v154 offset:18432
    ds_read_b64_tr_b16 a[122:123], v154 offset:19456
    ds_read_b64_tr_b16 a[124:125], v155 offset:18432
    ds_read_b64_tr_b16 a[126:127], v155 offset:19456
    v_max3_u32 v152, v152, v96, v97
    v_max3_u32 v152, v152, v98, v99
    s_waitcnt vmcnt(22) lgkmcnt(12)
    v_mfma_f32_32x32x16_bf16 v[8:23], v[100:103], a[56:59], v[8:23]
    buffer_load_dwordx4 v[84:87], v2, s[20:23], s34 offen offset:1024 sc1
    v_mfma_f32_32x32x16_bf16 v[24:39], v[100:103], a[60:63], v[24:39]
    ds_read_b64_tr_b16 a[128:129], v154 offset:20480
    ds_read_b64_tr_b16 a[130:131], v154 offset:21504
    ds_read_b64_tr_b16 a[132:133], v155 offset:20480
    ds_read_b64_tr_b16 a[134:135], v155 offset:21504
    v_max3_u32 v152, v152, v100, v101
    v_max3_u32 v152, v152, v102, v103
    s_waitcnt vmcnt(22) lgkmcnt(12)
    v_mfma_f32_32x32x16_bf16 v[8:23], v[104:107], a[64:67], v[8:23]
    buffer_load_dwordx4 v[88:91], v2, s[20:23], s34 offen offset:2048 sc1
    s_add_u32 s34, s34, 3072
    s_cmp_ge_u32 s34, s41
    s_cselect_b32 s11, 28672, 0
    s_sub_u32 s34, s34, s11
    v_mfma_f32_32x32x16_bf16 v[24:39], v[104:107], a[68:71], v[24:39]
    ds_read_b64_tr_b16 a[136:137], v154 offset:22528
    ds_read_b64_tr_b16 a[138:139], v154 offset:23552
    ds_read_b64_tr_b16 a[140:141], v155 offset:22528
    ds_read_b64_tr_b16 a[142:143], v155 offset:23552
    v_max3_u32 v152, v152, v104, v105
    v_max3_u32 v152, v152, v106, v107
    s_waitcnt vmcnt(22) lgkmcnt(12)
    v_mfma_f32_32x32x16_bf16 v[8:23], v[108:111], a[72:75], v[8:23]
    buffer_load_dwordx4 v[92:95], v2, s[20:23], s34 offen offset:0 sc1
    v_mfma_f32_32x32x16_bf16 v[24:39], v[108:111], a[76:79], v[24:39]
    ds_read_b64_tr_b16 a[144:145], v154 offset:24576
    ds_read_b64_tr_b16 a[146:147], v154 offset:25600
    ds_read_b64_tr_b16 a[148:149], v155 offset:24576
    ds_read_b64_tr_b16 a[150:151], v155 offset:25600
    v_max3_u32 v152, v152, v108, v109
    v_max3_u32 v152, v152, v110, v111
    s_waitcnt vmcnt(22) lgkmcnt(12)
    v_mfma_f32_32x32x16_bf16 v[8:23], v[112:115], a[80:83], v[8:23]
    buffer_load_dwordx4 v[96:99], v2, s[20:23], s34 offen offset:1024 sc1
    buffer_load_dword v229, v228, s[20:23], s37 offen offset:1020 sc1
    v_mfma_f32_32x32x16_bf16 v[24:39], v[112:115], a[84:87], v[24:39]
    ds_read_b64_tr_b16 a[152:153], v154 offset:26624
    ds_read_b64_tr_b16 a[154:155], v154 offset:27648
    ds_read_b64_tr_b16 a[156:157], v155 offset:26624
    ds_read_b64_tr_b16 a[158:159], v155 offset:27648
    v_max3_u32 v152, v152, v112, v113
    v_max3_u32 v152, v152, v114, v115
    s_waitcnt vmcnt(23) lgkmcnt(12)
    v_mfma_f32_32x32x16_bf16 v[8:23], v[116:119], a[88:91], v[8:23]
    buffer_load_dwordx4 v[100:103], v2, s[20:23], s34 offen offset:2048 sc1
    v_mfma_f32_32x32x16_bf16 v[24:39], v[116:119], a[92:95], v[24:39]
    ds_read_b64_tr_b16 a[160:161], v154 offset:28672
    ds_read_b64_tr_b16 a[162:163], v154 offset:29696
    ds_read_b64_tr_b16 a[164:165], v155 offset:28672
    ds_read_b64_tr_b16 a[166:167], v155 offset:29696
    v_max3_u32 v152, v152, v116, v117
    v_max3_u32 v152, v152, v118, v119
    s_waitcnt vmcnt(16) lgkmcnt(12)
    v_mfma_f32_32x32x16_bf16 v[8:23], v[120:123], a[96:99], v[8:23]
    buffer_load_dwordx4 v[104:107], v2, s[20:23], s34 offen offset:3072 sc1
    s_add_u32 s34, s34, 4096
    v_mfma_f32_32x32x16_bf16 v[24:39], v[120:123], a[100:103], v[24:39]
    ds_read_b64_tr_b16 a[168:169], v154 offset:30720
    ds_read_b64_tr_b16 a[170:171], v154 offset:31744
    ds_read_b64_tr_b16 a[172:173], v155 offset:30720
    ds_read_b64_tr_b16 a[174:175], v155 offset:31744
    v_max3_u32 v152, v152, v120, v121
    v_max3_u32 v152, v152, v122, v123
    s_waitcnt vmcnt(16) lgkmcnt(12)
    v_mfma_f32_32x32x16_bf16 v[8:23], v[124:127], a[104:107], v[8:23]
    buffer_load_dwordx4 v[108:111], v2, s[20:23], s34 offen offset:0 sc1
    v_mfma_f32_32x32x16_bf16 v[24:39], v[124:127], a[108:111], v[24:39]
    ds_read_b64_tr_b16 a[176:177], v154 offset:32768
    ds_read_b64_tr_b16 a[178:179], v154 offset:33792
    ds_read_b64_tr_b16 a[180:181], v155 offset:32768
    ds_read_b64_tr_b16 a[182:183], v155 offset:33792
    v_max3_u32 v152, v152, v124, v125
    v_max3_u32 v152, v152, v126, v127
    s_waitcnt vmcnt(12) lgkmcnt(12)
    v_mfma_f32_32x32x16_bf16 v[8:23], v[128:131], a[112:115], v[8:23]
    buffer_load_dwordx4 v[112:115], v2, s[20:23], s34 offen offset:1024 sc1
    v_mfma_f32_32x32x16_bf16 v[24:39], v[128:131], a[116:119], v[24:39]
    s_waitcnt vmcnt(20)
    ds_read_b64_tr_b16 a[184:185], v154 offset:34816
    ds_read_b64_tr_b16 a[186:187], v154 offset:35840
    ds_read_b64_tr_b16 a[188:189], v155 offset:34816
    ds_read_b64_tr_b16 a[190:191], v155 offset:35840
    v_max3_u32 v152, v152, v128, v129
    v_max3_u32 v152, v152, v130, v131
    s_waitcnt vmcnt(12) lgkmcnt(12)
    v_mfma_f32_32x32x16_bf16 v[8:23], v[132:135], a[120:123], v[8:23]
    buffer_load_dwordx4 v[116:119], v2, s[20:23], s34 offen offset:2048 sc1
    s_add_u32 s34, s36, 114688
    s_add_u32 s41, s41, 114688
    v_mfma_f32_32x32x16_bf16 v[24:39], v[132:135], a[124:127], v[24:39]
    ds_read_b64_tr_b16 a[192:193], v154 offset:36864
    ds_read_b64_tr_b16 a[194:195], v154 offset:37888
    ds_read_b64_tr_b16 a[196:197], v155 offset:36864
    ds_read_b64_tr_b16 a[198:199], v155 offset:37888
    v_max3_u32 v152, v152, v132, v133
    v_max3_u32 v152, v152, v134, v135
    s_waitcnt vmcnt(12) lgkmcnt(12)
    v_mfma_f32_32x32x16_bf16 v[8:23], v[72:75], a[128:131], v[8:23]
    s_waitcnt vmcnt(5)
    v_cmp_eq_u32 vcc, -1, v229
    s_nop 4
    s_cbranch_vccnz Lm_g2_wb
Lm_g2_wbe2:
    buffer_load_dwordx4 v[120:123], v2, s[20:23], s34 offen offset:0 sc1
    v_mfma_f32_32x32x16_bf16 v[24:39], v[72:75], a[132:135], v[24:39]
    ds_read_b64_tr_b16 a[200:201], v154 offset:38912
    ds_read_b64_tr_b16 a[202:203], v154 offset:39936
    ds_read_b64_tr_b16 a[204:205], v155 offset:38912
    ds_read_b64_tr_b16 a[206:207], v155 offset:39936
    v_max3_u32 v152, v152, v72, v73
    v_max3_u32 v152, v152, v74, v75
    s_waitcnt vmcnt(12) lgkmcnt(12)
    v_mfma_f32_32x32x16_bf16 v[8:23], v[76:79], a[136:139], v[8:23]
    buffer_load_dwordx4 v[124:127], v2, s[20:23], s34 offen offset:1024 sc1
    v_mfma_f32_32x32x16_bf16 v[24:39], v[76:79], a[140:143], v[24:39]
    s_waitcnt vmcnt(17)
    ds_read_b64_tr_b16 a[208:209], v154 offset:0
    ds_read_b64_tr_b16 a[210:211], v154 offset:1024
    ds_read_b64_tr_b16 a[212:213], v155 offset:0
    ds_read_b64_tr_b16 a[214:215], v155 offset:1024
    v_max3_u32 v152, v152, v76, v77
    v_max3_u32 v152, v152, v78, v79
    s_waitcnt vmcnt(12) lgkmcnt(12)
    v_mfma_f32_32x32x16_bf16 v[8:23], v[80:83], a[144:147], v[8:23]
    buffer_load_dwordx4 v[128:131], v2, s[20:23], s34 offen offset:2048 sc1
    v_mfma_f32_32x32x16_bf16 v[24:39], v[80:83], a[148:151], v[24:39]
    ds_read_b64_tr_b16 a[216:217], v154 offset:2048
    ds_read_b64_tr_b16 a[218:219], v154 offset:3072
    ds_read_b64_tr_b16 a[220:221], v155 offset:2048
    ds_read_b64_tr_b16 a[222:223], v155 offset:3072
    v_max3_u32 v152, v152, v80, v81
    v_max3_u32 v152, v152, v82, v83
    s_waitcnt vmcnt(12) lgkmcnt(12)
    v_mfma_f32_32x32x16_bf16 v[8:23], v[84:87], a[152:155], v[8:23]
    buffer_load_dwordx4 v[132:135], v2, s[20:23], s34 offen offset:3072 sc1
    s_add_u32 s34, s34, 4096
    v_mfma_f32_32x32x16_bf16 v[24:39], v[84:87], a[156:159], v[24:39]
    v_max3_u32 v152, v152, v84, v85
    v_max3_u32 v152, v152, v86, v87
    s_waitcnt vmcnt(12) lgkmcnt(12)
    v_mfma_f32_32x32x16_bf16 v[8:23], v[88:91], a[160:163], v[8:23]
    buffer_load_dwordx4 v[72:75], v2, s[20:23], s34 offen offset:0 sc1
    v_mfma_f32_32x32x16_bf16 v[24:39], v[88:91], a[164:167], v[24:39]
    s_waitcnt lgkmcnt(0)
    s_barrier
    v_max3_u32 v152, v152, v88, v89
    v_max3_u32 v152, v152, v90, v91
    s_waitcnt vmcnt(12)
    v_mfma_f32_32x32x16_bf16 v[8:23], v[92:95], a[168:171], v[8:23]
    buffer_load_dwordx4 v[76:79], v2, s[20:23], s34 offen offset:1024 sc1
    v_mfma_f32_32x32x16_bf16 v[24:39], v[92:95], a[172:175], v[24:39]
    v_max3_u32 v152, v152, v92, v93
    v_max3_u32 v152, v152, v94, v95
    s_waitcnt vmcnt(12)
    v_mfma_f32_32x32x16_bf16 v[8:23], v[96:99], a[176:179], v[8:23]
    buffer_load_dwordx4 v[80:83], v2, s[20:23], s34 offen offset:2048 sc1
    s_add_u32 s34, s34, 3072
    s_cmp_ge_u32 s34, s41
    s_cselect_b32 s11, 28672, 0
    s_sub_u32 s34, s34, s11
    v_mfma_f32_32x32x16_bf16 v[24:39], v[96:99], a[180:183], v[24:39]
    v_max3_u32 v152, v152, v96, v97
    v_max3_u32 v152, v152, v98, v99
    s_waitcnt vmcnt(11)
    v_mfma_f32_32x32x16_bf16 v[8:23], v[100:103], a[184:187], v[8:23]
    buffer_load_dwordx4 v[84:87], v2, s[20:23], s34 offen offset:0 sc1
    v_mfma_f32_32x32x16_bf16 v[24:39], v[100:103], a[188:191], v[24:39]
    v_max3_u32 v152, v152, v100, v101
    v_max3_u32 v152, v152, v102, v103
    s_waitcnt vmcnt(11)
    v_mfma_f32_32x32x16_bf16 v[8:23], v[104:107], a[192:195], v[8:23]
    buffer_load_dwordx4 v[88:91], v2, s[20:23], s34 offen offset:1024 sc1
    v_mfma_f32_32x32x16_bf16 v[24:39], v[104:107], a[196:199], v[24:39]
    v_max3_u32 v152, v152, v104, v105
    v_max3_u32 v152, v152, v106, v107
    s_waitcnt vmcnt(11)
    v_mfma_f32_32x32x16_bf16 v[8:23], v[108:111], a[200:203], v[8:23]
    buffer_load_dwordx4 v[92:95], v2, s[20:23], s34 offen offset:2048 sc1
    v_mfma_f32_32x32x16_bf16 v[24:39], v[108:111], a[204:207], v[24:39]
    v_max3_u32 v152, v152, v108, v109
    v_max3_u32 v152, v152, v110, v111
    s_waitcnt vmcnt(11)
    v_mfma_f32_32x32x16_bf16 v[8:23], v[112:115], a[208:211], v[8:23]
    buffer_load_dwordx4 v[96:99], v2, s[20:23], s34 offen offset:3072 sc1
    s_add_u32 s34, s34, 4096
    v_mfma_f32_32x32x16_bf16 v[24:39], v[112:115], a[212:215], v[24:39]
    v_max3_u32 v152, v152, v112, v113
    v_max3_u32 v152, v152, v114, v115
    s_waitcnt vmcnt(11)
    v_mfma_f32_32x32x16_bf16 v[8:23], v[116:119], a[216:219], v[8:23]
    buffer_load_dwordx4 v[100:103], v2, s[20:23], s34 offen offset:0 sc1
    v_mfma_f32_32x32x16_bf16 v[24:39], v[116:119], a[220:223], v[24:39]
    v_max3_u32 v152, v152, v116, v117
    v_max3_u32 v152, v152, v118, v119
    s_waitcnt vmcnt(11)
    v_mfma_f32_32x32x16_bf16 v[40:55], v[120:123], v[168:171], 0
    buffer_load_dwordx4 v[104:107], v2, s[20:23], s34 offen offset:1024 sc1
    v_mfma_f32_32x32x16_bf16 v[56:71], v[120:123], v[172:175], 0
    v_max3_u32 v152, v152, v120, v121
    v_max3_u32 v152, v152, v122, v123
    s_waitcnt vmcnt(11)
    v_mfma_f32_32x32x16_bf16 v[40:55], v[124:127], v[176:179], v[40:55]
    buffer_load_dwordx4 v[108:111], v2, s[20:23], s34 offen offset:2048 sc1
    s_add_u32 s34, s34, 3072
    s_cmp_ge_u32 s34, s41
    s_cselect_b32 s11, 28672, 0
    s_sub_u32 s34, s34, s11
    v_mfma_f32_32x32x16_bf16 v[56:71], v[124:127], v[180:183], v[56:71]
    v_max3_u32 v152, v152, v124, v125
    v_max3_u32 v152, v152, v126, v127
    s_waitcnt vmcnt(11)
    v_mfma_f32_32x32x16_bf16 v[40:55], v[128:131], v[184:187], v[40:55]
    buffer_load_dwordx4 v[112:115], v2, s[20:23], s34 offen offset:0 sc1
    ds_write_b128 v216, v[8:11] offset:0
    v_mfma_f32_32x32x16_bf16 v[56:71], v[128:131], v[188:191], v[56:71]
    ds_write_b128 v217, v[24:27] offset:0
    v_max3_u32 v152, v152, v128, v129
    v_max3_u32 v152, v152, v130, v131
    s_waitcnt vmcnt(11)
    v_mfma_f32_32x32x16_bf16 v[40:55], v[132:135], v[192:195], v[40:55]
    buffer_load_dwordx4 v[116:119], v2, s[20:23], s34 offen offset:1024 sc1
    ds_write_b128 v216, v[12:15] offset:1024
    v_mfma_f32_32x32x16_bf16 v[56:71], v[132:135], v[196:199], v[56:71]
    ds_write_b128 v217, v[28:31] offset:1024
    v_max3_u32 v152, v152, v132, v133
    v_max3_u32 v152, v152, v134, v135
    s_waitcnt vmcnt(11)
    v_mfma_f32_32x32x16_bf16 v[40:55], v[72:75], v[200:203], v[40:55]
    buffer_load_dwordx4 v[120:123], v2, s[20:23], s34 offen offset:2048 sc1
    ds_write_b128 v216, v[16:19] offset:2048
    v_mfma_f32_32x32x16_bf16 v[56:71], v[72:75], v[204:207], v[56:71]
    ds_write_b128 v217, v[32:35] offset:2048
    v_max3_u32 v152, v152, v72, v73
    v_max3_u32 v152, v152, v74, v75
    s_waitcnt vmcnt(11)
    v_mfma_f32_32x32x16_bf16 v[40:55], v[76:79], v[208:211], v[40:55]
    buffer_load_dwordx4 v[124:127], v2, s[20:23], s34 offen offset:3072 sc1
    s_add_u32 s34, s34, 4096
    ds_write_b128 v216, v[20:23] offset:3072
    v_mfma_f32_32x32x16_bf16 v[56:71], v[76:79], v[212:215], v[56:71]
    ds_write_b128 v217, v[36:39] offset:3072
    v_max3_u32 v152, v152, v76, v77
    v_max3_u32 v152, v152, v78, v79
    s_waitcnt vmcnt(11)
    v_mfma_f32_32x32x16_bf16 v[40:55], v[80:83], a[48:51], v[40:55]
    buffer_load_dwordx4 v[128:131], v2, s[20:23], s34 offen offset:0 sc1
    v_mfma_f32_32x32x16_bf16 v[56:71], v[80:83], a[52:55], v[56:71]
    v_max3_u32 v152, v152, v80, v81
    v_max3_u32 v152, v152, v82, v83
    s_waitcnt vmcnt(11)
    v_mfma_f32_32x32x16_bf16 v[40:55], v[84:87], a[56:59], v[40:55]
    buffer_load_dwordx4 v[132:135], v2, s[20:23], s34 offen offset:1024 sc1
    v_mfma_f32_32x32x16_bf16 v[56:71], v[84:87], a[60:63], v[56:71]
    v_max3_u32 v152, v152, v84, v85
    v_max3_u32 v152, v152, v86, v87
    s_waitcnt vmcnt(11)
    v_mfma_f32_32x32x16_bf16 v[40:55], v[88:91], a[64:67], v[40:55]
    buffer_load_dwordx4 v[72:75], v2, s[20:23], s34 offen offset:2048 sc1
    s_add_u32 s34, s34, 3072
    s_cmp_ge_u32 s34, s41
    s_cselect_b32 s11, 28672, 0
    s_sub_u32 s34, s34, s11
    v_mfma_f32_32x32x16_bf16 v[56:71], v[88:91], a[68:71], v[56:71]
    v_max3_u32 v152, v152, v88, v89
    v_max3_u32 v152, v152, v90, v91
    s_waitcnt vmcnt(11)
    v_mfma_f32_32x32x16_bf16 v[40:55], v[92:95], a[72:75], v[40:55]
    buffer_load_dwordx4 v[76:79], v2, s[20:23], s34 offen offset:0 sc1
    v_mfma_f32_32x32x16_bf16 v[56:71], v[92:95], a[76:79], v[56:71]
    v_max3_u32 v152, v152, v92, v93
    v_max3_u32 v152, v152, v94, v95
    s_waitcnt vmcnt(11)
    v_mfma_f32_32x32x16_bf16 v[40:55], v[96:99], a[80:83], v[40:55]
    buffer_load_dwordx4 v[80:83], v2, s[20:23], s34 offen offset:1024 sc1
    v_mfma_f32_32x32x16_bf16 v[56:71], v[96:99], a[84:87], v[56:71]
    v_max3_u32 v152, v152, v96, v97
    v_max3_u32 v152, v152, v98, v99
    s_waitcnt vmcnt(11)
    v_mfma_f32_32x32x16_bf16 v[40:55], v[100:103], a[88:91], v[40:55]
    buffer_load_dwordx4 v[84:87], v2, s[20:23], s34 offen offset:2048 sc1
    v_mfma_f32_32x32x16_bf16 v[56:71], v[100:103], a[92:95], v[56:71]
    v_max3_u32 v152, v152, v100, v101
    v_max3_u32 v152, v152, v102, v103
    s_waitcnt vmcnt(11)
    v_mfma_f32_32x32x16_bf16 v[40:55], v[104:107], a[96:99], v[40:55]
    buffer_load_dwordx4 v[88:91], v2, s[20:23], s34 offen offset:3072 sc1
    s_add_u32 s34, s34, 4096
    v_mfma_f32_32x32x16_bf16 v[56:71], v[104:107], a[100:103], v[56:71]
    v_max3_u32 v152, v152, v104, v105
    v_max3_u32 v152, v152, v106, v107
    s_waitcnt vmcnt(11)
    v_mfma_f32_32x32x16_bf16 v[40:55], v[108:111], a[104:107], v[40:55]
    buffer_load_dwordx4 v[92:95], v2, s[20:23], s34 offen offset:0 sc1
    v_mfma_f32_32x32x16_bf16 v[56:71], v[108:111], a[108:111], v[56:71]
    v_max3_u32 v152, v152, v108, v109
    v_max3_u32 v152, v152, v110, v111
    s_waitcnt vmcnt(11)
    v_mfma_f32_32x32x16_bf16 v[40:55], v[112:115], a[112:115], v[40:55]
    buffer_load_dwordx4 v[96:99], v2, s[20:23], s34 offen offset:1024 sc1
    v_mfma_f32_32x32x16_bf16 v[56:71], v[112:115], a[116:119], v[56:71]
    v_max3_u32 v152, v152, v112, v113
    v_max3_u32 v152, v152, v114, v115
    s_waitcnt vmcnt(11)
    v_mfma_f32_32x32x16_bf16 v[40:55], v[116:119], a[120:123], v[40:55]
    buffer_load_dwordx4 v[100:103], v2, s[20:23], s34 offen offset:2048 sc1
    v_mfma_f32_32x32x16_bf16 v[56:71], v[116:119], a[124:127], v[56:71]
    v_max3_u32 v152, v152, v116, v117
    v_max3_u32 v152, v152, v118, v119
    s_waitcnt vmcnt(11)
    v_mfma_f32_32x32x16_bf16 v[40:55], v[120:123], a[128:131], v[40:55]
    v_mfma_f32_32x32x16_bf16 v[56:71], v[120:123], a[132:135], v[56:71]
    v_max3_u32 v152, v152, v120, v121
    v_max3_u32 v152, v152, v122, v123
    s_waitcnt vmcnt(10)
    v_mfma_f32_32x32x16_bf16 v[40:55], v[124:127], a[136:139], v[40:55]
    v_mfma_f32_32x32x16_bf16 v[56:71], v[124:127], a[140:143], v[56:71]
    v_max3_u32 v152, v152, v124, v125
    v_max3_u32 v152, v152, v126, v127
    s_waitcnt vmcnt(9)
    v_mfma_f32_32x32x16_bf16 v[40:55], v[128:131], a[144:147], v[40:55]
    v_mfma_f32_32x32x16_bf16 v[56:71], v[128:131], a[148:151], v[56:71]
    v_max3_u32 v152, v152, v128, v129
    v_max3_u32 v152, v152, v130, v131
    s_waitcnt vmcnt(8)
    v_mfma_f32_32x32x16_bf16 v[40:55], v[132:135], a[152:155], v[40:55]
    v_mfma_f32_32x32x16_bf16 v[56:71], v[132:135], a[156:159], v[56:71]
    v_max3_u32 v152, v152, v132, v133
    v_max3_u32 v152, v152, v134, v135
    s_waitcnt vmcnt(7)
    v_mfma_f32_32x32x16_bf16 v[40:55], v[72:75], a[160:163], v[40:55]
    v_mfma_f32_32x32x16_bf16 v[56:71], v[72:75], a[164:167], v[56:71]
    v_max3_u32 v152, v152, v72, v73
    v_max3_u32 v152, v152, v74, v75
    s_waitcnt vmcnt(6)
    v_mfma_f32_32x32x16_bf16 v[40:55], v[76:79], a[168:171], v[40:55]
    v_mfma_f32_32x32x16_bf16 v[56:71], v[76:79], a[172:175], v[56:71]
    v_max3_u32 v152, v152, v76, v77
    v_max3_u32 v152, v152, v78, v79
    s_waitcnt vmcnt(5)
    v_mfma_f32_32x32x16_bf16 v[40:55], v[80:83], a[176:179], v[40:55]
    v_mfma_f32_32x32x16_bf16 v[56:71], v[80:83], a[180:183], v[56:71]
    v_max3_u32 v152, v152, v80, v81
    v_max3_u32 v152, v152, v82, v83
    s_waitcnt vmcnt(4)
    v_mfma_f32_32x32x16_bf16 v[40:55], v[84:87], a[184:187], v[40:55]
    v_mfma_f32_32x32x16_bf16 v[56:71], v[84:87], a[188:191], v[56:71]
    v_max3_u32 v152, v152, v84, v85
    v_max3_u32 v152, v152, v86, v87
    s_waitcnt vmcnt(3)
    v_mfma_f32_32x32x16_bf16 v[40:55], v[88:91], a[192:195], v[40:55]
    v_mfma_f32_32x32x16_bf16 v[56:71], v[88:91], a[196:199], v[56:71]
    v_max3_u32 v152, v152, v88, v89
    v_max3_u32 v152, v152, v90, v91
    s_waitcnt vmcnt(2)
    v_mfma_f32_32x32x16_bf16 v[40:55], v[92:95], a[200:203], v[40:55]
    v_mfma_f32_32x32x16_bf16 v[56:71], v[92:95], a[204:207], v[56:71]
    v_max3_u32 v152, v152, v92, v93
    v_max3_u32 v152, v152, v94, v95
    s_waitcnt vmcnt(1)
    v_mfma_f32_32x32x16_bf16 v[40:55], v[96:99], a[208:211], v[40:55]
    v_mfma_f32_32x32x16_bf16 v[56:71], v[96:99], a[212:215], v[56:71]
    v_max3_u32 v152, v152, v96, v97
    v_max3_u32 v152, v152, v98, v99
    s_waitcnt vmcnt(0)
    v_mfma_f32_32x32x16_bf16 v[40:55], v[100:103], a[216:219], v[40:55]
    v_mfma_f32_32x32x16_bf16 v[56:71], v[100:103], a[220:223], v[56:71]
    v_max3_u32 v152, v152, v100, v101
    v_max3_u32 v152, v152, v102, v103
Lm_g2_fin:
    v_cmp_eq_u32 vcc, -1, v152
    s_nop 7
    ds_write_b128 v218, v[40:43] offset:0
    ds_write_b128 v218, v[44:47] offset:1024
    ds_write_b128 v218, v[48:51] offset:2048
    ds_write_b128 v218, v[52:55] offset:3072
    s_cbranch_vccnz Lm_g2_redo
Lm_g2_ok:
    ds_write_b128 v219, v[56:59] offset:0
    ds_write_b128 v219, v[60:63] offset:1024
    ds_write_b128 v219, v[64:67] offset:2048
    ds_write_b128 v219, v[68:71] offset:3072
    s_waitcnt lgkmcnt(0)
    s_barrier
    ds_read_b128 v[8:11], v220 offset:0
    ds_read_b128 v[12:15], v220 offset:1024
    ds_read_b128 v[16:19], v220 offset:2048
    ds_read_b128 v[20:23], v220 offset:3072
    ds_read_b128 v[24:27], v220 offset:4096
    ds_read_b128 v[28:31], v220 offset:5120
    ds_read_b128 v[32:35], v220 offset:6144
    ds_read_b128 v[36:39], v220 offset:7168
    ds_read_b128 v[40:43], v220 offset:8192
    ds_read_b128 v[44:47], v220 offset:9216
    ds_read_b128 v[48:51], v220 offset:10240
    ds_read_b128 v[52:55], v220 offset:11264
    ds_read_b128 v[56:59], v220 offset:12288
    ds_read_b128 v[60:63], v220 offset:13312
    ds_read_b128 v[64:67], v220 offset:14336
    ds_read_b128 v[68:71], v220 offset:15360
    s_waitcnt lgkmcnt(12)
    v_pk_add_f32 v[240:241], v[240:241], v[8:9]
    v_pk_add_f32 v[242:243], v[242:243], v[10:11]
    v_pk_add_f32 v[244:245], v[244:245], v[12:13]
    v_pk_add_f32 v[246:247], v[246:247], v[14:15]
    v_pk_add_f32 v[248:249], v[248:249], v[16:17]
    v_pk_add_f32 v[250:251], v[250:251], v[18:19]
    v_pk_add_f32 v[252:253], v[252:253], v[20:21]
    v_pk_add_f32 v[254:255], v[254:255], v[22:23]
    s_waitcnt lgkmcnt(8)
    v_pk_add_f32 v[240:241], v[240:241], v[24:25]
    v_pk_add_f32 v[242:243], v[242:243], v[26:27]
    v_pk_add_f32 v[244:245], v[244:245], v[28:29]
    v_pk_add_f32 v[246:247], v[246:247], v[30:31]
    v_pk_add_f32 v[248:249], v[248:249], v[32:33]
    v_pk_add_f32 v[250:251], v[250:251], v[34:35]
    v_pk_add_f32 v[252:253], v[252:253], v[36:37]
    v_pk_add_f32 v[254:255], v[254:255], v[38:39]
    s_waitcnt lgkmcnt(4)
    v_pk_add_f32 v[240:241], v[240:241], v[40:41]
    v_pk_add_f32 v[242:243], v[242:243], v[42:43]
    v_pk_add_f32 v[244:245], v[244:245], v[44:45]
    v_pk_add_f32 v[246:247], v[246:247], v[46:47]
    v_pk_add_f32 v[248:249], v[248:249], v[48:49]
    v_pk_add_f32 v[250:251], v[250:251], v[50:51]
    v_pk_add_f32 v[252:253], v[252:253], v[52:53]
    v_pk_add_f32 v[254:255], v[254:255], v[54:55]
    s_waitcnt lgkmcnt(0)
    v_pk_add_f32 v[240:241], v[240:241], v[56:57]
    v_pk_add_f32 v[242:243], v[242:243], v[58:59]
    v_pk_add_f32 v[244:245], v[244:245], v[60:61]
    v_pk_add_f32 v[246:247], v[246:247], v[62:63]
    v_pk_add_f32 v[248:249], v[248:249], v[64:65]
    v_pk_add_f32 v[250:251], v[250:251], v[66:67]
    v_pk_add_f32 v[252:253], v[252:253], v[68:69]
    v_pk_add_f32 v[254:255], v[254:255], v[70:71]
    v_cvt_pk_bf16_f32 v24, v240, v241
    v_cvt_pk_bf16_f32 v25, v242, v243
    v_cvt_pk_bf16_f32 v26, v244, v245
    v_cvt_pk_bf16_f32 v27, v246, v247
    v_cvt_pk_bf16_f32 v28, v248, v249
    v_cvt_pk_bf16_f32 v29, v250, v251
    v_cvt_pk_bf16_f32 v30, v252, v253
    v_cvt_pk_bf16_f32 v31, v254, v255
    v_permlane32_swap_b32 v24, v26
    v_permlane32_swap_b32 v25, v27
    v_permlane32_swap_b32 v28, v30
    v_permlane32_swap_b32 v29, v31
    buffer_store_dwordx4 v[24:27], v165, s[4:7], s43 offen
    buffer_store_dwordx4 v[28:31], v165, s[4:7], s43 offen offset:32
Lm_end:
    s_endpgm
Lm_idle:
    s_sub_u32 s25, s25, 28
    s_mul_i32 s25, s25, 1835008
    s_lshl_b32 s10, s24, 9
    s_add_u32 s25, s25, s10
    s_and_b32 s10, s24, 3
    s_mul_i32 s10, s10, 112
    v_lshrrev_b32 v3, 2, v0
    v_add_u32 v3, s10, v3
    v_and_b32 v4, 3, v0
    v_lshlrev_b32 v4, 7, v4
    v_subrev_u32 v5, 448, v3
    v_min_u32 v3, v3, v5
    v_lshl_add_u32 v5, v3, 12, v4
    buffer_load_dword v6, v5, s[16:19], s25 offen
    v_add_u32 v3, 64, v3
    v_subrev_u32 v5, 448, v3
    v_min_u32 v3, v3, v5
    v_lshl_add_u32 v5, v3, 12, v4
    buffer_load_dword v6, v5, s[16:19], s25 offen
    v_add_u32 v3, 64, v3
    v_subrev_u32 v5, 448, v3
    v_min_u32 v3, v3, v5
    v_lshl_add_u32 v5, v3, 12, v4
    buffer_load_dword v6, v5, s[16:19], s25 offen
    v_add_u32 v3, 64, v3
    v_subrev_u32 v5, 448, v3
    v_min_u32 v3, v3, v5
    v_lshl_add_u32 v5, v3, 12, v4
    buffer_load_dword v6, v5, s[16:19], s25 offen
    v_add_u32 v3, 64, v3
    v_subrev_u32 v5, 448, v3
    v_min_u32 v3, v3, v5
    v_lshl_add_u32 v5, v3, 12, v4
    buffer_load_dword v6, v5, s[16:19], s25 offen
    v_add_u32 v3, 64, v3
    v_subrev_u32 v5, 448, v3
    v_min_u32 v3, v3, v5
    v_lshl_add_u32 v5, v3, 12, v4
    buffer_load_dword v6, v5, s[16:19], s25 offen
    v_add_u32 v3, 64, v3
    v_subrev_u32 v5, 448, v3
    v_min_u32 v3, v3, v5
    v_lshl_add_u32 v5, v3, 12, v4
    buffer_load_dword v6, v5, s[16:19], s25 offen
    v_add_u32 v3, 64, v3
    s_endpgm
Lm_g1_redoe:
    s_nop 15
    s_cmp_lt_i32 s10, 1
    s_cbranch_scc1 Lm_g1_oke
    s_sub_u32 s10, s10, 1
    s_mov_b32 s27, s38
    s_branch Lm_g1_again
Lm_g1_redo0:
    s_nop 15
    s_cmp_lt_i32 s10, 1
    s_cbranch_scc1 Lm_g1_ok0
    s_sub_u32 s10, s10, 1
    s_mov_b32 s27, s38
    s_branch Lm_g1_again
Lm_g2_wa:
    buffer_load_dword v229, v228, s[20:23], s35 offen offset:1020 sc1
    s_sub_u32 s10, s10, 1
    s_cbranch_scc1 Lm_g2_wae
    s_waitcnt vmcnt(0)
    v_cmp_eq_u32 vcc, -1, v229
    s_nop 4
    s_cbranch_vccnz Lm_g2_wa
Lm_g2_wae:
    s_branch Lm_g2_wae2
Lm_g2_wb:
    buffer_load_dword v229, v228, s[20:23], s37 offen offset:1020 sc1
    s_sub_u32 s10, s10, 1
    s_cbranch_scc1 Lm_g2_wbe
    s_waitcnt vmcnt(0)
    v_cmp_eq_u32 vcc, -1, v229
    s_nop 4
    s_cbranch_vccnz Lm_g2_wb
Lm_g2_wbe:
    s_branch Lm_g2_wbe2
Lm_g1_redo1:
    s_nop 15
    s_cmp_lt_i32 s10, 1
    s_cbranch_scc1 Lm_g1_ok1
    s_sub_u32 s10, s10, 1
    s_waitcnt vmcnt(0)
    v_mov_b32 v152, 0
    s_add_u32 s34, s36, 149760
    s_add_u32 s41, s33, 182528
    buffer_load_dwordx4 v[72:75], v2, s[96:99], s34 offen offset:0 sc1
    buffer_load_dwordx4 v[76:79], v2, s[96:99], s34 offen offset:1024 sc1
    buffer_load_dwordx4 v[80:83], v2, s[96:99], s34 offen offset:2048 sc1
    buffer_load_dwordx4 v[84:87], v2, s[96:99], s34 offen offset:3072 sc1
    s_add_u32 s34, s34, 4096
    buffer_load_dwordx4 v[88:91], v2, s[96:99], s34 offen offset:0 sc1
    buffer_load_dwordx4 v[92:95], v2, s[96:99], s34 offen offset:1024 sc1
    buffer_load_dwordx4 v[96:99], v2, s[96:99], s34 offen offset:2048 sc1
    buffer_load_dwordx4 v[100:103], v2, s[96:99], s34 offen offset:3072 sc1
    s_add_u32 s34, s34, 4096
    s_cmp_ge_u32 s34, s41
    s_cselect_b32 s11, 32768, 0
    s_sub_u32 s34, s34, s11
    buffer_load_dwordx4 v[104:107], v2, s[96:99], s34 offen offset:0 sc1
    buffer_load_dwordx4 v[108:111], v2, s[96:99], s34 offen offset:1024 sc1
    buffer_load_dwordx4 v[112:115], v2, s[96:99], s34 offen offset:2048 sc1
    buffer_load_dwordx4 v[116:119], v2, s[96:99], s34 offen offset:3072 sc1
    s_add_u32 s34, s34, 4096
    s_waitcnt vmcnt(11)
    v_mfma_f32_32x32x16_bf16 v[40:55], a[0:3], v[72:75], v[136:151]
    buffer_load_dwordx4 v[120:123], v2, s[96:99], s34 offen offset:0 sc1
    v_mfma_f32_32x32x16_bf16 v[56:71], a[4:7], v[72:75], 0
    v_max3_u32 v152, v152, v72, v73
    v_max3_u32 v152, v152, v74, v75
    s_waitcnt vmcnt(11)
    v_mfma_f32_32x32x16_bf16 v[40:55], a[8:11], v[76:79], v[40:55]
    buffer_load_dwordx4 v[124:127], v2, s[96:99], s34 offen offset:1024 sc1
    v_mfma_f32_32x32x16_bf16 v[56:71], a[12:15], v[76:79], v[56:71]
    v_max3_u32 v152, v152, v76, v77
    v_max3_u32 v152, v152, v78, v79
    s_waitcnt vmcnt(11)
    v_mfma_f32_32x32x16_bf16 v[40:55], a[16:19], v[80:83], v[40:55]
    buffer_load_dwordx4 v[128:131], v2, s[96:99], s34 offen offset:2048 sc1
    v_mfma_f32_32x32x16_bf16 v[56:71], a[20:23], v[80:83], v[56:71]
    v_max3_u32 v152, v152, v80, v81
    v_max3_u32 v152, v152, v82, v83
    s_waitcnt vmcnt(11)
    v_mfma_f32_32x32x16_bf16 v[40:55], a[24:27], v[84:87], v[40:55]
    buffer_load_dwordx4 v[132:135], v2, s[96:99], s34 offen offset:3072 sc1
    s_add_u32 s34, s34, 4096
    s_cmp_ge_u32 s34, s41
    s_cselect_b32 s11, 32768, 0
    s_sub_u32 s34, s34, s11
    v_mfma_f32_32x32x16_bf16 v[56:71], a[28:31], v[84:87], v[56:71]
    v_max3_u32 v152, v152, v84, v85
    v_max3_u32 v152, v152, v86, v87
    s_waitcnt vmcnt(11)
    v_mfma_f32_32x32x16_bf16 v[40:55], a[32:35], v[88:91], v[40:55]
    buffer_load_dwordx4 v[72:75], v2, s[96:99], s34 offen offset:0 sc1
    v_mfma_f32_32x32x16_bf16 v[56:71], a[36:39], v[88:91], v[56:71]
    v_max3_u32 v152, v152, v88, v89
    v_max3_u32 v152, v152, v90, v91
    s_waitcnt vmcnt(11)
    v_mfma_f32_32x32x16_bf16 v[40:55], a[40:43], v[92:95], v[40:55]
    buffer_load_dwordx4 v[76:79], v2, s[96:99], s34 offen offset:1024 sc1
    v_mfma_f32_32x32x16_bf16 v[56:71], a[44:47], v[92:95], v[56:71]
    v_max3_u32 v152, v152, v92, v93
    v_max3_u32 v152, v152, v94, v95
    s_waitcnt vmcnt(11)
    v_mfma_f32_32x32x16_bf16 v[40:55], a[48:51], v[96:99], v[40:55]
    buffer_load_dwordx4 v[80:83], v2, s[96:99], s34 offen offset:2048 sc1
    v_mfma_f32_32x32x16_bf16 v[56:71], a[52:55], v[96:99], v[56:71]
    v_max3_u32 v152, v152, v96, v97
    v_max3_u32 v152, v152, v98, v99
    s_waitcnt vmcnt(11)
    v_mfma_f32_32x32x16_bf16 v[40:55], a[56:59], v[100:103], v[40:55]
    buffer_load_dwordx4 v[84:87], v2, s[96:99], s34 offen offset:3072 sc1
    s_add_u32 s34, s34, 4096
    v_mfma_f32_32x32x16_bf16 v[56:71], a[60:63], v[100:103], v[56:71]
    v_max3_u32 v152, v152, v100, v101
    v_max3_u32 v152, v152, v102, v103
    s_waitcnt vmcnt(11)
    v_mfma_f32_32x32x16_bf16 v[40:55], a[64:67], v[104:107], v[40:55]
    buffer_load_dwordx4 v[88:91], v2, s[96:99], s34 offen offset:0 sc1
    v_mfma_f32_32x32x16_bf16 v[56:71], a[68:71], v[104:107], v[56:71]
    v_max3_u32 v152, v152, v104, v105
    v_max3_u32 v152, v152, v106, v107
    s_waitcnt vmcnt(11)
    v_mfma_f32_32x32x16_bf16 v[40:55], a[72:75], v[108:111], v[40:55]
    buffer_load_dwordx4 v[92:95], v2, s[96:99], s34 offen offset:1024 sc1
    v_mfma_f32_32x32x16_bf16 v[56:71], a[76:79], v[108:111], v[56:71]
    v_max3_u32 v152, v152, v108, v109
    v_max3_u32 v152, v152, v110, v111
    s_waitcnt vmcnt(11)
    v_mfma_f32_32x32x16_bf16 v[40:55], a[80:83], v[112:115], v[40:55]
    buffer_load_dwordx4 v[96:99], v2, s[96:99], s34 offen offset:2048 sc1
    v_mfma_f32_32x32x16_bf16 v[56:71], a[84:87], v[112:115], v[56:71]
    v_max3_u32 v152, v152, v112, v113
    v_max3_u32 v152, v152, v114, v115
    s_waitcnt vmcnt(11)
    v_mfma_f32_32x32x16_bf16 v[40:55], a[88:91], v[116:119], v[40:55]
    buffer_load_dwordx4 v[100:103], v2, s[96:99], s34 offen offset:3072 sc1
    s_add_u32 s34, s34, 4096
    s_cmp_ge_u32 s34, s41
    s_cselect_b32 s11, 32768, 0
    s_sub_u32 s34, s34, s11
    v_mfma_f32_32x32x16_bf16 v[56:71], a[92:95], v[116:119], v[56:71]
    v_max3_u32 v152, v152, v116, v117
    v_max3_u32 v152, v152, v118, v119
    s_waitcnt vmcnt(11)
    v_mfma_f32_32x32x16_bf16 v[40:55], a[96:99], v[120:123], v[40:55]
    buffer_load_dwordx4 v[104:107], v2, s[96:99], s34 offen offset:0 sc1
    v_mfma_f32_32x32x16_bf16 v[56:71], a[100:103], v[120:123], v[56:71]
    v_max3_u32 v152, v152, v120, v121
    v_max3_u32 v152, v152, v122, v123
    s_waitcnt vmcnt(11)
    v_mfma_f32_32x32x16_bf16 v[40:55], a[104:107], v[124:127], v[40:55]
    buffer_load_dwordx4 v[108:111], v2, s[96:99], s34 offen offset:1024 sc1
    v_mfma_f32_32x32x16_bf16 v[56:71], a[108:111], v[124:127], v[56:71]
    v_max3_u32 v152, v152, v124, v125
    v_max3_u32 v152, v152, v126, v127
    s_waitcnt vmcnt(11)
    v_mfma_f32_32x32x16_bf16 v[40:55], a[112:115], v[128:131], v[40:55]
    buffer_load_dwordx4 v[112:115], v2, s[96:99], s34 offen offset:2048 sc1
    v_mfma_f32_32x32x16_bf16 v[56:71], a[116:119], v[128:131], v[56:71]
    v_max3_u32 v152, v152, v128, v129
    v_max3_u32 v152, v152, v130, v131
    s_waitcnt vmcnt(11)
    v_mfma_f32_32x32x16_bf16 v[40:55], a[120:123], v[132:135], v[40:55]
    buffer_load_dwordx4 v[116:119], v2, s[96:99], s34 offen offset:3072 sc1
    s_add_u32 s34, s34, 4096
    v_mfma_f32_32x32x16_bf16 v[56:71], a[124:127], v[132:135], v[56:71]
    v_max3_u32 v152, v152, v132, v133
    v_max3_u32 v152, v152, v134, v135
    s_waitcnt vmcnt(11)
    v_mfma_f32_32x32x16_bf16 v[40:55], a[128:131], v[72:75], v[40:55]
    buffer_load_dwordx4 v[120:123], v2, s[96:99], s34 offen offset:0 sc1
    v_mfma_f32_32x32x16_bf16 v[56:71], a[132:135], v[72:75], v[56:71]
    v_max3_u32 v152, v152, v72, v73
    v_max3_u32 v152, v152, v74, v75
    s_waitcnt vmcnt(11)
    v_mfma_f32_32x32x16_bf16 v[40:55], a[136:139], v[76:79], v[40:55]
    buffer_load_dwordx4 v[124:127], v2, s[96:99], s34 offen offset:1024 sc1
    v_mfma_f32_32x32x16_bf16 v[56:71], a[140:143], v[76:79], v[56:71]
    v_max3_u32 v152, v152, v76, v77
    v_max3_u32 v152, v152, v78, v79
    s_waitcnt vmcnt(11)
    v_mfma_f32_32x32x16_bf16 v[40:55], a[144:147], v[80:83], v[40:55]
    buffer_load_dwordx4 v[128:131], v2, s[96:99], s34 offen offset:2048 sc1
    v_mfma_f32_32x32x16_bf16 v[56:71], a[148:151], v[80:83], v[56:71]
    v_max3_u32 v152, v152, v80, v81
    v_max3_u32 v152, v152, v82, v83
    s_waitcnt vmcnt(11)
    v_mfma_f32_32x32x16_bf16 v[40:55], a[152:155], v[84:87], v[40:55]
    buffer_load_dwordx4 v[132:135], v2, s[96:99], s34 offen offset:3072 sc1
    v_mfma_f32_32x32x16_bf16 v[56:71], a[156:159], v[84:87], v[56:71]
    v_max3_u32 v152, v152, v84, v85
    v_max3_u32 v152, v152, v86, v87
    s_waitcnt vmcnt(11)
    v_mfma_f32_32x32x16_bf16 v[40:55], a[160:163], v[88:91], v[40:55]
    v_mfma_f32_32x32x16_bf16 v[56:71], a[164:167], v[88:91], v[56:71]
    v_max3_u32 v152, v152, v88, v89
    v_max3_u32 v152, v152, v90, v91
    s_waitcnt vmcnt(10)
    v_mfma_f32_32x32x16_bf16 v[40:55], a[168:171], v[92:95], v[40:55]
    v_mfma_f32_32x32x16_bf16 v[56:71], a[172:175], v[92:95], v[56:71]
    v_max3_u32 v152, v152, v92, v93
    v_max3_u32 v152, v152, v94, v95
    s_waitcnt vmcnt(9)
    v_mfma_f32_32x32x16_bf16 v[40:55], a[176:179], v[96:99], v[40:55]
    v_mfma_f32_32x32x16_bf16 v[56:71], a[180:183], v[96:99], v[56:71]
    v_max3_u32 v152, v152, v96, v97
    v_max3_u32 v152, v152, v98, v99
    s_waitcnt vmcnt(8)
    v_mfma_f32_32x32x16_bf16 v[40:55], a[184:187], v[100:103], v[40:55]
    v_mfma_f32_32x32x16_bf16 v[56:71], a[188:191], v[100:103], v[56:71]
    v_max3_u32 v152, v152, v100, v101
    v_max3_u32 v152, v152, v102, v103
    s_waitcnt vmcnt(7)
    v_mfma_f32_32x32x16_bf16 v[40:55], a[192:195], v[104:107], v[40:55]
    v_mfma_f32_32x32x16_bf16 v[56:71], a[196:199], v[104:107], v[56:71]
    v_max3_u32 v152, v152, v104, v105
    v_max3_u32 v152, v152, v106, v107
    s_waitcnt vmcnt(6)
    v_mfma_f32_32x32x16_bf16 v[40:55], a[200:203], v[108:111], v[40:55]
    v_mfma_f32_32x32x16_bf16 v[56:71], a[204:207], v[108:111], v[56:71]
    v_max3_u32 v152, v152, v108, v109
    v_max3_u32 v152, v152, v110, v111
    s_waitcnt vmcnt(5)
    v_mfma_f32_32x32x16_bf16 v[40:55], a[208:211], v[112:115], v[40:55]
    v_mfma_f32_32x32x16_bf16 v[56:71], a[212:215], v[112:115], v[56:71]
    v_max3_u32 v152, v152, v112, v113
    v_max3_u32 v152, v152, v114, v115
    s_waitcnt vmcnt(4)
    v_mfma_f32_32x32x16_bf16 v[40:55], a[216:219], v[116:119], v[40:55]
    v_mfma_f32_32x32x16_bf16 v[56:71], a[220:223], v[116:119], v[56:71]
    v_max3_u32 v152, v152, v116, v117
    v_max3_u32 v152, v152, v118, v119
    s_waitcnt vmcnt(3)
    v_mfma_f32_32x32x16_bf16 v[40:55], a[224:227], v[120:123], v[40:55]
    v_mfma_f32_32x32x16_bf16 v[56:71], a[228:231], v[120:123], v[56:71]
    v_max3_u32 v152, v152, v120, v121
    v_max3_u32 v152, v152, v122, v123
    s_waitcnt vmcnt(2)
    v_mfma_f32_32x32x16_bf16 v[40:55], a[232:235], v[124:127], v[40:55]
    v_mfma_f32_32x32x16_bf16 v[56:71], a[236:239], v[124:127], v[56:71]
    v_max3_u32 v152, v152, v124, v125
    v_max3_u32 v152, v152, v126, v127
    s_waitcnt vmcnt(1)
    v_mfma_f32_32x32x16_bf16 v[40:55], a[240:243], v[128:131], v[40:55]
    v_mfma_f32_32x32x16_bf16 v[56:71], a[244:247], v[128:131], v[56:71]
    v_max3_u32 v152, v152, v128, v129
    v_max3_u32 v152, v152, v130, v131
    s_waitcnt vmcnt(0)
    v_mfma_f32_32x32x16_bf16 v[56:71], a[252:255], v[132:135], v[56:71]
    v_mfma_f32_32x32x16_bf16 v[40:55], a[248:251], v[132:135], v[40:55]
    v_max3_u32 v152, v152, v132, v133
    v_max3_u32 v152, v152, v134, v135
    s_nop 15
    s_branch Lm_g1_fin
Lm_g2_redo:
    s_nop 15
    s_cmp_lt_i32 s10, 1
    s_cbranch_scc1 Lm_g2_ok
    s_sub_u32 s10, s10, 1
    v_mov_b32 v152, 0
    s_add_u32 s34, s36, 0
    s_add_u32 s41, s33, 28672
    buffer_load_dwordx4 v[72:75], v2, s[20:23], s34 offen offset:0 sc1
    buffer_load_dwordx4 v[76:79], v2, s[20:23], s34 offen offset:1024 sc1
    buffer_load_dwordx4 v[80:83], v2, s[20:23], s34 offen offset:2048 sc1
    buffer_load_dwordx4 v[84:87], v2, s[20:23], s34 offen offset:3072 sc1
    s_add_u32 s34, s34, 4096
    buffer_load_dwordx4 v[88:91], v2, s[20:23], s34 offen offset:0 sc1
    buffer_load_dwordx4 v[92:95], v2, s[20:23], s34 offen offset:1024 sc1
    buffer_load_dwordx4 v[96:99], v2, s[20:23], s34 offen offset:2048 sc1
    s_add_u32 s34, s34, 3072
    s_cmp_ge_u32 s34, s41
    s_cselect_b32 s11, 28672, 0
    s_sub_u32 s34, s34, s11
    buffer_load_dwordx4 v[100:103], v2, s[20:23], s34 offen offset:0 sc1
    buffer_load_dwordx4 v[104:107], v2, s[20:23], s34 offen offset:1024 sc1
    buffer_load_dwordx4 v[108:111], v2, s[20:23], s34 offen offset:2048 sc1
    buffer_load_dwordx4 v[112:115], v2, s[20:23], s34 offen offset:3072 sc1
    s_add_u32 s34, s34, 4096
    buffer_load_dwordx4 v[116:119], v2, s[20:23], s34 offen offset:0 sc1
    s_waitcnt vmcnt(11)
    v_mfma_f32_32x32x16_bf16 v[8:23], v[72:75], v[168:171], 0
    buffer_load_dwordx4 v[120:123], v2, s[20:23], s34 offen offset:1024 sc1
    v_mfma_f32_32x32x16_bf16 v[24:39], v[72:75], v[172:175], 0
    v_max3_u32 v152, v152, v72, v73
    v_max3_u32 v152, v152, v74, v75
    s_waitcnt vmcnt(11)
    v_mfma_f32_32x32x16_bf16 v[8:23], v[76:79], v[176:179], v[8:23]
    buffer_load_dwordx4 v[124:127], v2, s[20:23], s34 offen offset:2048 sc1
    s_add_u32 s34, s34, 3072
    s_cmp_ge_u32 s34, s41
    s_cselect_b32 s11, 28672, 0
    s_sub_u32 s34, s34, s11
    v_mfma_f32_32x32x16_bf16 v[24:39], v[76:79], v[180:183], v[24:39]
    v_max3_u32 v152, v152, v76, v77
    v_max3_u32 v152, v152, v78, v79
    s_waitcnt vmcnt(11)
    v_mfma_f32_32x32x16_bf16 v[8:23], v[80:83], v[184:187], v[8:23]
    buffer_load_dwordx4 v[128:131], v2, s[20:23], s34 offen offset:0 sc1
    v_mfma_f32_32x32x16_bf16 v[24:39], v[80:83], v[188:191], v[24:39]
    v_max3_u32 v152, v152, v80, v81
    v_max3_u32 v152, v152, v82, v83
    s_waitcnt vmcnt(11)
    v_mfma_f32_32x32x16_bf16 v[8:23], v[84:87], v[192:195], v[8:23]
    buffer_load_dwordx4 v[132:135], v2, s[20:23], s34 offen offset:1024 sc1
    v_mfma_f32_32x32x16_bf16 v[24:39], v[84:87], v[196:199], v[24:39]
    v_max3_u32 v152, v152, v84, v85
    v_max3_u32 v152, v152, v86, v87
    s_waitcnt vmcnt(11)
    v_mfma_f32_32x32x16_bf16 v[8:23], v[88:91], v[200:203], v[8:23]
    buffer_load_dwordx4 v[72:75], v2, s[20:23], s34 offen offset:2048 sc1
    v_mfma_f32_32x32x16_bf16 v[24:39], v[88:91], v[204:207], v[24:39]
    v_max3_u32 v152, v152, v88, v89
    v_max3_u32 v152, v152, v90, v91
    s_waitcnt vmcnt(11)
    v_mfma_f32_32x32x16_bf16 v[8:23], v[92:95], v[208:211], v[8:23]
    buffer_load_dwordx4 v[76:79], v2, s[20:23], s34 offen offset:3072 sc1
    s_add_u32 s34, s34, 4096
    v_mfma_f32_32x32x16_bf16 v[24:39], v[92:95], v[212:215], v[24:39]
    v_max3_u32 v152, v152, v92, v93
    v_max3_u32 v152, v152, v94, v95
    s_waitcnt vmcnt(11)
    v_mfma_f32_32x32x16_bf16 v[8:23], v[96:99], a[48:51], v[8:23]
    buffer_load_dwordx4 v[80:83], v2, s[20:23], s34 offen offset:0 sc1
    v_mfma_f32_32x32x16_bf16 v[24:39], v[96:99], a[52:55], v[24:39]
    v_max3_u32 v152, v152, v96, v97
    v_max3_u32 v152, v152, v98, v99
    s_waitcnt vmcnt(11)
    v_mfma_f32_32x32x16_bf16 v[8:23], v[100:103], a[56:59], v[8:23]
    buffer_load_dwordx4 v[84:87], v2, s[20:23], s34 offen offset:1024 sc1
    v_mfma_f32_32x32x16_bf16 v[24:39], v[100:103], a[60:63], v[24:39]
    v_max3_u32 v152, v152, v100, v101
    v_max3_u32 v152, v152, v102, v103
    s_waitcnt vmcnt(11)
    v_mfma_f32_32x32x16_bf16 v[8:23], v[104:107], a[64:67], v[8:23]
    buffer_load_dwordx4 v[88:91], v2, s[20:23], s34 offen offset:2048 sc1
    s_add_u32 s34, s34, 3072
    s_cmp_ge_u32 s34, s41
    s_cselect_b32 s11, 28672, 0
    s_sub_u32 s34, s34, s11
    v_mfma_f32_32x32x16_bf16 v[24:39], v[104:107], a[68:71], v[24:39]
    v_max3_u32 v152, v152, v104, v105
    v_max3_u32 v152, v152, v106, v107
    s_waitcnt vmcnt(11)
    v_mfma_f32_32x32x16_bf16 v[8:23], v[108:111], a[72:75], v[8:23]
    buffer_load_dwordx4 v[92:95], v2, s[20:23], s34 offen offset:0 sc1
    v_mfma_f32_32x32x16_bf16 v[24:39], v[108:111], a[76:79], v[24:39]
    v_max3_u32 v152, v152, v108, v109
    v_max3_u32 v152, v152, v110, v111
    s_waitcnt vmcnt(11)
    v_mfma_f32_32x32x16_bf16 v[8:23], v[112:115], a[80:83], v[8:23]
    buffer_load_dwordx4 v[96:99], v2, s[20:23], s34 offen offset:1024 sc1
    v_mfma_f32_32x32x16_bf16 v[24:39], v[112:115], a[84:87], v[24:39]
    v_max3_u32 v152, v152, v112, v113
    v_max3_u32 v152, v152, v114, v115
    s_waitcnt vmcnt(11)
    v_mfma_f32_32x32x16_bf16 v[8:23], v[116:119], a[88:91], v[8:23]
    buffer_load_dwordx4 v[100:103], v2, s[20:23], s34 offen offset:2048 sc1
    v_mfma_f32_32x32x16_bf16 v[24:39], v[116:119], a[92:95], v[24:39]
    v_max3_u32 v152, v152, v116, v117
    v_max3_u32 v152, v152, v118, v119
    s_waitcnt vmcnt(11)
    v_mfma_f32_32x32x16_bf16 v[8:23], v[120:123], a[96:99], v[8:23]
    buffer_load_dwordx4 v[104:107], v2, s[20:23], s34 offen offset:3072 sc1
    s_add_u32 s34, s34, 4096
    v_mfma_f32_32x32x16_bf16 v[24:39], v[120:123], a[100:103], v[24:39]
    v_max3_u32 v152, v152, v120, v121
    v_max3_u32 v152, v152, v122, v123
    s_waitcnt vmcnt(11)
    v_mfma_f32_32x32x16_bf16 v[8:23], v[124:127], a[104:107], v[8:23]
    buffer_load_dwordx4 v[108:111], v2, s[20:23], s34 offen offset:0 sc1
    v_mfma_f32_32x32x16_bf16 v[24:39], v[124:127], a[108:111], v[24:39]
    v_max3_u32 v152, v152, v124, v125
    v_max3_u32 v152, v152, v126, v127
    s_waitcnt vmcnt(11)
    v_mfma_f32_32x32x16_bf16 v[8:23], v[128:131], a[112:115], v[8:23]
    buffer_load_dwordx4 v[112:115], v2, s[20:23], s34 offen offset:1024 sc1
    v_mfma_f32_32x32x16_bf16 v[24:39], v[128:131], a[116:119], v[24:39]
    v_max3_u32 v152, v152, v128, v129
    v_max3_u32 v152, v152, v130, v131
    s_waitcnt vmcnt(11)
    v_mfma_f32_32x32x16_bf16 v[8:23], v[132:135], a[120:123], v[8:23]
    buffer_load_dwordx4 v[116:119], v2, s[20:23], s34 offen offset:2048 sc1
    s_add_u32 s34, s36, 114688
    s_add_u32 s41, s41, 114688
    v_mfma_f32_32x32x16_bf16 v[24:39], v[132:135], a[124:127], v[24:39]
    v_max3_u32 v152, v152, v132, v133
    v_max3_u32 v152, v152, v134, v135
    s_waitcnt vmcnt(11)
    v_mfma_f32_32x32x16_bf16 v[8:23], v[72:75], a[128:131], v[8:23]
    buffer_load_dwordx4 v[120:123], v2, s[20:23], s34 offen offset:0 sc1
    v_mfma_f32_32x32x16_bf16 v[24:39], v[72:75], a[132:135], v[24:39]
    v_max3_u32 v152, v152, v72, v73
    v_max3_u32 v152, v152, v74, v75
    s_waitcnt vmcnt(11)
    v_mfma_f32_32x32x16_bf16 v[8:23], v[76:79], a[136:139], v[8:23]
    buffer_load_dwordx4 v[124:127], v2, s[20:23], s34 offen offset:1024 sc1
    v_mfma_f32_32x32x16_bf16 v[24:39], v[76:79], a[140:143], v[24:39]
    v_max3_u32 v152, v152, v76, v77
    v_max3_u32 v152, v152, v78, v79
    s_waitcnt vmcnt(11)
    v_mfma_f32_32x32x16_bf16 v[8:23], v[80:83], a[144:147], v[8:23]
    buffer_load_dwordx4 v[128:131], v2, s[20:23], s34 offen offset:2048 sc1
    v_mfma_f32_32x32x16_bf16 v[24:39], v[80:83], a[148:151], v[24:39]
    v_max3_u32 v152, v152, v80, v81
    v_max3_u32 v152, v152, v82, v83
    s_waitcnt vmcnt(11)
    v_mfma_f32_32x32x16_bf16 v[8:23], v[84:87], a[152:155], v[8:23]
    buffer_load_dwordx4 v[132:135], v2, s[20:23], s34 offen offset:3072 sc1
    s_add_u32 s34, s34, 4096
    v_mfma_f32_32x32x16_bf16 v[24:39], v[84:87], a[156:159], v[24:39]
    v_max3_u32 v152, v152, v84, v85
    v_max3_u32 v152, v152, v86, v87
    s_waitcnt vmcnt(11)
    v_mfma_f32_32x32x16_bf16 v[8:23], v[88:91], a[160:163], v[8:23]
    buffer_load_dwordx4 v[72:75], v2, s[20:23], s34 offen offset:0 sc1
    v_mfma_f32_32x32x16_bf16 v[24:39], v[88:91], a[164:167], v[24:39]
    v_max3_u32 v152, v152, v88, v89
    v_max3_u32 v152, v152, v90, v91
    s_waitcnt vmcnt(11)
    v_mfma_f32_32x32x16_bf16 v[8:23], v[92:95], a[168:171], v[8:23]
    buffer_load_dwordx4 v[76:79], v2, s[20:23], s34 offen offset:1024 sc1
    v_mfma_f32_32x32x16_bf16 v[24:39], v[92:95], a[172:175], v[24:39]
    v_max3_u32 v152, v152, v92, v93
    v_max3_u32 v152, v152, v94, v95
    s_waitcnt vmcnt(11)
    v_mfma_f32_32x32x16_bf16 v[8:23], v[96:99], a[176:179], v[8:23]
    buffer_load_dwordx4 v[80:83], v2, s[20:23], s34 offen offset:2048 sc1
    s_add_u32 s34, s34, 3072
    s_cmp_ge_u32 s34, s41
    s_cselect_b32 s11, 28672, 0
    s_sub_u32 s34, s34, s11
    v_mfma_f32_32x32x16_bf16 v[24:39], v[96:99], a[180:183], v[24:39]
    v_max3_u32 v152, v152, v96, v97
    v_max3_u32 v152, v152, v98, v99
    s_waitcnt vmcnt(11)
    v_mfma_f32_32x32x16_bf16 v[8:23], v[100:103], a[184:187], v[8:23]
    buffer_load_dwordx4 v[84:87], v2, s[20:23], s34 offen offset:0 sc1
    v_mfma_f32_32x32x16_bf16 v[24:39], v[100:103], a[188:191], v[24:39]
    v_max3_u32 v152, v152, v100, v101
    v_max3_u32 v152, v152, v102, v103
    s_waitcnt vmcnt(11)
    v_mfma_f32_32x32x16_bf16 v[8:23], v[104:107], a[192:195], v[8:23]
    buffer_load_dwordx4 v[88:91], v2, s[20:23], s34 offen offset:1024 sc1
    v_mfma_f32_32x32x16_bf16 v[24:39], v[104:107], a[196:199], v[24:39]
    v_max3_u32 v152, v152, v104, v105
    v_max3_u32 v152, v152, v106, v107
    s_waitcnt vmcnt(11)
    v_mfma_f32_32x32x16_bf16 v[8:23], v[108:111], a[200:203], v[8:23]
    buffer_load_dwordx4 v[92:95], v2, s[20:23], s34 offen offset:2048 sc1
    v_mfma_f32_32x32x16_bf16 v[24:39], v[108:111], a[204:207], v[24:39]
    v_max3_u32 v152, v152, v108, v109
    v_max3_u32 v152, v152, v110, v111
    s_waitcnt vmcnt(11)
    v_mfma_f32_32x32x16_bf16 v[8:23], v[112:115], a[208:211], v[8:23]
    buffer_load_dwordx4 v[96:99], v2, s[20:23], s34 offen offset:3072 sc1
    s_add_u32 s34, s34, 4096
    v_mfma_f32_32x32x16_bf16 v[24:39], v[112:115], a[212:215], v[24:39]
    v_max3_u32 v152, v152, v112, v113
    v_max3_u32 v152, v152, v114, v115
    s_waitcnt vmcnt(11)
    v_mfma_f32_32x32x16_bf16 v[8:23], v[116:119], a[216:219], v[8:23]
    buffer_load_dwordx4 v[100:103], v2, s[20:23], s34 offen offset:0 sc1
    v_mfma_f32_32x32x16_bf16 v[24:39], v[116:119], a[220:223], v[24:39]
    v_max3_u32 v152, v152, v116, v117
    v_max3_u32 v152, v152, v118, v119
    s_waitcnt vmcnt(11)
    v_mfma_f32_32x32x16_bf16 v[40:55], v[120:123], v[168:171], 0
    buffer_load_dwordx4 v[104:107], v2, s[20:23], s34 offen offset:1024 sc1
    v_mfma_f32_32x32x16_bf16 v[56:71], v[120:123], v[172:175], 0
    v_max3_u32 v152, v152, v120, v121
    v_max3_u32 v152, v152, v122, v123
    s_waitcnt vmcnt(11)
    v_mfma_f32_32x32x16_bf16 v[40:55], v[124:127], v[176:179], v[40:55]
    buffer_load_dwordx4 v[108:111], v2, s[20:23], s34 offen offset:2048 sc1
    s_add_u32 s34, s34, 3072
    s_cmp_ge_u32 s34, s41
    s_cselect_b32 s11, 28672, 0
    s_sub_u32 s34, s34, s11
    v_mfma_f32_32x32x16_bf16 v[56:71], v[124:127], v[180:183], v[56:71]
    v_max3_u32 v152, v152, v124, v125
    v_max3_u32 v152, v152, v126, v127
    s_waitcnt vmcnt(11)
    v_mfma_f32_32x32x16_bf16 v[40:55], v[128:131], v[184:187], v[40:55]
    buffer_load_dwordx4 v[112:115], v2, s[20:23], s34 offen offset:0 sc1
    ds_write_b128 v216, v[8:11] offset:0
    v_mfma_f32_32x32x16_bf16 v[56:71], v[128:131], v[188:191], v[56:71]
    ds_write_b128 v217, v[24:27] offset:0
    v_max3_u32 v152, v152, v128, v129
    v_max3_u32 v152, v152, v130, v131
    s_waitcnt vmcnt(11)
    v_mfma_f32_32x32x16_bf16 v[40:55], v[132:135], v[192:195], v[40:55]
    buffer_load_dwordx4 v[116:119], v2, s[20:23], s34 offen offset:1024 sc1
    ds_write_b128 v216, v[12:15] offset:1024
    v_mfma_f32_32x32x16_bf16 v[56:71], v[132:135], v[196:199], v[56:71]
    ds_write_b128 v217, v[28:31] offset:1024
    v_max3_u32 v152, v152, v132, v133
    v_max3_u32 v152, v152, v134, v135
    s_waitcnt vmcnt(11)
    v_mfma_f32_32x32x16_bf16 v[40:55], v[72:75], v[200:203], v[40:55]
    buffer_load_dwordx4 v[120:123], v2, s[20:23], s34 offen offset:2048 sc1
    ds_write_b128 v216, v[16:19] offset:2048
    v_mfma_f32_32x32x16_bf16 v[56:71], v[72:75], v[204:207], v[56:71]
    ds_write_b128 v217, v[32:35] offset:2048
    v_max3_u32 v152, v152, v72, v73
    v_max3_u32 v152, v152, v74, v75
    s_waitcnt vmcnt(11)
    v_mfma_f32_32x32x16_bf16 v[40:55], v[76:79], v[208:211], v[40:55]
    buffer_load_dwordx4 v[124:127], v2, s[20:23], s34 offen offset:3072 sc1
    s_add_u32 s34, s34, 4096
    ds_write_b128 v216, v[20:23] offset:3072
    v_mfma_f32_32x32x16_bf16 v[56:71], v[76:79], v[212:215], v[56:71]
    ds_write_b128 v217, v[36:39] offset:3072
    v_max3_u32 v152, v152, v76, v77
    v_max3_u32 v152, v152, v78, v79
    s_waitcnt vmcnt(11)
    v_mfma_f32_32x32x16_bf16 v[40:55], v[80:83], a[48:51], v[40:55]
    buffer_load_dwordx4 v[128:131], v2, s[20:23], s34 offen offset:0 sc1
    v_mfma_f32_32x32x16_bf16 v[56:71], v[80:83], a[52:55], v[56:71]
    v_max3_u32 v152, v152, v80, v81
    v_max3_u32 v152, v152, v82, v83
    s_waitcnt vmcnt(11)
    v_mfma_f32_32x32x16_bf16 v[40:55], v[84:87], a[56:59], v[40:55]
    buffer_load_dwordx4 v[132:135], v2, s[20:23], s34 offen offset:1024 sc1
    v_mfma_f32_32x32x16_bf16 v[56:71], v[84:87], a[60:63], v[56:71]
    v_max3_u32 v152, v152, v84, v85
    v_max3_u32 v152, v152, v86, v87
    s_waitcnt vmcnt(11)
    v_mfma_f32_32x32x16_bf16 v[40:55], v[88:91], a[64:67], v[40:55]
    buffer_load_dwordx4 v[72:75], v2, s[20:23], s34 offen offset:2048 sc1
    s_add_u32 s34, s34, 3072
    s_cmp_ge_u32 s34, s41
    s_cselect_b32 s11, 28672, 0
    s_sub_u32 s34, s34, s11
    v_mfma_f32_32x32x16_bf16 v[56:71], v[88:91], a[68:71], v[56:71]
    v_max3_u32 v152, v152, v88, v89
    v_max3_u32 v152, v152, v90, v91
    s_waitcnt vmcnt(11)
    v_mfma_f32_32x32x16_bf16 v[40:55], v[92:95], a[72:75], v[40:55]
    buffer_load_dwordx4 v[76:79], v2, s[20:23], s34 offen offset:0 sc1
    v_mfma_f32_32x32x16_bf16 v[56:71], v[92:95], a[76:79], v[56:71]
    v_max3_u32 v152, v152, v92, v93
    v_max3_u32 v152, v152, v94, v95
    s_waitcnt vmcnt(11)
    v_mfma_f32_32x32x16_bf16 v[40:55], v[96:99], a[80:83], v[40:55]
    buffer_load_dwordx4 v[80:83], v2, s[20:23], s34 offen offset:1024 sc1
    v_mfma_f32_32x32x16_bf16 v[56:71], v[96:99], a[84:87], v[56:71]
    v_max3_u32 v152, v152, v96, v97
    v_max3_u32 v152, v152, v98, v99
    s_waitcnt vmcnt(11)
    v_mfma_f32_32x32x16_bf16 v[40:55], v[100:103], a[88:91], v[40:55]
    buffer_load_dwordx4 v[84:87], v2, s[20:23], s34 offen offset:2048 sc1
    v_mfma_f32_32x32x16_bf16 v[56:71], v[100:103], a[92:95], v[56:71]
    v_max3_u32 v152, v152, v100, v101
    v_max3_u32 v152, v152, v102, v103
    s_waitcnt vmcnt(11)
    v_mfma_f32_32x32x16_bf16 v[40:55], v[104:107], a[96:99], v[40:55]
    buffer_load_dwordx4 v[88:91], v2, s[20:23], s34 offen offset:3072 sc1
    s_add_u32 s34, s34, 4096
    v_mfma_f32_32x32x16_bf16 v[56:71], v[104:107], a[100:103], v[56:71]
    v_max3_u32 v152, v152, v104, v105
    v_max3_u32 v152, v152, v106, v107
    s_waitcnt vmcnt(11)
    v_mfma_f32_32x32x16_bf16 v[40:55], v[108:111], a[104:107], v[40:55]
    buffer_load_dwordx4 v[92:95], v2, s[20:23], s34 offen offset:0 sc1
    v_mfma_f32_32x32x16_bf16 v[56:71], v[108:111], a[108:111], v[56:71]
    v_max3_u32 v152, v152, v108, v109
    v_max3_u32 v152, v152, v110, v111
    s_waitcnt vmcnt(11)
    v_mfma_f32_32x32x16_bf16 v[40:55], v[112:115], a[112:115], v[40:55]
    buffer_load_dwordx4 v[96:99], v2, s[20:23], s34 offen offset:1024 sc1
    v_mfma_f32_32x32x16_bf16 v[56:71], v[112:115], a[116:119], v[56:71]
    v_max3_u32 v152, v152, v112, v113
    v_max3_u32 v152, v152, v114, v115
    s_waitcnt vmcnt(11)
    v_mfma_f32_32x32x16_bf16 v[40:55], v[116:119], a[120:123], v[40:55]
    buffer_load_dwordx4 v[100:103], v2, s[20:23], s34 offen offset:2048 sc1
    v_mfma_f32_32x32x16_bf16 v[56:71], v[116:119], a[124:127], v[56:71]
    v_max3_u32 v152, v152, v116, v117
    v_max3_u32 v152, v152, v118, v119
    s_waitcnt vmcnt(11)
    v_mfma_f32_32x32x16_bf16 v[40:55], v[120:123], a[128:131], v[40:55]
    v_mfma_f32_32x32x16_bf16 v[56:71], v[120:123], a[132:135], v[56:71]
    v_max3_u32 v152, v152, v120, v121
    v_max3_u32 v152, v152, v122, v123
    s_waitcnt vmcnt(10)
    v_mfma_f32_32x32x16_bf16 v[40:55], v[124:127], a[136:139], v[40:55]
    v_mfma_f32_32x32x16_bf16 v[56:71], v[124:127], a[140:143], v[56:71]
    v_max3_u32 v152, v152, v124, v125
    v_max3_u32 v152, v152, v126, v127
    s_waitcnt vmcnt(9)
    v_mfma_f32_32x32x16_bf16 v[40:55], v[128:131], a[144:147], v[40:55]
    v_mfma_f32_32x32x16_bf16 v[56:71], v[128:131], a[148:151], v[56:71]
    v_max3_u32 v152, v152, v128, v129
    v_max3_u32 v152, v152, v130, v131
    s_waitcnt vmcnt(8)
    v_mfma_f32_32x32x16_bf16 v[40:55], v[132:135], a[152:155], v[40:55]
    v_mfma_f32_32x32x16_bf16 v[56:71], v[132:135], a[156:159], v[56:71]
    v_max3_u32 v152, v152, v132, v133
    v_max3_u32 v152, v152, v134, v135
    s_waitcnt vmcnt(7)
    v_mfma_f32_32x32x16_bf16 v[40:55], v[72:75], a[160:163], v[40:55]
    v_mfma_f32_32x32x16_bf16 v[56:71], v[72:75], a[164:167], v[56:71]
    v_max3_u32 v152, v152, v72, v73
    v_max3_u32 v152, v152, v74, v75
    s_waitcnt vmcnt(6)
    v_mfma_f32_32x32x16_bf16 v[40:55], v[76:79], a[168:171], v[40:55]
    v_mfma_f32_32x32x16_bf16 v[56:71], v[76:79], a[172:175], v[56:71]
    v_max3_u32 v152, v152, v76, v77
    v_max3_u32 v152, v152, v78, v79
    s_waitcnt vmcnt(5)
    v_mfma_f32_32x32x16_bf16 v[40:55], v[80:83], a[176:179], v[40:55]
    v_mfma_f32_32x32x16_bf16 v[56:71], v[80:83], a[180:183], v[56:71]
    v_max3_u32 v152, v152, v80, v81
    v_max3_u32 v152, v152, v82, v83
    s_waitcnt vmcnt(4)
    v_mfma_f32_32x32x16_bf16 v[40:55], v[84:87], a[184:187], v[40:55]
    v_mfma_f32_32x32x16_bf16 v[56:71], v[84:87], a[188:191], v[56:71]
    v_max3_u32 v152, v152, v84, v85
    v_max3_u32 v152, v152, v86, v87
    s_waitcnt vmcnt(3)
    v_mfma_f32_32x32x16_bf16 v[40:55], v[88:91], a[192:195], v[40:55]
    v_mfma_f32_32x32x16_bf16 v[56:71], v[88:91], a[196:199], v[56:71]
    v_max3_u32 v152, v152, v88, v89
    v_max3_u32 v152, v152, v90, v91
    s_waitcnt vmcnt(2)
    v_mfma_f32_32x32x16_bf16 v[40:55], v[92:95], a[200:203], v[40:55]
    v_mfma_f32_32x32x16_bf16 v[56:71], v[92:95], a[204:207], v[56:71]
    v_max3_u32 v152, v152, v92, v93
    v_max3_u32 v152, v152, v94, v95
    s_waitcnt vmcnt(1)
    v_mfma_f32_32x32x16_bf16 v[40:55], v[96:99], a[208:211], v[40:55]
    v_mfma_f32_32x32x16_bf16 v[56:71], v[96:99], a[212:215], v[56:71]
    v_max3_u32 v152, v152, v96, v97
    v_max3_u32 v152, v152, v98, v99
    s_waitcnt vmcnt(0)
    v_mfma_f32_32x32x16_bf16 v[40:55], v[100:103], a[216:219], v[40:55]
    v_mfma_f32_32x32x16_bf16 v[56:71], v[100:103], a[220:223], v[56:71]
    v_max3_u32 v152, v152, v100, v101
    v_max3_u32 v152, v152, v102, v103
    s_nop 15
    s_branch Lm_g2_fin
Lm_oslow:
    s_nop 15
    v_mfma_f32_32x32x16_bf16 v[240:255], v[176:179], v[168:171], 0
    v_mfma_f32_32x32x16_bf16 v[240:255], v[180:183], v[172:175], v[240:255]
    v_mov_b32 v69, v161
    s_mov_b32 s11, 32
    s_movk_i32 s41, 2048
Lm_os1:
    buffer_load_dwordx4 v[8:11], v2, s[20:23], s33 offen sc1
    ds_read_b64_tr_b16 v[12:13], v69
    ds_read_b64_tr_b16 v[14:15], v69 offset:1024
    s_waitcnt vmcnt(0) lgkmcnt(0)
    v_max3_u32 v68, v8, v9, v10
    v_max_u32 v68, v68, v11
    s_sub_i32 s10, s10, 1
    v_cmp_eq_u32 vcc, -1, v68
    s_cmp_lt_i32 s10, 1
    s_cbranch_scc1 Lm_os2
    s_nop 2
    s_cbranch_vccnz Lm_os1
Lm_os2:
    v_mfma_f32_32x32x16_bf16 v[240:255], v[12:15], v[8:11], v[240:255]
    s_add_u32 s33, s33, 1024
    v_add_u32 v69, s41, v69
    s_xor_b32 s41, s41, 3584
    s_sub_u32 s11, s11, 1
    s_cmp_lg_u32 s11, 0
    s_cbranch_scc1 Lm_os1
    s_nop 15
    s_branch Lm_odone
Lm_slow:
    s_mov_b32 s36, s35
    s_mov_b32 s37, 64
    v_mov_b32 v152, 0xff800000
Lm_s1:
    buffer_load_dwordx4 v[56:59], v2, s[20:23], s36 offen offset:0 sc1
    buffer_load_dwordx4 v[60:63], v2, s[20:23], s36 offen offset:1024 sc1
    s_waitcnt vmcnt(0)
    v_mfma_f32_32x32x16_bf16 v[104:119], v[56:59], v[8:11], 0
    v_mfma_f32_32x32x16_bf16 v[104:119], v[60:63], v[12:15], v[104:119]
    s_add_u32 s36, s36, 4096
    s_nop 10
    v_max3_f32 v152, v152, v104, v105
    v_max3_f32 v152, v152, v106, v107
    v_max3_f32 v152, v152, v108, v109
    v_max3_f32 v152, v152, v110, v111
    v_max3_f32 v152, v152, v112, v113
    v_max3_f32 v152, v152, v114, v115
    v_max3_f32 v152, v152, v116, v117
    v_max3_f32 v152, v152, v118, v119
    s_sub_u32 s37, s37, 1
    s_cmp_lg_u32 s37, 0
    s_cbranch_scc1 Lm_s1
    v_mov_b32 v5, v152
    s_nop 1
    v_permlane32_swap_b32 v5, v152
    v_max_f32 v152, v5, v152
    v_sub_f32 v120, 0, v152
    v_mov_b32 v40, 0
    v_sub_f32 v121, 0, v152
    v_mov_b32 v41, 0
    v_sub_f32 v122, 0, v152
    v_mov_b32 v42, 0
    v_sub_f32 v123, 0, v152
    v_mov_b32 v43, 0
    v_sub_f32 v124, 0, v152
    v_mov_b32 v44, 0
    v_sub_f32 v125, 0, v152
    v_mov_b32 v45, 0
    v_sub_f32 v126, 0, v152
    v_mov_b32 v46, 0
    v_sub_f32 v127, 0, v152
    v_mov_b32 v47, 0
    v_sub_f32 v128, 0, v152
    v_mov_b32 v48, 0
    v_sub_f32 v129, 0, v152
    v_mov_b32 v49, 0
    v_sub_f32 v130, 0, v152
    v_mov_b32 v50, 0
    v_sub_f32 v131, 0, v152
    v_mov_b32 v51, 0
    v_sub_f32 v132, 0, v152
    v_mov_b32 v52, 0
    v_sub_f32 v133, 0, v152
    v_mov_b32 v53, 0
    v_sub_f32 v134, 0, v152
    v_mov_b32 v54, 0
    v_sub_f32 v135, 0, v152
    v_mov_b32 v55, 0
    s_mov_b32 s36, s35
    s_mov_b32 s37, 64
Lm_s2:
    buffer_load_dwordx4 v[56:59], v2, s[20:23], s36 offen offset:0 sc1
    buffer_load_dwordx4 v[60:63], v2, s[20:23], s36 offen offset:1024 sc1
    buffer_load_dwordx4 v[64:67], v2, s[20:23], s36 offen offset:2048 sc1
    buffer_load_dwordx4 v[68:71], v2, s[20:23], s36 offen offset:3072 sc1
    s_waitcnt vmcnt(0)
    v_mfma_f32_32x32x16_bf16 v[104:119], v[56:59], v[8:11], v[120:135]
    v_mfma_f32_32x32x16_bf16 v[104:119], v[60:63], v[12:15], v[104:119]
    s_add_u32 s36, s36, 4096
    s_nop 10
    v_exp_f32 v104, v104
    v_exp_f32 v105, v105
    v_exp_f32 v106, v106
    v_exp_f32 v107, v107
    v_exp_f32 v108, v108
    v_exp_f32 v109, v109
    v_exp_f32 v110, v110
    v_exp_f32 v111, v111
    v_exp_f32 v112, v112
    v_exp_f32 v113, v113
    v_exp_f32 v114, v114
    v_exp_f32 v115, v115
    v_exp_f32 v116, v116
    v_exp_f32 v117, v117
    v_exp_f32 v118, v118
    v_exp_f32 v119, v119
    v_cvt_pk_bf16_f32 v144, v104, v105
    v_cvt_pk_bf16_f32 v145, v106, v107
    v_cvt_pk_bf16_f32 v146, v108, v109
    v_cvt_pk_bf16_f32 v147, v110, v111
    v_cvt_pk_bf16_f32 v148, v112, v113
    v_cvt_pk_bf16_f32 v149, v114, v115
    v_cvt_pk_bf16_f32 v150, v116, v117
    v_cvt_pk_bf16_f32 v151, v118, v119
    v_mfma_f32_32x32x16_bf16 v[40:55], v[64:67], v[144:147], v[40:55]
    s_nop 0
    v_mfma_f32_32x32x16_bf16 v[40:55], v[68:71], v[148:151], v[40:55]
    s_sub_u32 s37, s37, 1
    s_cmp_lg_u32 s37, 0
    s_cbranch_scc1 Lm_s2
    s_nop 8
    v_mov_b32 v152, v52
    v_mov_b32 v5, v52
    s_nop 1
    v_permlane32_swap_b32 v5, v152
    s_branch Lm_fin
L_text_end:
.section .rodata,"a"
.p2align 6
.amdhsa_kernel sequential_preLN__mha_block__mixer_token_mlp__prompt_kernel
  .amdhsa_next_free_vgpr 512
  .amdhsa_next_free_sgpr 102
  .amdhsa_accum_offset 256
  .amdhsa_group_segment_fixed_size 0
  .amdhsa_kernarg_size 88
  .amdhsa_user_sgpr_count 2
  .amdhsa_user_sgpr_kernarg_segment_ptr 1
  .amdhsa_system_sgpr_workgroup_id_x 1
.end_amdhsa_kernel
```
